```python
import torch

def _softmax(x, axis=-1):
    return torch.softmax(x, dim=axis)
def _gelu(x):
    return torch.nn.functional.gelu(x, approximate="tanh")
def _silu(x):
    return torch.nn.functional.silu(x)
def _sigmoid(x):
    return torch.sigmoid(x)
def _layernorm(x, axis=-1, eps=1e-5):
    m = x.mean(dim=axis, keepdim=True)
    v = x.var(dim=axis, keepdim=True, unbiased=False)
    return (x - m) / torch.sqrt(v + eps)
def _scatter_add(tgt, idx, src, axis=0):
    return tgt.clone().index_add_(axis, idx, src)
def _segment_sum(src, seg, n):
    out = torch.zeros((n,) + src.shape[1:], dtype=src.dtype)
    return out.index_add_(0, seg, src)
def _pad(x, pw):
    flat = tuple(v for pair in reversed(pw) for v in pair)
    return torch.nn.functional.pad(x, flat)

kernel_name = 'gated_mix__ssm_conv_h3__geglu_ffn__prompt'

def setup_inputs():

    _w = (lambda a: (lambda t: t.to(torch.bfloat16) if t.is_floating_point() else t)(torch.as_tensor(a)))
    def _A_setup():
        B, S, D = 1, 2048, 576
        ks = 4
        return {
            "q": _w((lambda *s: torch.randn(*s, dtype=torch.bfloat16) * 0.05)(B, S, D)),
            "k": _w((lambda *s: torch.randn(*s, dtype=torch.bfloat16) * 0.4)(B, S, D)),
            "v": _w((lambda *s: torch.randn(*s, dtype=torch.bfloat16) * 0.4)(B, S, D)),
            "shift_k": _w((lambda *s: torch.randn(*s, dtype=torch.bfloat16) * 0.4)(D, ks) * 0.5),
            "ssm_k": _w((lambda *s: torch.randn(*s, dtype=torch.bfloat16) * 0.4)(D, S) * (1.0 / S ** 0.5)),
            "ssm_D": _w((lambda *s: torch.randn(*s, dtype=torch.bfloat16) * 0.4)(D)),
        }
    _A_in = _A_setup()

    def _B_setup():
        B, S, D, F = 1, 2048, 576, 4608
        return {
            "x": _w((lambda *s: torch.randn(*s, dtype=torch.bfloat16) * 0.05)(B, S, D)),
            "w_gate": _w((lambda *s: torch.randn(*s, dtype=torch.bfloat16) * 0.05)(D, F)),
            "w_up": _w((lambda *s: torch.randn(*s, dtype=torch.bfloat16) * 0.05)(D, F)),
            "w_down": _w((lambda *s: torch.randn(*s, dtype=torch.bfloat16) * 0.05)(F, D)),
        }
    _B_in = _B_setup()

    return {
        "A_q": _A_in["q"],
        "A_k": _A_in["k"],
        "A_v": _A_in["v"],
        "A_shift_k": _A_in["shift_k"],
        "A_ssm_k": _A_in["ssm_k"],
        "A_ssm_D": _A_in["ssm_D"],
        "B_x": _B_in["x"],
        "B_w_gate": _B_in["w_gate"],
        "B_w_up": _B_in["w_up"],
        "B_w_down": _B_in["w_down"],
        "gate_w": _w((lambda *s: torch.randn(*s, dtype=torch.bfloat16) * 0.05)(576) * 16.0),
    }

def reference(A_q, A_k, A_v, A_shift_k, A_ssm_k, A_ssm_D, B_x, B_w_gate, B_w_up, B_w_down, gate_w):
    def _A_ref(q, k, v, shift_k, ssm_k, ssm_D):
        B, S, D = q.shape
        ks = shift_k.shape[-1]
        k_pad = _pad(k, ((0, 0), (ks - 1, 0), (0, 0)))
        k_shift = torch.zeros_like(k)
        for t in range(ks):
            k_shift = k_shift + k_pad[:, t:t + S, :] * shift_k[:, ks - 1 - t][None, None, :]
        kv = k_shift * v
        L = 2 * S
        kv_pad = _pad(kv, ((0, 0), (0, S), (0, 0)))
        kf_pad = _pad(ssm_k, ((0, 0), (0, S)))
        kv_f = (lambda x, axes=(-2,-1): torch.fft.rfft2(x.float(), dim=axes))(kv_pad[:, None, :, :], axes=(1, 2))
        kf_f = (lambda x, axes=(-2,-1): torch.fft.rfft2(x.float(), dim=axes))(kf_pad[:, None, :], axes=(1, 2))
        kf_f = (lambda x, *d: x.permute(*d))(kf_f, 1, 2, 0)
        y_f = kv_f * kf_f[None, :, :, :]
        y = (lambda x, s, axes=(-2,-1): torch.fft.irfft2(x, s=s, dim=axes).to(torch.bfloat16))(y_f, (1, L), axes=(1, 2))[:, 0, :S, :]
        y = y + kv * ssm_D[None, None, :]
        return q * y

    def _B_ref(x, w_gate, w_up, w_down):
        return (_gelu(x @ w_gate) * (x @ w_up)) @ w_down

    x = A_q
    g = _sigmoid((x * gate_w).sum(-1, keepdims=True))
    a = _A_ref(x, A_k, A_v, A_shift_k, A_ssm_k, A_ssm_D)
    b = _B_ref(x, B_w_gate, B_w_up, B_w_down)
    return g * a + (1 - g) * b
```

```asm
; @launch grid=(256,1,1) block=(256,1,1) lds=163840
.amdgcn_target "amdgcn-amd-amdhsa--gfx950"
.text
.globl gated_mix__ssm_conv_h3__geglu_ffn__prompt_kernel
.p2align 8
.type gated_mix__ssm_conv_h3__geglu_ffn__prompt_kernel,@function
gated_mix__ssm_conv_h3__geglu_ffn__prompt_kernel:
s_cmp_ge_u32 s2, 256
s_cbranch_scc1 K_end
s_load_dwordx4 s[40:43], s[0:1], 56
s_load_dwordx2 s[4:5], s[0:1], 0
v_lshrrev_b32 v3, 6, v0
s_lshr_b32 s46, s2, 3
s_and_b32 s47, s2, 1
v_readfirstlane_b32 s24, v3
v_and_b32 v0, 63, v0
s_lshl_b32 s47, s47, 5
s_add_u32 s3, s46, s47
s_bfe_u32 s56, s2, 0x20001
s_getpc_b64 s[62:63]
A_pc:
s_sub_u32 s62, s62, A_pc-gated_mix__ssm_conv_h3__geglu_ffn__prompt_kernel
s_subb_u32 s63, s63, 0
s_lshl_b32 s55, s3, 2
s_add_u32 s55, s55, s24
s_and_b32 s55, s55, 127
s_mul_i32 s55, s55, 384
v_min_u32 v28, 5, v0
v_lshl_add_u32 v28, v28, 6, s55
v_min_u32 v28, 43456, v28
global_load_dword v223, v28, s[62:63]
s_cmp_eq_u32 s3, 63
s_cbranch_scc1 A_gate
s_mul_i32 s46, s3, 37
s_lshr_b32 s46, s46, 8
s_mul_i32 s47, s46, 7
s_sub_u32 s26, s3, s47
s_mul_i32 s47, s56, 9
s_add_u32 s25, s47, s46
s_lshl_b32 s46, s46, 1
s_cmp_ge_u32 s26, 4
s_addc_u32 s60, s46, s26
s_mul_i32 s46, s60, 29
s_lshr_b32 s46, s46, 8
s_mul_i32 s46, s46, 9
s_sub_u32 s60, s60, s46
s_mul_i32 s33, s60, 589824
s_mov_b32 s10, 5308416
s_mov_b32 s11, 0x00020000
v_bfe_u32 v29, v0, 4, 1
v_lshrrev_b32 v28, 5, v0
v_lshl_add_u32 v28, v28, 2, v29
s_lshr_b32 s48, s24, 1
s_mul_i32 s49, s48, 73728
v_mul_u32_u24 v28, 36864, v28
v_and_b32 v29, 15, v0
v_lshl_add_u32 v28, v29, 4, v28
s_lshl_b32 s47, s25, 8
s_add_u32 s49, s49, s47
v_add_u32 v2, s49, v28
v_add_u32 v3, 8160, v2
v_add_u32 v4, 8160, v3
v_add_u32 v5, 8160, v4
s_and_b32 s50, s24, 1
s_mul_i32 s52, s50, 8448
s_mul_i32 s49, s48, 4224
s_add_u32 s52, s52, s49
s_cmp_eq_u32 s50, 0
s_waitcnt lgkmcnt(0)
s_cselect_b32 s8, s40, s42
s_cselect_b32 s9, s41, s43
s_add_u32 m0, s52, 20480
s_add_u32 s36, s33, 294912
buffer_load_dwordx4 v2, s[8:11], s33 offen offset:0 lds
buffer_load_dwordx4 v3, s[8:11], s33 offen offset:1056 lds
buffer_load_dwordx4 v4, s[8:11], s33 offen offset:2112 lds
buffer_load_dwordx4 v5, s[8:11], s33 offen offset:3168 lds
s_add_u32 m0, s52, 37376
s_nop 0
buffer_load_dwordx4 v2, s[8:11], s36 offen offset:0 lds
buffer_load_dwordx4 v3, s[8:11], s36 offen offset:1056 lds
buffer_load_dwordx4 v4, s[8:11], s36 offen offset:2112 lds
buffer_load_dwordx4 v5, s[8:11], s36 offen offset:3168 lds
s_lshl_b32 s34, s60, 7
s_mov_b32 s6, 2363392
s_mov_b32 s7, 0x00020000
s_lshl_b32 s49, s50, 3
v_lshrrev_b32 v28, 3, v0
v_add_u32 v28, s49, v28
v_lshrrev_b32 v29, 1, v28
v_and_b32 v30, 7, v0
v_xor_b32 v29, v29, v30
v_mul_u32_u24 v28, 1152, v28
v_lshl_add_u32 v31, v29, 4, v28
s_mul_i32 s49, s48, 18432
s_add_u32 s49, s49, 4096
v_add_u32 v6, s49, v31
v_add_u32 v7, 35840, v6
s_mov_b32 s49, 35840
s_cmp_eq_u32 s48, 0
s_cselect_b32 s49, s49, 2146435072
v_add_u32 v8, s49, v7
s_mul_i32 s53, s24, 3072
s_mul_i32 s46, s26, 17
s_mul_i32 s47, s26, 20
s_sub_u32 s47, s47, 12
s_cmp_ge_u32 s26, 4
s_cselect_b32 s46, s47, s46
s_cselect_b32 s28, 4, 3
s_cselect_b32 s47, 20, 17
s_lshl_b32 s51, s56, 1
s_sub_u32 s51, s51, s46
s_sub_u32 s51, s51, 3
s_and_b32 s51, s51, 7
s_add_u32 s51, s51, 5
s_add_u32 s51, s51, s46
s_add_u32 s47, s47, s46
s_mul_i32 s29, s51, 18432
s_sub_u32 s4, s4, 4096
s_subb_u32 s5, s5, 0
s_add_u32 s49, s29, s34
s_add_u32 m0, s53, 54272
s_add_u32 s33, s33, 589824
buffer_load_dwordx4 v6, s[4:7], s49 offen offset:0 lds
buffer_load_dwordx4 v7, s[4:7], s49 offen offset:1024 lds
buffer_load_dwordx4 v8, s[4:7], s49 offen offset:2048 lds
s_add_u32 s34, s34, 128
s_cmp_eq_u32 s34, 1152
s_cselect_b32 s34, 0, s34
s_cselect_b32 s33, 0, s33
s_load_dwordx2 s[72:73], s[0:1], 8
s_load_dwordx2 s[76:77], s[0:1], 16
s_load_dwordx2 s[80:81], s[0:1], 24
s_load_dwordx2 s[84:85], s[0:1], 40
s_load_dwordx2 s[64:65], s[0:1], 72
s_load_dwordx2 s[68:69], s[0:1], 88
s_load_dwordx2 s[88:89], s[0:1], 96
s_load_dwordx2 s[12:13], s[0:1], 104
v_cmp_eq_u32 vcc, 0, v0
v_mov_b32 v28, 2146435072
s_mul_i32 s54, s24, 5120
s_mul_i32 s95, s24, 25600
s_add_u32 s95, s95, 61440
v_cndmask_b32 v27, v28, v0, vcc
s_and_b32 s58, s3, 3
s_lshr_b32 s57, s3, 2
s_mov_b32 s14, 48447488
s_mov_b32 s15, 0x00020000
s_mov_b32 s66, 5308928
s_mov_b32 s67, 0x00020000
s_mov_b32 s70, 2359296
s_mov_b32 s71, 0x00020000
s_mov_b32 s74, 2368512
s_mov_b32 s75, 0x00020000
s_mov_b32 s78, 2359296
s_mov_b32 s79, 0x00020000
s_mov_b32 s82, 4608
s_mov_b32 s83, 0x00020000
s_mov_b32 s86, 1152
s_mov_b32 s87, 0x00020000
s_mov_b32 s90, 256
s_mov_b32 s91, 0x00020000
s_mov_b32 s18, 5308928
s_mov_b32 s19, 0x00020000
s_mul_i32 s39, s47, 18432
s_mul_i32 s61, s47, 147456
s_mul_i32 s38, s46, 18432
s_mul_i32 s59, s46, 147456
s_mul_i32 s32, s51, 147456
s_mov_b32 s35, 3184710632
v_mov_b32 v26, 3222493025
s_lshl_b32 s40, s25, 2
s_add_u32 s27, s40, s26
s_add_u32 s40, s40, s24
s_lshl_b32 s41, s40, 10
v_lshl_add_u32 v25, v0, 4, s41
s_mul_i32 s41, s26, 144
s_add_u32 s40, s40, s41
s_lshl_b32 s40, s40, 5
s_add_u32 s93, s40, 23675008
s_mul_i32 s40, s24, 144
s_add_u32 s40, s40, s27
s_lshl_b32 s40, s40, 5
s_add_u32 s40, s40, 23707264
s_cmp_ge_u32 s26, 4
s_cselect_b32 s94, s93, s40
s_mov_b32 s37, 2146435072
s_add_u32 s40, s48, s60
s_add_u32 s40, s40, 0
s_cmp_ge_u32 s40, 9
s_cselect_b32 s41, 9, 0
s_sub_u32 s40, s40, s41
s_lshl_b32 s40, s40, 7
s_add_u32 s40, s40, 4096
v_add_u32 v9, s40, v31
s_add_u32 s40, s48, s60
s_add_u32 s40, s40, 2
s_cmp_ge_u32 s40, 9
s_cselect_b32 s41, 9, 0
s_sub_u32 s40, s40, s41
s_lshl_b32 s40, s40, 7
s_add_u32 s40, s40, 3072
v_add_u32 v10, s40, v31
s_add_u32 s40, s48, s60
s_add_u32 s40, s40, 4
s_cmp_ge_u32 s40, 9
s_cselect_b32 s41, 9, 0
s_sub_u32 s40, s40, s41
s_lshl_b32 s40, s40, 7
s_add_u32 s40, s40, 2048
v_add_u32 v11, s40, v31
s_add_u32 s40, s48, s60
s_add_u32 s40, s40, 6
s_cmp_ge_u32 s40, 9
s_cselect_b32 s41, 9, 0
s_sub_u32 s40, s40, s41
s_lshl_b32 s40, s40, 7
s_add_u32 s40, s40, 1024
v_add_u32 v12, s40, v31
s_add_u32 s40, s48, s60
s_add_u32 s40, s40, 8
s_cmp_ge_u32 s40, 9
s_cselect_b32 s41, 9, 0
s_sub_u32 s40, s40, s41
s_lshl_b32 s40, s40, 7
s_add_u32 s40, s40, 4096
s_cmp_eq_u32 s48, 0
s_cselect_b32 s40, s40, 2146435072
v_add_u32 v13, s40, v31
v_bfe_u32 v28, v0, 2, 3
v_mul_u32_u24 v28, 1056, v28
v_lshrrev_b32 v29, 5, v0
v_lshl_add_u32 v28, v29, 9, v28
v_and_b32 v29, 3, v0
v_lshl_add_u32 v28, v29, 3, v28
s_lshl_b32 s40, s24, 6
s_add_u32 s40, s40, 20480
v_add_u32 v14, s40, v28
v_add_u32 v15, 46080, v14
v_add_u32 v16, 92160, v14
v_bfe_u32 v28, v0, 1, 3
v_lshrrev_b32 v29, 4, v0
v_xor_b32 v28, v28, v29
v_lshlrev_b32 v28, 4, v28
v_and_b32 v29, 7, v0
v_lshl_add_u32 v28, v29, 7, v28
v_bfe_u32 v29, v0, 3, 1
v_mul_u32_u24 v30, 5120, v29
v_add_u32 v23, v30, v28
v_xor_b32 v24, 64, v23
v_mul_u32_u24 v30, 3072, v29
v_add_u32 v28, v30, v28
v_xor_b32 v29, 64, v28
v_add_u32 v17, 54272, v28
v_add_u32 v18, 54272, v29
v_add_u32 v19, 100352, v28
v_add_u32 v20, 100352, v29
v_add_u32 v21, 146432, v28
v_add_u32 v22, 146432, v29
s_waitcnt lgkmcnt(0)
s_sub_u32 s64, s64, 512
s_subb_u32 s65, s65, 0
s_sub_u32 s72, s72, 9216
s_subb_u32 s73, s73, 0
s_mov_b64 s[16:17], s[64:65]
s_add_u32 m0, s52, 66560
s_add_u32 s36, s33, 294912
buffer_load_dwordx4 v2, s[8:11], s33 offen offset:0 lds
buffer_load_dwordx4 v3, s[8:11], s33 offen offset:1056 lds
buffer_load_dwordx4 v4, s[8:11], s33 offen offset:2112 lds
buffer_load_dwordx4 v5, s[8:11], s33 offen offset:3168 lds
s_add_u32 m0, s52, 83456
s_add_u32 s49, s29, s34
buffer_load_dwordx4 v2, s[8:11], s36 offen offset:0 lds
buffer_load_dwordx4 v3, s[8:11], s36 offen offset:1056 lds
buffer_load_dwordx4 v4, s[8:11], s36 offen offset:2112 lds
buffer_load_dwordx4 v5, s[8:11], s36 offen offset:3168 lds
s_add_u32 m0, s53, 100352
s_add_u32 s33, s33, 589824
buffer_load_dwordx4 v6, s[4:7], s49 offen offset:0 lds
buffer_load_dwordx4 v7, s[4:7], s49 offen offset:1024 lds
buffer_load_dwordx4 v8, s[4:7], s49 offen offset:2048 lds
s_add_u32 s34, s34, 128
s_cmp_eq_u32 s34, 1152
s_cselect_b32 s34, 0, s34
s_cselect_b32 s33, 0, s33
s_waitcnt lgkmcnt(0)
s_waitcnt vmcnt(11)
s_barrier
ds_read_b64_tr_b16 a[0:1], v14 offset:0
ds_read_b64_tr_b16 a[2:3], v14 offset:256
ds_read_b64_tr_b16 a[4:5], v14 offset:32
ds_read_b64_tr_b16 a[6:7], v14 offset:288
ds_read_b64_tr_b16 a[8:9], v14 offset:8448
ds_read_b64_tr_b16 a[10:11], v14 offset:8704
ds_read_b64_tr_b16 a[12:13], v14 offset:8480
ds_read_b64_tr_b16 a[14:15], v14 offset:8736
ds_read_b128 v[172:175], v17 offset:0
ds_read_b128 v[176:179], v17 offset:6144
ds_read_b128 v[180:183], v17 offset:1024
ds_read_b128 v[184:187], v17 offset:7168
ds_read_b128 v[188:191], v17 offset:2048
ds_read_b64_tr_b16 a[16:17], v14 offset:16896
ds_read_b64_tr_b16 a[18:19], v14 offset:17152
ds_read_b64_tr_b16 a[20:21], v14 offset:16928
ds_read_b64_tr_b16 a[22:23], v14 offset:17184
ds_read_b64_tr_b16 a[24:25], v14 offset:25344
ds_read_b64_tr_b16 a[26:27], v14 offset:25600
ds_read_b64_tr_b16 a[28:29], v14 offset:25376
ds_read_b64_tr_b16 a[30:31], v14 offset:25632
ds_read_b128 v[192:195], v18 offset:0
ds_read_b128 v[196:199], v18 offset:6144
ds_read_b128 v[200:203], v18 offset:1024
ds_read_b128 v[204:207], v18 offset:7168
ds_read_b128 v[208:211], v18 offset:2048
s_add_u32 m0, s52, 112640
s_add_u32 s36, s33, 294912
buffer_load_dwordx4 v2, s[8:11], s33 offen offset:0 lds
buffer_load_dwordx4 v3, s[8:11], s33 offen offset:1056 lds
buffer_load_dwordx4 v4, s[8:11], s33 offen offset:2112 lds
buffer_load_dwordx4 v5, s[8:11], s33 offen offset:3168 lds
s_add_u32 m0, s52, 129536
s_add_u32 s49, s29, s34
buffer_load_dwordx4 v2, s[8:11], s36 offen offset:0 lds
buffer_load_dwordx4 v3, s[8:11], s36 offen offset:1056 lds
buffer_load_dwordx4 v4, s[8:11], s36 offen offset:2112 lds
buffer_load_dwordx4 v5, s[8:11], s36 offen offset:3168 lds
s_add_u32 m0, s53, 146432
s_add_u32 s33, s33, 589824
buffer_load_dwordx4 v6, s[4:7], s49 offen offset:0 lds
buffer_load_dwordx4 v7, s[4:7], s49 offen offset:1024 lds
buffer_load_dwordx4 v8, s[4:7], s49 offen offset:2048 lds
s_add_u32 s34, s34, 128
s_cmp_eq_u32 s34, 1152
s_cselect_b32 s34, 0, s34
s_cselect_b32 s33, 0, s33
s_waitcnt lgkmcnt(0)
s_waitcnt vmcnt(11)
s_barrier
v_mfma_f32_16x16x32_bf16 v[52:55], a[0:3], v[172:175], 0
s_add_u32 m0, s52, 20480
s_add_u32 s36, s33, 294912
ds_read_b64_tr_b16 a[32:33], v15 offset:0
v_mfma_f32_16x16x32_bf16 v[56:59], a[4:7], v[172:175], 0
buffer_load_dwordx4 v2, s[8:11], s33 offen offset:0 lds
ds_read_b64_tr_b16 a[34:35], v15 offset:256
v_mfma_f32_16x16x32_bf16 v[60:63], a[8:11], v[172:175], 0
ds_read_b64_tr_b16 a[36:37], v15 offset:32
v_mfma_f32_16x16x32_bf16 v[64:67], a[12:15], v[172:175], 0
buffer_load_dwordx4 v3, s[8:11], s33 offen offset:1056 lds
ds_read_b64_tr_b16 a[38:39], v15 offset:288
v_mfma_f32_16x16x32_bf16 v[68:71], a[0:3], v[176:179], 0
ds_read_b64_tr_b16 a[40:41], v15 offset:8448
v_mfma_f32_16x16x32_bf16 v[72:75], a[4:7], v[176:179], 0
ds_read_b64_tr_b16 a[42:43], v15 offset:8704
v_mfma_f32_16x16x32_bf16 v[76:79], a[8:11], v[176:179], 0
buffer_load_dwordx4 v4, s[8:11], s33 offen offset:2112 lds
ds_read_b64_tr_b16 a[44:45], v15 offset:8480
v_mfma_f32_16x16x32_bf16 v[80:83], a[12:15], v[176:179], 0
v_mfma_f32_16x16x32_bf16 v[100:103], a[0:3], v[180:183], 0
ds_read_b64_tr_b16 a[46:47], v15 offset:8736
v_mfma_f32_16x16x32_bf16 v[104:107], a[4:7], v[180:183], 0
ds_read_b128 v[132:135], v19 offset:0
v_mfma_f32_16x16x32_bf16 v[108:111], a[8:11], v[180:183], 0
buffer_load_dwordx4 v5, s[8:11], s33 offen offset:3168 lds
ds_read_b128 v[136:139], v19 offset:6144
v_mfma_f32_16x16x32_bf16 v[112:115], a[12:15], v[180:183], 0
ds_read_b128 v[140:143], v19 offset:1024
v_mfma_f32_16x16x32_bf16 v[116:119], a[0:3], v[184:187], 0
ds_read_b128 v[144:147], v19 offset:7168
v_mfma_f32_16x16x32_bf16 v[120:123], a[4:7], v[184:187], 0
s_add_u32 m0, s52, 37376
s_add_u32 s49, s29, s34
ds_read_b128 v[148:151], v19 offset:2048
v_mfma_f32_16x16x32_bf16 v[124:127], a[8:11], v[184:187], 0
buffer_load_dwordx4 v2, s[8:11], s36 offen offset:0 lds
v_mfma_f32_16x16x32_bf16 v[128:131], a[12:15], v[184:187], 0
ds_read_b64_tr_b16 a[48:49], v15 offset:16896
v_mfma_f32_16x16x32_bf16 v[84:87], a[0:3], v[188:191], 0
ds_read_b64_tr_b16 a[50:51], v15 offset:17152
v_mfma_f32_16x16x32_bf16 v[88:91], a[4:7], v[188:191], 0
buffer_load_dwordx4 v3, s[8:11], s36 offen offset:1056 lds
ds_read_b64_tr_b16 a[52:53], v15 offset:16928
v_mfma_f32_16x16x32_bf16 v[92:95], a[8:11], v[188:191], 0
ds_read_b64_tr_b16 a[54:55], v15 offset:17184
v_mfma_f32_16x16x32_bf16 v[96:99], a[12:15], v[188:191], 0
ds_read_b64_tr_b16 a[56:57], v15 offset:25344
v_mfma_f32_16x16x32_bf16 v[52:55], a[16:19], v[192:195], v[52:55]
buffer_load_dwordx4 v4, s[8:11], s36 offen offset:2112 lds
ds_read_b64_tr_b16 a[58:59], v15 offset:25600
v_mfma_f32_16x16x32_bf16 v[56:59], a[20:23], v[192:195], v[56:59]
ds_read_b64_tr_b16 a[60:61], v15 offset:25376
v_mfma_f32_16x16x32_bf16 v[60:63], a[24:27], v[192:195], v[60:63]
v_mfma_f32_16x16x32_bf16 v[64:67], a[28:31], v[192:195], v[64:67]
ds_read_b64_tr_b16 a[62:63], v15 offset:25632
v_mfma_f32_16x16x32_bf16 v[68:71], a[16:19], v[196:199], v[68:71]
buffer_load_dwordx4 v5, s[8:11], s36 offen offset:3168 lds
ds_read_b128 v[152:155], v20 offset:0
v_mfma_f32_16x16x32_bf16 v[72:75], a[20:23], v[196:199], v[72:75]
ds_read_b128 v[156:159], v20 offset:6144
v_mfma_f32_16x16x32_bf16 v[76:79], a[24:27], v[196:199], v[76:79]
ds_read_b128 v[160:163], v20 offset:1024
v_mfma_f32_16x16x32_bf16 v[80:83], a[28:31], v[196:199], v[80:83]
s_add_u32 m0, s53, 54272
s_add_u32 s33, s33, 589824
ds_read_b128 v[164:167], v20 offset:7168
v_mfma_f32_16x16x32_bf16 v[100:103], a[16:19], v[200:203], v[100:103]
buffer_load_dwordx4 v6, s[4:7], s49 offen offset:0 lds
ds_read_b128 v[168:171], v20 offset:2048
v_mfma_f32_16x16x32_bf16 v[104:107], a[20:23], v[200:203], v[104:107]
v_mfma_f32_16x16x32_bf16 v[108:111], a[24:27], v[200:203], v[108:111]
v_mfma_f32_16x16x32_bf16 v[112:115], a[28:31], v[200:203], v[112:115]
buffer_load_dwordx4 v7, s[4:7], s49 offen offset:1024 lds
v_mfma_f32_16x16x32_bf16 v[116:119], a[16:19], v[204:207], v[116:119]
v_mfma_f32_16x16x32_bf16 v[120:123], a[20:23], v[204:207], v[120:123]
v_mfma_f32_16x16x32_bf16 v[124:127], a[24:27], v[204:207], v[124:127]
buffer_load_dwordx4 v8, s[4:7], s49 offen offset:2048 lds
s_add_u32 s34, s34, 128
v_mfma_f32_16x16x32_bf16 v[128:131], a[28:31], v[204:207], v[128:131]
s_cmp_eq_u32 s34, 1152
s_cselect_b32 s34, 0, s34
s_cselect_b32 s33, 0, s33
v_mfma_f32_16x16x32_bf16 v[84:87], a[16:19], v[208:211], v[84:87]
v_mfma_f32_16x16x32_bf16 v[88:91], a[20:23], v[208:211], v[88:91]
v_mfma_f32_16x16x32_bf16 v[92:95], a[24:27], v[208:211], v[92:95]
v_mfma_f32_16x16x32_bf16 v[96:99], a[28:31], v[208:211], v[96:99]
s_waitcnt lgkmcnt(0)
s_waitcnt vmcnt(11)
s_barrier
v_mfma_f32_16x16x32_bf16 v[52:55], a[32:35], v[132:135], v[52:55]
s_add_u32 m0, s52, 66560
s_add_u32 s36, s33, 294912
ds_read_b64_tr_b16 a[64:65], v16 offset:0
v_mfma_f32_16x16x32_bf16 v[56:59], a[36:39], v[132:135], v[56:59]
buffer_load_dwordx4 v2, s[8:11], s33 offen offset:0 lds
ds_read_b64_tr_b16 a[66:67], v16 offset:256
v_mfma_f32_16x16x32_bf16 v[60:63], a[40:43], v[132:135], v[60:63]
ds_read_b64_tr_b16 a[68:69], v16 offset:32
v_mfma_f32_16x16x32_bf16 v[64:67], a[44:47], v[132:135], v[64:67]
buffer_load_dwordx4 v3, s[8:11], s33 offen offset:1056 lds
ds_read_b64_tr_b16 a[70:71], v16 offset:288
v_mfma_f32_16x16x32_bf16 v[68:71], a[32:35], v[136:139], v[68:71]
ds_read_b64_tr_b16 a[72:73], v16 offset:8448
v_mfma_f32_16x16x32_bf16 v[72:75], a[36:39], v[136:139], v[72:75]
ds_read_b64_tr_b16 a[74:75], v16 offset:8704
v_mfma_f32_16x16x32_bf16 v[76:79], a[40:43], v[136:139], v[76:79]
buffer_load_dwordx4 v4, s[8:11], s33 offen offset:2112 lds
ds_read_b64_tr_b16 a[76:77], v16 offset:8480
v_mfma_f32_16x16x32_bf16 v[80:83], a[44:47], v[136:139], v[80:83]
v_mfma_f32_16x16x32_bf16 v[100:103], a[32:35], v[140:143], v[100:103]
ds_read_b64_tr_b16 a[78:79], v16 offset:8736
v_mfma_f32_16x16x32_bf16 v[104:107], a[36:39], v[140:143], v[104:107]
ds_read_b128 v[172:175], v21 offset:0
v_mfma_f32_16x16x32_bf16 v[108:111], a[40:43], v[140:143], v[108:111]
buffer_load_dwordx4 v5, s[8:11], s33 offen offset:3168 lds
ds_read_b128 v[176:179], v21 offset:6144
v_mfma_f32_16x16x32_bf16 v[112:115], a[44:47], v[140:143], v[112:115]
ds_read_b128 v[180:183], v21 offset:1024
v_mfma_f32_16x16x32_bf16 v[116:119], a[32:35], v[144:147], v[116:119]
ds_read_b128 v[184:187], v21 offset:7168
v_mfma_f32_16x16x32_bf16 v[120:123], a[36:39], v[144:147], v[120:123]
s_add_u32 m0, s52, 83456
s_add_u32 s49, s29, s34
ds_read_b128 v[188:191], v21 offset:2048
v_mfma_f32_16x16x32_bf16 v[124:127], a[40:43], v[144:147], v[124:127]
buffer_load_dwordx4 v2, s[8:11], s36 offen offset:0 lds
v_mfma_f32_16x16x32_bf16 v[128:131], a[44:47], v[144:147], v[128:131]
ds_read_b64_tr_b16 a[80:81], v16 offset:16896
v_mfma_f32_16x16x32_bf16 v[84:87], a[32:35], v[148:151], v[84:87]
ds_read_b64_tr_b16 a[82:83], v16 offset:17152
v_mfma_f32_16x16x32_bf16 v[88:91], a[36:39], v[148:151], v[88:91]
buffer_load_dwordx4 v3, s[8:11], s36 offen offset:1056 lds
ds_read_b64_tr_b16 a[84:85], v16 offset:16928
v_mfma_f32_16x16x32_bf16 v[92:95], a[40:43], v[148:151], v[92:95]
ds_read_b64_tr_b16 a[86:87], v16 offset:17184
v_mfma_f32_16x16x32_bf16 v[96:99], a[44:47], v[148:151], v[96:99]
ds_read_b64_tr_b16 a[88:89], v16 offset:25344
v_mfma_f32_16x16x32_bf16 v[52:55], a[48:51], v[152:155], v[52:55]
buffer_load_dwordx4 v4, s[8:11], s36 offen offset:2112 lds
ds_read_b64_tr_b16 a[90:91], v16 offset:25600
v_mfma_f32_16x16x32_bf16 v[56:59], a[52:55], v[152:155], v[56:59]
ds_read_b64_tr_b16 a[92:93], v16 offset:25376
v_mfma_f32_16x16x32_bf16 v[60:63], a[56:59], v[152:155], v[60:63]
v_mfma_f32_16x16x32_bf16 v[64:67], a[60:63], v[152:155], v[64:67]
ds_read_b64_tr_b16 a[94:95], v16 offset:25632
v_mfma_f32_16x16x32_bf16 v[68:71], a[48:51], v[156:159], v[68:71]
buffer_load_dwordx4 v5, s[8:11], s36 offen offset:3168 lds
ds_read_b128 v[192:195], v22 offset:0
v_mfma_f32_16x16x32_bf16 v[72:75], a[52:55], v[156:159], v[72:75]
ds_read_b128 v[196:199], v22 offset:6144
v_mfma_f32_16x16x32_bf16 v[76:79], a[56:59], v[156:159], v[76:79]
ds_read_b128 v[200:203], v22 offset:1024
v_mfma_f32_16x16x32_bf16 v[80:83], a[60:63], v[156:159], v[80:83]
s_add_u32 m0, s53, 100352
s_add_u32 s33, s33, 589824
ds_read_b128 v[204:207], v22 offset:7168
v_mfma_f32_16x16x32_bf16 v[100:103], a[48:51], v[160:163], v[100:103]
buffer_load_dwordx4 v6, s[4:7], s49 offen offset:0 lds
ds_read_b128 v[208:211], v22 offset:2048
v_mfma_f32_16x16x32_bf16 v[104:107], a[52:55], v[160:163], v[104:107]
v_mfma_f32_16x16x32_bf16 v[108:111], a[56:59], v[160:163], v[108:111]
v_mfma_f32_16x16x32_bf16 v[112:115], a[60:63], v[160:163], v[112:115]
buffer_load_dwordx4 v7, s[4:7], s49 offen offset:1024 lds
v_mfma_f32_16x16x32_bf16 v[116:119], a[48:51], v[164:167], v[116:119]
v_mfma_f32_16x16x32_bf16 v[120:123], a[52:55], v[164:167], v[120:123]
v_mfma_f32_16x16x32_bf16 v[124:127], a[56:59], v[164:167], v[124:127]
buffer_load_dwordx4 v8, s[4:7], s49 offen offset:2048 lds
s_add_u32 s34, s34, 128
v_mfma_f32_16x16x32_bf16 v[128:131], a[60:63], v[164:167], v[128:131]
s_cmp_eq_u32 s34, 1152
s_cselect_b32 s34, 0, s34
s_cselect_b32 s33, 0, s33
v_mfma_f32_16x16x32_bf16 v[84:87], a[48:51], v[168:171], v[84:87]
v_mfma_f32_16x16x32_bf16 v[88:91], a[52:55], v[168:171], v[88:91]
v_mfma_f32_16x16x32_bf16 v[92:95], a[56:59], v[168:171], v[92:95]
v_mfma_f32_16x16x32_bf16 v[96:99], a[60:63], v[168:171], v[96:99]
s_waitcnt lgkmcnt(0)
s_waitcnt vmcnt(11)
s_barrier
v_mfma_f32_16x16x32_bf16 v[52:55], a[64:67], v[172:175], v[52:55]
s_add_u32 m0, s52, 112640
s_add_u32 s36, s33, 294912
ds_read_b64_tr_b16 a[96:97], v14 offset:0
v_mfma_f32_16x16x32_bf16 v[56:59], a[68:71], v[172:175], v[56:59]
buffer_load_dwordx4 v2, s[8:11], s33 offen offset:0 lds
ds_read_b64_tr_b16 a[98:99], v14 offset:256
v_mfma_f32_16x16x32_bf16 v[60:63], a[72:75], v[172:175], v[60:63]
ds_read_b64_tr_b16 a[100:101], v14 offset:32
v_mfma_f32_16x16x32_bf16 v[64:67], a[76:79], v[172:175], v[64:67]
buffer_load_dwordx4 v3, s[8:11], s33 offen offset:1056 lds
ds_read_b64_tr_b16 a[102:103], v14 offset:288
v_mfma_f32_16x16x32_bf16 v[68:71], a[64:67], v[176:179], v[68:71]
ds_read_b64_tr_b16 a[104:105], v14 offset:8448
v_mfma_f32_16x16x32_bf16 v[72:75], a[68:71], v[176:179], v[72:75]
ds_read_b64_tr_b16 a[106:107], v14 offset:8704
v_mfma_f32_16x16x32_bf16 v[76:79], a[72:75], v[176:179], v[76:79]
buffer_load_dwordx4 v4, s[8:11], s33 offen offset:2112 lds
ds_read_b64_tr_b16 a[108:109], v14 offset:8480
v_mfma_f32_16x16x32_bf16 v[80:83], a[76:79], v[176:179], v[80:83]
v_mfma_f32_16x16x32_bf16 v[100:103], a[64:67], v[180:183], v[100:103]
ds_read_b64_tr_b16 a[110:111], v14 offset:8736
v_mfma_f32_16x16x32_bf16 v[104:107], a[68:71], v[180:183], v[104:107]
ds_read_b128 v[132:135], v17 offset:0
v_mfma_f32_16x16x32_bf16 v[108:111], a[72:75], v[180:183], v[108:111]
buffer_load_dwordx4 v5, s[8:11], s33 offen offset:3168 lds
ds_read_b128 v[136:139], v17 offset:6144
v_mfma_f32_16x16x32_bf16 v[112:115], a[76:79], v[180:183], v[112:115]
ds_read_b128 v[140:143], v17 offset:1024
v_mfma_f32_16x16x32_bf16 v[116:119], a[64:67], v[184:187], v[116:119]
ds_read_b128 v[144:147], v17 offset:7168
v_mfma_f32_16x16x32_bf16 v[120:123], a[68:71], v[184:187], v[120:123]
s_add_u32 m0, s52, 129536
s_add_u32 s49, s29, s34
ds_read_b128 v[148:151], v17 offset:2048
v_mfma_f32_16x16x32_bf16 v[124:127], a[72:75], v[184:187], v[124:127]
buffer_load_dwordx4 v2, s[8:11], s36 offen offset:0 lds
v_mfma_f32_16x16x32_bf16 v[128:131], a[76:79], v[184:187], v[128:131]
ds_read_b64_tr_b16 a[112:113], v14 offset:16896
v_mfma_f32_16x16x32_bf16 v[84:87], a[64:67], v[188:191], v[84:87]
ds_read_b64_tr_b16 a[114:115], v14 offset:17152
v_mfma_f32_16x16x32_bf16 v[88:91], a[68:71], v[188:191], v[88:91]
buffer_load_dwordx4 v3, s[8:11], s36 offen offset:1056 lds
ds_read_b64_tr_b16 a[116:117], v14 offset:16928
v_mfma_f32_16x16x32_bf16 v[92:95], a[72:75], v[188:191], v[92:95]
ds_read_b64_tr_b16 a[118:119], v14 offset:17184
v_mfma_f32_16x16x32_bf16 v[96:99], a[76:79], v[188:191], v[96:99]
ds_read_b64_tr_b16 a[120:121], v14 offset:25344
v_mfma_f32_16x16x32_bf16 v[52:55], a[80:83], v[192:195], v[52:55]
buffer_load_dwordx4 v4, s[8:11], s36 offen offset:2112 lds
ds_read_b64_tr_b16 a[122:123], v14 offset:25600
v_mfma_f32_16x16x32_bf16 v[56:59], a[84:87], v[192:195], v[56:59]
ds_read_b64_tr_b16 a[124:125], v14 offset:25376
v_mfma_f32_16x16x32_bf16 v[60:63], a[88:91], v[192:195], v[60:63]
v_mfma_f32_16x16x32_bf16 v[64:67], a[92:95], v[192:195], v[64:67]
ds_read_b64_tr_b16 a[126:127], v14 offset:25632
v_mfma_f32_16x16x32_bf16 v[68:71], a[80:83], v[196:199], v[68:71]
buffer_load_dwordx4 v5, s[8:11], s36 offen offset:3168 lds
ds_read_b128 v[152:155], v18 offset:0
v_mfma_f32_16x16x32_bf16 v[72:75], a[84:87], v[196:199], v[72:75]
ds_read_b128 v[156:159], v18 offset:6144
v_mfma_f32_16x16x32_bf16 v[76:79], a[88:91], v[196:199], v[76:79]
ds_read_b128 v[160:163], v18 offset:1024
v_mfma_f32_16x16x32_bf16 v[80:83], a[92:95], v[196:199], v[80:83]
s_add_u32 m0, s53, 146432
s_add_u32 s33, s33, 589824
ds_read_b128 v[164:167], v18 offset:7168
v_mfma_f32_16x16x32_bf16 v[100:103], a[80:83], v[200:203], v[100:103]
buffer_load_dwordx4 v6, s[4:7], s49 offen offset:0 lds
ds_read_b128 v[168:171], v18 offset:2048
v_mfma_f32_16x16x32_bf16 v[104:107], a[84:87], v[200:203], v[104:107]
v_mfma_f32_16x16x32_bf16 v[108:111], a[88:91], v[200:203], v[108:111]
v_mfma_f32_16x16x32_bf16 v[112:115], a[92:95], v[200:203], v[112:115]
buffer_load_dwordx4 v7, s[4:7], s49 offen offset:1024 lds
v_mfma_f32_16x16x32_bf16 v[116:119], a[80:83], v[204:207], v[116:119]
v_mfma_f32_16x16x32_bf16 v[120:123], a[84:87], v[204:207], v[120:123]
v_mfma_f32_16x16x32_bf16 v[124:127], a[88:91], v[204:207], v[124:127]
buffer_load_dwordx4 v8, s[4:7], s49 offen offset:2048 lds
s_add_u32 s34, s34, 128
v_mfma_f32_16x16x32_bf16 v[128:131], a[92:95], v[204:207], v[128:131]
s_cmp_eq_u32 s34, 1152
s_cselect_b32 s34, 0, s34
s_cselect_b32 s33, 0, s33
v_mfma_f32_16x16x32_bf16 v[84:87], a[80:83], v[208:211], v[84:87]
v_mfma_f32_16x16x32_bf16 v[88:91], a[84:87], v[208:211], v[88:91]
v_mfma_f32_16x16x32_bf16 v[92:95], a[88:91], v[208:211], v[92:95]
v_mfma_f32_16x16x32_bf16 v[96:99], a[92:95], v[208:211], v[96:99]
s_waitcnt lgkmcnt(0)
s_waitcnt vmcnt(11)
s_barrier
v_mfma_f32_16x16x32_bf16 v[52:55], a[96:99], v[132:135], v[52:55]
s_add_u32 m0, s52, 20480
s_add_u32 s36, s33, 294912
ds_read_b64_tr_b16 a[128:129], v15 offset:0
v_mfma_f32_16x16x32_bf16 v[56:59], a[100:103], v[132:135], v[56:59]
buffer_load_dwordx4 v2, s[8:11], s33 offen offset:0 lds
ds_read_b64_tr_b16 a[130:131], v15 offset:256
v_mfma_f32_16x16x32_bf16 v[60:63], a[104:107], v[132:135], v[60:63]
ds_read_b64_tr_b16 a[132:133], v15 offset:32
v_mfma_f32_16x16x32_bf16 v[64:67], a[108:111], v[132:135], v[64:67]
buffer_load_dwordx4 v3, s[8:11], s33 offen offset:1056 lds
ds_read_b64_tr_b16 a[134:135], v15 offset:288
v_mfma_f32_16x16x32_bf16 v[68:71], a[96:99], v[136:139], v[68:71]
ds_read_b64_tr_b16 a[136:137], v15 offset:8448
v_mfma_f32_16x16x32_bf16 v[72:75], a[100:103], v[136:139], v[72:75]
ds_read_b64_tr_b16 a[138:139], v15 offset:8704
v_mfma_f32_16x16x32_bf16 v[76:79], a[104:107], v[136:139], v[76:79]
buffer_load_dwordx4 v4, s[8:11], s33 offen offset:2112 lds
ds_read_b64_tr_b16 a[140:141], v15 offset:8480
v_mfma_f32_16x16x32_bf16 v[80:83], a[108:111], v[136:139], v[80:83]
v_mfma_f32_16x16x32_bf16 v[100:103], a[96:99], v[140:143], v[100:103]
ds_read_b64_tr_b16 a[142:143], v15 offset:8736
v_mfma_f32_16x16x32_bf16 v[104:107], a[100:103], v[140:143], v[104:107]
ds_read_b128 v[172:175], v19 offset:0
v_mfma_f32_16x16x32_bf16 v[108:111], a[104:107], v[140:143], v[108:111]
buffer_load_dwordx4 v5, s[8:11], s33 offen offset:3168 lds
ds_read_b128 v[176:179], v19 offset:6144
v_mfma_f32_16x16x32_bf16 v[112:115], a[108:111], v[140:143], v[112:115]
ds_read_b128 v[180:183], v19 offset:1024
v_mfma_f32_16x16x32_bf16 v[116:119], a[96:99], v[144:147], v[116:119]
ds_read_b128 v[184:187], v19 offset:7168
v_mfma_f32_16x16x32_bf16 v[120:123], a[100:103], v[144:147], v[120:123]
s_add_u32 m0, s52, 37376
s_add_u32 s49, s29, s34
ds_read_b128 v[188:191], v19 offset:2048
v_mfma_f32_16x16x32_bf16 v[124:127], a[104:107], v[144:147], v[124:127]
buffer_load_dwordx4 v2, s[8:11], s36 offen offset:0 lds
v_mfma_f32_16x16x32_bf16 v[128:131], a[108:111], v[144:147], v[128:131]
ds_read_b64_tr_b16 a[144:145], v15 offset:16896
v_mfma_f32_16x16x32_bf16 v[84:87], a[96:99], v[148:151], v[84:87]
ds_read_b64_tr_b16 a[146:147], v15 offset:17152
v_mfma_f32_16x16x32_bf16 v[88:91], a[100:103], v[148:151], v[88:91]
buffer_load_dwordx4 v3, s[8:11], s36 offen offset:1056 lds
ds_read_b64_tr_b16 a[148:149], v15 offset:16928
v_mfma_f32_16x16x32_bf16 v[92:95], a[104:107], v[148:151], v[92:95]
ds_read_b64_tr_b16 a[150:151], v15 offset:17184
v_mfma_f32_16x16x32_bf16 v[96:99], a[108:111], v[148:151], v[96:99]
ds_read_b64_tr_b16 a[152:153], v15 offset:25344
v_mfma_f32_16x16x32_bf16 v[52:55], a[112:115], v[152:155], v[52:55]
buffer_load_dwordx4 v4, s[8:11], s36 offen offset:2112 lds
ds_read_b64_tr_b16 a[154:155], v15 offset:25600
v_mfma_f32_16x16x32_bf16 v[56:59], a[116:119], v[152:155], v[56:59]
ds_read_b64_tr_b16 a[156:157], v15 offset:25376
v_mfma_f32_16x16x32_bf16 v[60:63], a[120:123], v[152:155], v[60:63]
v_mfma_f32_16x16x32_bf16 v[64:67], a[124:127], v[152:155], v[64:67]
ds_read_b64_tr_b16 a[158:159], v15 offset:25632
v_mfma_f32_16x16x32_bf16 v[68:71], a[112:115], v[156:159], v[68:71]
buffer_load_dwordx4 v5, s[8:11], s36 offen offset:3168 lds
ds_read_b128 v[192:195], v20 offset:0
v_mfma_f32_16x16x32_bf16 v[72:75], a[116:119], v[156:159], v[72:75]
ds_read_b128 v[196:199], v20 offset:6144
v_mfma_f32_16x16x32_bf16 v[76:79], a[120:123], v[156:159], v[76:79]
ds_read_b128 v[200:203], v20 offset:1024
v_mfma_f32_16x16x32_bf16 v[80:83], a[124:127], v[156:159], v[80:83]
s_add_u32 m0, s53, 54272
s_add_u32 s33, s33, 589824
ds_read_b128 v[204:207], v20 offset:7168
v_mfma_f32_16x16x32_bf16 v[100:103], a[112:115], v[160:163], v[100:103]
buffer_load_dwordx4 v6, s[4:7], s49 offen offset:0 lds
ds_read_b128 v[208:211], v20 offset:2048
v_mfma_f32_16x16x32_bf16 v[104:107], a[116:119], v[160:163], v[104:107]
v_mfma_f32_16x16x32_bf16 v[108:111], a[120:123], v[160:163], v[108:111]
v_mfma_f32_16x16x32_bf16 v[112:115], a[124:127], v[160:163], v[112:115]
buffer_load_dwordx4 v7, s[4:7], s49 offen offset:1024 lds
v_mfma_f32_16x16x32_bf16 v[116:119], a[112:115], v[164:167], v[116:119]
v_mfma_f32_16x16x32_bf16 v[120:123], a[116:119], v[164:167], v[120:123]
v_mfma_f32_16x16x32_bf16 v[124:127], a[120:123], v[164:167], v[124:127]
buffer_load_dwordx4 v8, s[4:7], s49 offen offset:2048 lds
s_add_u32 s34, s34, 128
v_mfma_f32_16x16x32_bf16 v[128:131], a[124:127], v[164:167], v[128:131]
s_cmp_eq_u32 s34, 1152
s_cselect_b32 s34, 0, s34
s_cselect_b32 s33, 0, s33
v_mfma_f32_16x16x32_bf16 v[84:87], a[112:115], v[168:171], v[84:87]
v_mfma_f32_16x16x32_bf16 v[88:91], a[116:119], v[168:171], v[88:91]
v_mfma_f32_16x16x32_bf16 v[92:95], a[120:123], v[168:171], v[92:95]
v_mfma_f32_16x16x32_bf16 v[96:99], a[124:127], v[168:171], v[96:99]
s_waitcnt lgkmcnt(0)
s_waitcnt vmcnt(11)
s_barrier
v_mfma_f32_16x16x32_bf16 v[52:55], a[128:131], v[172:175], v[52:55]
s_add_u32 m0, s52, 66560
s_add_u32 s36, s33, 294912
ds_read_b64_tr_b16 a[160:161], v16 offset:0
v_mfma_f32_16x16x32_bf16 v[56:59], a[132:135], v[172:175], v[56:59]
buffer_load_dwordx4 v2, s[8:11], s33 offen offset:0 lds
ds_read_b64_tr_b16 a[162:163], v16 offset:256
v_mfma_f32_16x16x32_bf16 v[60:63], a[136:139], v[172:175], v[60:63]
ds_read_b64_tr_b16 a[164:165], v16 offset:32
v_mfma_f32_16x16x32_bf16 v[64:67], a[140:143], v[172:175], v[64:67]
buffer_load_dwordx4 v3, s[8:11], s33 offen offset:1056 lds
ds_read_b64_tr_b16 a[166:167], v16 offset:288
v_mfma_f32_16x16x32_bf16 v[68:71], a[128:131], v[176:179], v[68:71]
ds_read_b64_tr_b16 a[168:169], v16 offset:8448
v_mfma_f32_16x16x32_bf16 v[72:75], a[132:135], v[176:179], v[72:75]
ds_read_b64_tr_b16 a[170:171], v16 offset:8704
v_mfma_f32_16x16x32_bf16 v[76:79], a[136:139], v[176:179], v[76:79]
buffer_load_dwordx4 v4, s[8:11], s33 offen offset:2112 lds
ds_read_b64_tr_b16 a[172:173], v16 offset:8480
v_mfma_f32_16x16x32_bf16 v[80:83], a[140:143], v[176:179], v[80:83]
v_mfma_f32_16x16x32_bf16 v[100:103], a[128:131], v[180:183], v[100:103]
ds_read_b64_tr_b16 a[174:175], v16 offset:8736
v_mfma_f32_16x16x32_bf16 v[104:107], a[132:135], v[180:183], v[104:107]
ds_read_b128 v[132:135], v21 offset:0
v_mfma_f32_16x16x32_bf16 v[108:111], a[136:139], v[180:183], v[108:111]
buffer_load_dwordx4 v5, s[8:11], s33 offen offset:3168 lds
ds_read_b128 v[136:139], v21 offset:6144
v_mfma_f32_16x16x32_bf16 v[112:115], a[140:143], v[180:183], v[112:115]
ds_read_b128 v[140:143], v21 offset:1024
v_mfma_f32_16x16x32_bf16 v[116:119], a[128:131], v[184:187], v[116:119]
ds_read_b128 v[144:147], v21 offset:7168
v_mfma_f32_16x16x32_bf16 v[120:123], a[132:135], v[184:187], v[120:123]
s_add_u32 m0, s52, 83456
s_add_u32 s49, s29, s34
ds_read_b128 v[148:151], v21 offset:2048
v_mfma_f32_16x16x32_bf16 v[124:127], a[136:139], v[184:187], v[124:127]
buffer_load_dwordx4 v2, s[8:11], s36 offen offset:0 lds
v_mfma_f32_16x16x32_bf16 v[128:131], a[140:143], v[184:187], v[128:131]
ds_read_b64_tr_b16 a[176:177], v16 offset:16896
v_mfma_f32_16x16x32_bf16 v[84:87], a[128:131], v[188:191], v[84:87]
ds_read_b64_tr_b16 a[178:179], v16 offset:17152
v_mfma_f32_16x16x32_bf16 v[88:91], a[132:135], v[188:191], v[88:91]
buffer_load_dwordx4 v3, s[8:11], s36 offen offset:1056 lds
ds_read_b64_tr_b16 a[180:181], v16 offset:16928
v_mfma_f32_16x16x32_bf16 v[92:95], a[136:139], v[188:191], v[92:95]
ds_read_b64_tr_b16 a[182:183], v16 offset:17184
v_mfma_f32_16x16x32_bf16 v[96:99], a[140:143], v[188:191], v[96:99]
ds_read_b64_tr_b16 a[184:185], v16 offset:25344
v_mfma_f32_16x16x32_bf16 v[52:55], a[144:147], v[192:195], v[52:55]
buffer_load_dwordx4 v4, s[8:11], s36 offen offset:2112 lds
ds_read_b64_tr_b16 a[186:187], v16 offset:25600
v_mfma_f32_16x16x32_bf16 v[56:59], a[148:151], v[192:195], v[56:59]
ds_read_b64_tr_b16 a[188:189], v16 offset:25376
v_mfma_f32_16x16x32_bf16 v[60:63], a[152:155], v[192:195], v[60:63]
v_mfma_f32_16x16x32_bf16 v[64:67], a[156:159], v[192:195], v[64:67]
ds_read_b64_tr_b16 a[190:191], v16 offset:25632
v_mfma_f32_16x16x32_bf16 v[68:71], a[144:147], v[196:199], v[68:71]
buffer_load_dwordx4 v5, s[8:11], s36 offen offset:3168 lds
ds_read_b128 v[152:155], v22 offset:0
v_mfma_f32_16x16x32_bf16 v[72:75], a[148:151], v[196:199], v[72:75]
ds_read_b128 v[156:159], v22 offset:6144
v_mfma_f32_16x16x32_bf16 v[76:79], a[152:155], v[196:199], v[76:79]
ds_read_b128 v[160:163], v22 offset:1024
v_mfma_f32_16x16x32_bf16 v[80:83], a[156:159], v[196:199], v[80:83]
s_add_u32 m0, s53, 100352
s_add_u32 s33, s33, 589824
ds_read_b128 v[164:167], v22 offset:7168
v_mfma_f32_16x16x32_bf16 v[100:103], a[144:147], v[200:203], v[100:103]
buffer_load_dwordx4 v6, s[4:7], s49 offen offset:0 lds
ds_read_b128 v[168:171], v22 offset:2048
v_mfma_f32_16x16x32_bf16 v[104:107], a[148:151], v[200:203], v[104:107]
v_mfma_f32_16x16x32_bf16 v[108:111], a[152:155], v[200:203], v[108:111]
v_mfma_f32_16x16x32_bf16 v[112:115], a[156:159], v[200:203], v[112:115]
buffer_load_dwordx4 v7, s[4:7], s49 offen offset:1024 lds
v_mfma_f32_16x16x32_bf16 v[116:119], a[144:147], v[204:207], v[116:119]
v_mfma_f32_16x16x32_bf16 v[120:123], a[148:151], v[204:207], v[120:123]
v_mfma_f32_16x16x32_bf16 v[124:127], a[152:155], v[204:207], v[124:127]
buffer_load_dwordx4 v8, s[4:7], s49 offen offset:2048 lds
s_add_u32 s34, s34, 128
v_mfma_f32_16x16x32_bf16 v[128:131], a[156:159], v[204:207], v[128:131]
s_cmp_eq_u32 s34, 1152
s_cselect_b32 s34, 0, s34
s_cselect_b32 s33, 0, s33
v_mfma_f32_16x16x32_bf16 v[84:87], a[144:147], v[208:211], v[84:87]
v_mfma_f32_16x16x32_bf16 v[88:91], a[148:151], v[208:211], v[88:91]
v_mfma_f32_16x16x32_bf16 v[92:95], a[152:155], v[208:211], v[92:95]
v_mfma_f32_16x16x32_bf16 v[96:99], a[156:159], v[208:211], v[96:99]
s_waitcnt lgkmcnt(0)
s_waitcnt vmcnt(11)
s_barrier
v_mfma_f32_16x16x32_bf16 v[52:55], a[160:163], v[132:135], v[52:55]
s_add_u32 m0, s52, 112640
s_add_u32 s36, s33, 294912
ds_read_b64_tr_b16 a[192:193], v14 offset:0
v_mfma_f32_16x16x32_bf16 v[56:59], a[164:167], v[132:135], v[56:59]
buffer_load_dwordx4 v2, s[8:11], s33 offen offset:0 lds
ds_read_b64_tr_b16 a[194:195], v14 offset:256
v_mfma_f32_16x16x32_bf16 v[60:63], a[168:171], v[132:135], v[60:63]
ds_read_b64_tr_b16 a[196:197], v14 offset:32
v_mfma_f32_16x16x32_bf16 v[64:67], a[172:175], v[132:135], v[64:67]
buffer_load_dwordx4 v3, s[8:11], s33 offen offset:1056 lds
ds_read_b64_tr_b16 a[198:199], v14 offset:288
v_mfma_f32_16x16x32_bf16 v[68:71], a[160:163], v[136:139], v[68:71]
ds_read_b64_tr_b16 a[200:201], v14 offset:8448
v_mfma_f32_16x16x32_bf16 v[72:75], a[164:167], v[136:139], v[72:75]
ds_read_b64_tr_b16 a[202:203], v14 offset:8704
v_mfma_f32_16x16x32_bf16 v[76:79], a[168:171], v[136:139], v[76:79]
buffer_load_dwordx4 v4, s[8:11], s33 offen offset:2112 lds
ds_read_b64_tr_b16 a[204:205], v14 offset:8480
v_mfma_f32_16x16x32_bf16 v[80:83], a[172:175], v[136:139], v[80:83]
v_mfma_f32_16x16x32_bf16 v[100:103], a[160:163], v[140:143], v[100:103]
ds_read_b64_tr_b16 a[206:207], v14 offset:8736
v_mfma_f32_16x16x32_bf16 v[104:107], a[164:167], v[140:143], v[104:107]
ds_read_b128 v[172:175], v17 offset:0
v_mfma_f32_16x16x32_bf16 v[108:111], a[168:171], v[140:143], v[108:111]
buffer_load_dwordx4 v5, s[8:11], s33 offen offset:3168 lds
ds_read_b128 v[176:179], v17 offset:6144
v_mfma_f32_16x16x32_bf16 v[112:115], a[172:175], v[140:143], v[112:115]
ds_read_b128 v[180:183], v17 offset:1024
v_mfma_f32_16x16x32_bf16 v[116:119], a[160:163], v[144:147], v[116:119]
ds_read_b128 v[184:187], v17 offset:7168
v_mfma_f32_16x16x32_bf16 v[120:123], a[164:167], v[144:147], v[120:123]
s_add_u32 m0, s52, 129536
s_add_u32 s49, s29, s34
ds_read_b128 v[188:191], v17 offset:2048
v_mfma_f32_16x16x32_bf16 v[124:127], a[168:171], v[144:147], v[124:127]
buffer_load_dwordx4 v2, s[8:11], s36 offen offset:0 lds
v_mfma_f32_16x16x32_bf16 v[128:131], a[172:175], v[144:147], v[128:131]
ds_read_b64_tr_b16 a[208:209], v14 offset:16896
v_mfma_f32_16x16x32_bf16 v[84:87], a[160:163], v[148:151], v[84:87]
ds_read_b64_tr_b16 a[210:211], v14 offset:17152
v_mfma_f32_16x16x32_bf16 v[88:91], a[164:167], v[148:151], v[88:91]
buffer_load_dwordx4 v3, s[8:11], s36 offen offset:1056 lds
ds_read_b64_tr_b16 a[212:213], v14 offset:16928
v_mfma_f32_16x16x32_bf16 v[92:95], a[168:171], v[148:151], v[92:95]
ds_read_b64_tr_b16 a[214:215], v14 offset:17184
v_mfma_f32_16x16x32_bf16 v[96:99], a[172:175], v[148:151], v[96:99]
ds_read_b64_tr_b16 a[216:217], v14 offset:25344
v_mfma_f32_16x16x32_bf16 v[52:55], a[176:179], v[152:155], v[52:55]
buffer_load_dwordx4 v4, s[8:11], s36 offen offset:2112 lds
ds_read_b64_tr_b16 a[218:219], v14 offset:25600
v_mfma_f32_16x16x32_bf16 v[56:59], a[180:183], v[152:155], v[56:59]
ds_read_b64_tr_b16 a[220:221], v14 offset:25376
v_mfma_f32_16x16x32_bf16 v[60:63], a[184:187], v[152:155], v[60:63]
v_mfma_f32_16x16x32_bf16 v[64:67], a[188:191], v[152:155], v[64:67]
ds_read_b64_tr_b16 a[222:223], v14 offset:25632
v_mfma_f32_16x16x32_bf16 v[68:71], a[176:179], v[156:159], v[68:71]
buffer_load_dwordx4 v5, s[8:11], s36 offen offset:3168 lds
ds_read_b128 v[192:195], v18 offset:0
v_mfma_f32_16x16x32_bf16 v[72:75], a[180:183], v[156:159], v[72:75]
ds_read_b128 v[196:199], v18 offset:6144
v_mfma_f32_16x16x32_bf16 v[76:79], a[184:187], v[156:159], v[76:79]
ds_read_b128 v[200:203], v18 offset:1024
v_mfma_f32_16x16x32_bf16 v[80:83], a[188:191], v[156:159], v[80:83]
s_add_u32 m0, s53, 146432
s_add_u32 s33, s33, 589824
ds_read_b128 v[204:207], v18 offset:7168
v_mfma_f32_16x16x32_bf16 v[100:103], a[176:179], v[160:163], v[100:103]
buffer_load_dwordx4 v6, s[4:7], s49 offen offset:0 lds
ds_read_b128 v[208:211], v18 offset:2048
v_mfma_f32_16x16x32_bf16 v[104:107], a[180:183], v[160:163], v[104:107]
v_mfma_f32_16x16x32_bf16 v[108:111], a[184:187], v[160:163], v[108:111]
v_mfma_f32_16x16x32_bf16 v[112:115], a[188:191], v[160:163], v[112:115]
buffer_load_dwordx4 v7, s[4:7], s49 offen offset:1024 lds
v_mfma_f32_16x16x32_bf16 v[116:119], a[176:179], v[164:167], v[116:119]
v_mfma_f32_16x16x32_bf16 v[120:123], a[180:183], v[164:167], v[120:123]
v_mfma_f32_16x16x32_bf16 v[124:127], a[184:187], v[164:167], v[124:127]
buffer_load_dwordx4 v8, s[4:7], s49 offen offset:2048 lds
s_add_u32 s34, s34, 128
v_mfma_f32_16x16x32_bf16 v[128:131], a[188:191], v[164:167], v[128:131]
s_cmp_eq_u32 s34, 1152
s_cselect_b32 s34, 0, s34
s_cselect_b32 s33, 0, s33
v_mfma_f32_16x16x32_bf16 v[84:87], a[176:179], v[168:171], v[84:87]
v_mfma_f32_16x16x32_bf16 v[88:91], a[180:183], v[168:171], v[88:91]
v_mfma_f32_16x16x32_bf16 v[92:95], a[184:187], v[168:171], v[92:95]
v_mfma_f32_16x16x32_bf16 v[96:99], a[188:191], v[168:171], v[96:99]
s_waitcnt lgkmcnt(0)
s_waitcnt vmcnt(11)
s_barrier
v_mfma_f32_16x16x32_bf16 v[52:55], a[192:195], v[172:175], v[52:55]
s_add_u32 s29, s29, 92160
s_cmp_eq_u32 s29, s39
s_cselect_b32 s29, s38, s29
v_mfma_f32_16x16x32_bf16 v[56:59], a[196:199], v[172:175], v[56:59]
s_mul_i32 s40, s56, 36
ds_read_b64_tr_b16 a[224:225], v15 offset:0
ds_read_b64_tr_b16 a[226:227], v15 offset:256
v_mfma_f32_16x16x32_bf16 v[60:63], a[200:203], v[172:175], v[60:63]
ds_read_b64_tr_b16 a[228:229], v15 offset:32
s_mul_i32 s41, s24, 9
v_mfma_f32_16x16x32_bf16 v[64:67], a[204:207], v[172:175], v[64:67]
buffer_load_dword v50, v27, s[88:91], 0 offen sc1
ds_read_b64_tr_b16 a[230:231], v15 offset:288
v_mfma_f32_16x16x32_bf16 v[68:71], a[192:195], v[176:179], v[68:71]
ds_read_b64_tr_b16 a[232:233], v15 offset:8448
s_add_u32 s40, s40, s41
v_mfma_f32_16x16x32_bf16 v[72:75], a[196:199], v[176:179], v[72:75]
ds_read_b64_tr_b16 a[234:235], v15 offset:8704
s_mul_i32 s96, s40, 36864
v_mfma_f32_16x16x32_bf16 v[76:79], a[200:203], v[176:179], v[76:79]
s_add_u32 m0, s54, 0
s_mov_b32 s31, s29
ds_read_b64_tr_b16 a[236:237], v15 offset:8480
v_mfma_f32_16x16x32_bf16 v[80:83], a[204:207], v[176:179], v[80:83]
buffer_load_dwordx4 v9, s[4:7], s31 offen offset:0 lds
v_lshrrev_b32 v28, 4, v0
v_mfma_f32_16x16x32_bf16 v[100:103], a[192:195], v[180:183], v[100:103]
ds_read_b64_tr_b16 a[238:239], v15 offset:8736
v_mul_u32_u24 v28, 4608, v28
v_mfma_f32_16x16x32_bf16 v[104:107], a[196:199], v[180:183], v[104:107]
buffer_load_dwordx4 v10, s[4:7], s31 offen offset:1024 lds
ds_read_b128 v[132:135], v19 offset:0
v_mfma_f32_16x16x32_bf16 v[108:111], a[200:203], v[180:183], v[108:111]
ds_read_b128 v[136:139], v19 offset:6144
v_lshrrev_b32 v29, 1, v0
v_mfma_f32_16x16x32_bf16 v[112:115], a[204:207], v[180:183], v[112:115]
ds_read_b128 v[140:143], v19 offset:1024
v_and_b32 v30, 8, v29
v_mfma_f32_16x16x32_bf16 v[116:119], a[192:195], v[184:187], v[116:119]
s_add_u32 s29, s29, 18432
s_cmp_eq_u32 s29, s39
s_cselect_b32 s29, s38, s29
v_mfma_f32_16x16x32_bf16 v[120:123], a[196:199], v[184:187], v[120:123]
buffer_load_dwordx4 v11, s[4:7], s31 offen offset:2048 lds
ds_read_b128 v[144:147], v19 offset:7168
v_mfma_f32_16x16x32_bf16 v[124:127], a[200:203], v[184:187], v[124:127]
ds_read_b128 v[148:151], v19 offset:2048
s_lshl_b32 s41, s24, 2
v_mfma_f32_16x16x32_bf16 v[128:131], a[204:207], v[184:187], v[128:131]
buffer_load_dwordx4 v12, s[4:7], s31 offen offset:3072 lds
ds_read_b64_tr_b16 a[240:241], v15 offset:16896
v_mfma_f32_16x16x32_bf16 v[84:87], a[192:195], v[188:191], v[84:87]
ds_read_b64_tr_b16 a[242:243], v15 offset:17152
v_xor_b32 v30, s41, v30
v_mfma_f32_16x16x32_bf16 v[88:91], a[196:199], v[188:191], v[88:91]
ds_read_b64_tr_b16 a[244:245], v15 offset:16928
v_xor_b32 v30, v30, v0
v_mfma_f32_16x16x32_bf16 v[92:95], a[200:203], v[188:191], v[92:95]
ds_read_b64_tr_b16 a[246:247], v15 offset:17184
v_and_b32 v30, 15, v30
v_mfma_f32_16x16x32_bf16 v[96:99], a[204:207], v[188:191], v[96:99]
s_add_u32 m0, s54, 4096
ds_read_b64_tr_b16 a[248:249], v15 offset:25344
buffer_load_dwordx4 v13, s[4:7], s31 offen offset:0 lds
v_mfma_f32_16x16x32_bf16 v[52:55], a[208:211], v[192:195], v[52:55]
ds_read_b64_tr_b16 a[250:251], v15 offset:25600
v_lshl_add_u32 v28, v30, 4, v28
v_mfma_f32_16x16x32_bf16 v[56:59], a[212:215], v[192:195], v[56:59]
ds_read_b64_tr_b16 a[252:253], v15 offset:25376
s_lshl_b32 s41, s58, 8
v_mfma_f32_16x16x32_bf16 v[60:63], a[216:219], v[192:195], v[60:63]
s_add_u32 m0, s54, 20480
s_mov_b32 s31, s29
v_add_u32 v3, s41, v28
v_mfma_f32_16x16x32_bf16 v[64:67], a[220:223], v[192:195], v[64:67]
buffer_load_dwordx4 v9, s[4:7], s31 offen offset:0 lds
ds_read_b64_tr_b16 a[254:255], v15 offset:25632
v_mfma_f32_16x16x32_bf16 v[68:71], a[208:211], v[196:199], v[68:71]
ds_read_b128 v[152:155], v20 offset:0
v_add_u32 v4, 96, v3
v_mfma_f32_16x16x32_bf16 v[72:75], a[212:215], v[196:199], v[72:75]
buffer_load_dwordx4 v10, s[4:7], s31 offen offset:1024 lds
ds_read_b128 v[156:159], v20 offset:6144
v_mfma_f32_16x16x32_bf16 v[76:79], a[216:219], v[196:199], v[76:79]
ds_read_b128 v[160:163], v20 offset:1024
v_add_u32 v5, 96, v4
v_mfma_f32_16x16x32_bf16 v[80:83], a[220:223], v[196:199], v[80:83]
ds_read_b128 v[164:167], v20 offset:7168
v_add_u32 v6, 96, v5
v_mfma_f32_16x16x32_bf16 v[100:103], a[208:211], v[200:203], v[100:103]
s_add_u32 s29, s29, 18432
s_cmp_eq_u32 s29, s39
s_cselect_b32 s29, s38, s29
v_mfma_f32_16x16x32_bf16 v[104:107], a[212:215], v[200:203], v[104:107]
buffer_load_dwordx4 v11, s[4:7], s31 offen offset:2048 lds
ds_read_b128 v[168:171], v20 offset:2048
v_mfma_f32_16x16x32_bf16 v[108:111], a[216:219], v[200:203], v[108:111]
v_mul_u32_u24 v29, 1152, v29
v_and_b32 v30, 1, v0
v_mfma_f32_16x16x32_bf16 v[112:115], a[220:223], v[200:203], v[112:115]
buffer_load_dwordx4 v12, s[4:7], s31 offen offset:3072 lds
v_lshl_add_u32 v29, v30, 4, v29
v_mfma_f32_16x16x32_bf16 v[116:119], a[208:211], v[204:207], v[116:119]
s_lshl_b32 s41, s58, 5
s_add_u32 s41, s41, 1536
v_cmp_gt_u32 vcc, 32, v0
v_mfma_f32_16x16x32_bf16 v[120:123], a[212:215], v[204:207], v[120:123]
v_add_u32 v29, s41, v29
v_mov_b32 v30, 2146435072
v_mfma_f32_16x16x32_bf16 v[124:127], a[216:219], v[204:207], v[124:127]
s_add_u32 m0, s54, 24576
s_nop 0
buffer_load_dwordx4 v13, s[4:7], s31 offen offset:0 lds
v_mfma_f32_16x16x32_bf16 v[128:131], a[220:223], v[204:207], v[128:131]
v_cndmask_b32 v216, v30, v29, vcc
s_lshl_b32 s41, s58, 9
v_mfma_f32_16x16x32_bf16 v[84:87], a[208:211], v[208:211], v[84:87]
s_add_u32 s41, s41, 43139072
v_lshl_add_u32 v29, v0, 4, s41
v_cndmask_b32 v2, v30, v29, vcc
v_mfma_f32_16x16x32_bf16 v[88:91], a[212:215], v[208:211], v[88:91]
v_mfma_f32_16x16x32_bf16 v[92:95], a[216:219], v[208:211], v[92:95]
v_mfma_f32_16x16x32_bf16 v[96:99], a[220:223], v[208:211], v[96:99]
s_waitcnt lgkmcnt(0)
s_waitcnt vmcnt(11)
s_barrier
v_mfma_f32_16x16x32_bf16 v[52:55], a[224:227], v[132:135], v[52:55]
s_add_u32 m0, s54, 40960
s_mov_b32 s31, s29
ds_read_b64_tr_b16 v[224:225], v16 offset:0
v_mfma_f32_16x16x32_bf16 v[56:59], a[228:231], v[132:135], v[56:59]
buffer_load_dwordx4 v9, s[4:7], s31 offen offset:0 lds
ds_read_b64_tr_b16 v[226:227], v16 offset:256
v_mfma_f32_16x16x32_bf16 v[60:63], a[232:235], v[132:135], v[60:63]
ds_read_b64_tr_b16 v[228:229], v16 offset:32
s_lshl_b32 s43, s57, 2
v_mfma_f32_16x16x32_bf16 v[64:67], a[236:239], v[132:135], v[64:67]
ds_read_b64_tr_b16 v[230:231], v16 offset:288
s_mov_b32 s44, 841027584
v_mfma_f32_16x16x32_bf16 v[68:71], a[224:227], v[136:139], v[68:71]
ds_read_b64_tr_b16 v[232:233], v16 offset:8448
s_mov_b32 s45, 1716868163
v_mfma_f32_16x16x32_bf16 v[72:75], a[228:231], v[136:139], v[72:75]
ds_read_b64_tr_b16 v[234:235], v16 offset:8704
s_lshr_b64 s[44:45], s[44:45], s43
v_mfma_f32_16x16x32_bf16 v[76:79], a[232:235], v[136:139], v[76:79]
buffer_load_dwordx4 v10, s[4:7], s31 offen offset:1024 lds
ds_read_b64_tr_b16 v[236:237], v16 offset:8480
v_mfma_f32_16x16x32_bf16 v[80:83], a[236:239], v[136:139], v[80:83]
s_and_b32 s44, s44, 7
s_mul_i32 s44, s44, 144
s_add_u32 s44, s44, s40
v_mfma_f32_16x16x32_bf16 v[100:103], a[224:227], v[140:143], v[100:103]
ds_read_b64_tr_b16 v[238:239], v16 offset:8736
s_mov_b32 s46, 857870592
v_mfma_f32_16x16x32_bf16 v[104:107], a[228:231], v[140:143], v[104:107]
ds_read_b128 v[172:175], v21 offset:0
s_mov_b32 s47, 1717916740
v_mfma_f32_16x16x32_bf16 v[108:111], a[232:235], v[140:143], v[108:111]
ds_read_b128 v[176:179], v21 offset:6144
s_lshr_b64 s[46:47], s[46:47], s43
v_mfma_f32_16x16x32_bf16 v[112:115], a[236:239], v[140:143], v[112:115]
ds_read_b128 v[180:183], v21 offset:1024
s_and_b32 s46, s46, 7
v_mfma_f32_16x16x32_bf16 v[116:119], a[224:227], v[144:147], v[116:119]
s_add_u32 s29, s29, 18432
s_cmp_eq_u32 s29, s39
s_cselect_b32 s29, s38, s29
v_mfma_f32_16x16x32_bf16 v[120:123], a[228:231], v[144:147], v[120:123]
buffer_load_dwordx4 v11, s[4:7], s31 offen offset:2048 lds
ds_read_b128 v[184:187], v21 offset:7168
v_mfma_f32_16x16x32_bf16 v[124:127], a[232:235], v[144:147], v[124:127]
ds_read_b128 v[188:191], v21 offset:2048
s_mul_i32 s46, s46, 144
v_mfma_f32_16x16x32_bf16 v[128:131], a[236:239], v[144:147], v[128:131]
ds_read_b64_tr_b16 v[240:241], v16 offset:16896
s_add_u32 s46, s46, s40
v_mfma_f32_16x16x32_bf16 v[84:87], a[224:227], v[148:151], v[84:87]
ds_read_b64_tr_b16 v[242:243], v16 offset:17152
s_sub_u32 s46, s46, 9
v_mfma_f32_16x16x32_bf16 v[88:91], a[228:231], v[148:151], v[88:91]
ds_read_b64_tr_b16 v[244:245], v16 offset:16928
s_lshr_b32 s47, s57, 2
v_mfma_f32_16x16x32_bf16 v[92:95], a[232:235], v[148:151], v[92:95]
ds_read_b64_tr_b16 v[246:247], v16 offset:17184
s_mul_i32 s47, s47, 144
v_mfma_f32_16x16x32_bf16 v[96:99], a[236:239], v[148:151], v[96:99]
buffer_load_dwordx4 v12, s[4:7], s31 offen offset:3072 lds
ds_read_b64_tr_b16 v[248:249], v16 offset:25344
v_mfma_f32_16x16x32_bf16 v[52:55], a[240:243], v[152:155], v[52:55]
ds_read_b64_tr_b16 v[250:251], v16 offset:25600
s_lshl_b32 s45, s58, 2
v_mfma_f32_16x16x32_bf16 v[56:59], a[244:247], v[152:155], v[56:59]
ds_read_b64_tr_b16 v[252:253], v16 offset:25376
s_add_u32 s42, s47, s45
v_mfma_f32_16x16x32_bf16 v[60:63], a[248:251], v[152:155], v[60:63]
s_add_u32 s42, s42, 1086
s_lshl_b32 s45, s58, 5
s_add_u32 s47, s47, s45
v_mfma_f32_16x16x32_bf16 v[64:67], a[252:255], v[152:155], v[64:67]
ds_read_b64_tr_b16 v[254:255], v16 offset:25632
s_add_u32 s47, s47, 990
v_mfma_f32_16x16x32_bf16 v[68:71], a[240:243], v[156:159], v[68:71]
ds_read_b128 v[192:195], v22 offset:0
s_add_u32 s45, s57, 1584
v_mfma_f32_16x16x32_bf16 v[72:75], a[244:247], v[156:159], v[72:75]
s_add_u32 m0, s54, 45056
ds_read_b128 v[196:199], v22 offset:6144
buffer_load_dwordx4 v13, s[4:7], s31 offen offset:0 lds
v_mfma_f32_16x16x32_bf16 v[76:79], a[248:251], v[156:159], v[76:79]
ds_read_b128 v[200:203], v22 offset:1024
v_add_u32 v28, s44, v0
v_mfma_f32_16x16x32_bf16 v[80:83], a[252:255], v[156:159], v[80:83]
ds_read_b128 v[204:207], v22 offset:7168
v_add_u32 v29, s46, v0
v_mfma_f32_16x16x32_bf16 v[100:103], a[240:243], v[160:163], v[100:103]
ds_read_b128 v[208:211], v22 offset:2048
v_cmp_gt_u32 vcc, 9, v0
v_mfma_f32_16x16x32_bf16 v[104:107], a[244:247], v[160:163], v[104:107]
v_add_u32 v30, s47, v0
v_mov_b32 v31, s45
v_mfma_f32_16x16x32_bf16 v[108:111], a[248:251], v[160:163], v[108:111]
v_cndmask_b32 v28, v29, v28, vcc
v_cmp_gt_u32 vcc, 50, v0
v_mfma_f32_16x16x32_bf16 v[112:115], a[252:255], v[160:163], v[112:115]
s_xor_b32 s62, s3, 0
s_lshl_b32 s62, s62, 2
s_add_u32 s62, s62, s24
v_mfma_f32_16x16x32_bf16 v[116:119], a[240:243], v[164:167], v[116:119]
s_mul_i32 s62, s62, 5376
s_mul_i32 s63, s56, 1327104
s_add_u32 s62, s62, s63
v_mfma_f32_16x16x32_bf16 v[120:123], a[244:247], v[164:167], v[120:123]
v_min_u32 v218, 41, v0
v_lshlrev_b32 v218, 7, v218
buffer_load_dword v219, v218, s[64:67], s62 offen offset:512
v_mfma_f32_16x16x32_bf16 v[124:127], a[248:251], v[164:167], v[124:127]
v_add_u32 v29, s42, v0
v_cndmask_b32 v30, v29, v30, vcc
v_mfma_f32_16x16x32_bf16 v[128:131], a[252:255], v[164:167], v[128:131]
v_cmp_gt_u32 vcc, 54, v0
v_mov_b32 v29, 23675008
v_mfma_f32_16x16x32_bf16 v[84:87], a[240:243], v[168:171], v[84:87]
v_cndmask_b32 v30, v31, v30, vcc
v_cmp_gt_u32 vcc, 18, v0
v_mfma_f32_16x16x32_bf16 v[88:91], a[244:247], v[168:171], v[88:91]
s_nop 0
v_cndmask_b32 v28, v30, v28, vcc
v_lshl_add_u32 v7, v28, 5, v29
v_mfma_f32_16x16x32_bf16 v[92:95], a[248:251], v[168:171], v[92:95]
v_bfe_u32 v28, v0, 2, 2
v_mul_u32_u24 v28, 1056, v28
v_mfma_f32_16x16x32_bf16 v[96:99], a[252:255], v[168:171], v[96:99]
v_and_b32 v29, 3, v0
v_lshl_add_u32 v28, v29, 3, v28
v_and_b32 v29, 48, v0
v_lshl_add_u32 v28, v29, 4, v28
v_add_u32 v28, 512, v28
v_lshlrev_b32 v29, 3, v0
v_and_b32 v32, 128, v29
v_add_u32 v30, v28, v32
v_sub_u32 v31, v28, v32
v_add_u32 v14, s95, v30
v_add_u32 v15, s95, v31
v_add_u32 v16, s95, v29
v_add_u32 v17, s54, v30
v_add_u32 v18, s54, v31
v_add_u32 v19, s54, v29
s_waitcnt lgkmcnt(0)
s_waitcnt vmcnt(11)
s_barrier
v_mfma_f32_16x16x32_bf16 v[52:55], v[224:227], v[172:175], v[52:55]
ds_read_b128 v[132:135], v23 offset:0
v_mfma_f32_16x16x32_bf16 v[56:59], v[228:231], v[172:175], v[56:59]
v_mfma_f32_16x16x32_bf16 v[60:63], v[232:235], v[172:175], v[60:63]
v_mfma_f32_16x16x32_bf16 v[64:67], v[236:239], v[172:175], v[64:67]
v_mfma_f32_16x16x32_bf16 v[52:55], v[240:243], v[192:195], v[52:55]
v_mfma_f32_16x16x32_bf16 v[56:59], v[244:247], v[192:195], v[56:59]
ds_read_b128 v[136:139], v24 offset:0
v_mfma_f32_16x16x32_bf16 v[60:63], v[248:251], v[192:195], v[60:63]
v_mfma_f32_16x16x32_bf16 v[64:67], v[252:255], v[192:195], v[64:67]
v_mfma_f32_16x16x32_bf16 v[68:71], v[224:227], v[176:179], v[68:71]
v_mfma_f32_16x16x32_bf16 v[72:75], v[228:231], v[176:179], v[72:75]
v_mfma_f32_16x16x32_bf16 v[76:79], v[232:235], v[176:179], v[76:79]
ds_read_b128 v[140:143], v23 offset:10240
v_mul_f32 v28, v52, v52
v_mfma_f32_16x16x32_bf16 v[80:83], v[236:239], v[176:179], v[80:83]
v_mul_f32 v29, v53, v53
v_fma_f32 v28, v28, s35, v26
v_mfma_f32_16x16x32_bf16 v[68:71], v[240:243], v[196:199], v[68:71]
v_fma_f32 v29, v29, s35, v26
v_mul_f32 v28, v52, v28
v_mfma_f32_16x16x32_bf16 v[72:75], v[244:247], v[196:199], v[72:75]
v_mul_f32 v29, v53, v29
v_mul_f32 v36, v52, v60
v_mfma_f32_16x16x32_bf16 v[76:79], v[248:251], v[196:199], v[76:79]
v_exp_f32 v28, v28
v_mfma_f32_16x16x32_bf16 v[80:83], v[252:255], v[196:199], v[80:83]
ds_read_b128 v[144:147], v24 offset:10240
v_mul_f32 v37, v53, v61
v_mfma_f32_16x16x32_bf16 v[100:103], v[224:227], v[180:183], v[100:103]
v_exp_f32 v29, v29
v_mfma_f32_16x16x32_bf16 v[104:107], v[228:231], v[180:183], v[104:107]
v_add_f32 v28, 1.0, v28
v_add_f32 v29, 1.0, v29
v_mfma_f32_16x16x32_bf16 v[108:111], v[232:235], v[180:183], v[108:111]
v_rcp_f32 v28, v28
v_mfma_f32_16x16x32_bf16 v[112:115], v[236:239], v[180:183], v[112:115]
v_rcp_f32 v29, v29
v_mfma_f32_16x16x32_bf16 v[100:103], v[240:243], v[200:203], v[100:103]
ds_read_b128 v[148:151], v23 offset:1024
v_mul_f32 v36, v36, v28
v_mfma_f32_16x16x32_bf16 v[104:107], v[244:247], v[200:203], v[104:107]
v_mul_f32 v37, v37, v29
v_mul_f32 v30, v54, v54
v_mfma_f32_16x16x32_bf16 v[108:111], v[248:251], v[200:203], v[108:111]
v_mul_f32 v31, v55, v55
v_fma_f32 v30, v30, s35, v26
v_mfma_f32_16x16x32_bf16 v[112:115], v[252:255], v[200:203], v[112:115]
v_fma_f32 v31, v31, s35, v26
v_mul_f32 v30, v54, v30
v_mfma_f32_16x16x32_bf16 v[116:119], v[224:227], v[184:187], v[116:119]
v_mul_f32 v31, v55, v31
v_mul_f32 v38, v54, v62
v_mfma_f32_16x16x32_bf16 v[120:123], v[228:231], v[184:187], v[120:123]
ds_read_b128 v[152:155], v24 offset:1024
v_mul_f32 v39, v55, v63
v_mfma_f32_16x16x32_bf16 v[124:127], v[232:235], v[184:187], v[124:127]
v_exp_f32 v30, v30
v_mfma_f32_16x16x32_bf16 v[128:131], v[236:239], v[184:187], v[128:131]
v_exp_f32 v31, v31
v_mfma_f32_16x16x32_bf16 v[116:119], v[240:243], v[204:207], v[116:119]
v_add_f32 v30, 1.0, v30
v_add_f32 v31, 1.0, v31
v_mfma_f32_16x16x32_bf16 v[120:123], v[244:247], v[204:207], v[120:123]
v_rcp_f32 v30, v30
v_mfma_f32_16x16x32_bf16 v[124:127], v[248:251], v[204:207], v[124:127]
v_rcp_f32 v31, v31
v_mfma_f32_16x16x32_bf16 v[128:131], v[252:255], v[204:207], v[128:131]
v_cvt_pk_bf16_f32 v44, v36, v37
v_mul_f32 v38, v38, v30
v_mfma_f32_16x16x32_bf16 v[84:87], v[224:227], v[188:191], v[84:87]
v_mul_f32 v39, v39, v31
v_mul_f32 v32, v56, v56
v_mfma_f32_16x16x32_bf16 v[88:91], v[228:231], v[188:191], v[88:91]
v_mul_f32 v33, v57, v57
v_fma_f32 v32, v32, s35, v26
v_mfma_f32_16x16x32_bf16 v[92:95], v[232:235], v[188:191], v[92:95]
v_fma_f32 v33, v33, s35, v26
v_mul_f32 v32, v56, v32
v_mfma_f32_16x16x32_bf16 v[96:99], v[236:239], v[188:191], v[96:99]
v_mul_f32 v33, v57, v33
v_mul_f32 v40, v56, v64
v_mfma_f32_16x16x32_bf16 v[84:87], v[240:243], v[208:211], v[84:87]
v_exp_f32 v32, v32
v_mfma_f32_16x16x32_bf16 v[88:91], v[244:247], v[208:211], v[88:91]
v_exp_f32 v33, v33
v_mfma_f32_16x16x32_bf16 v[92:95], v[248:251], v[208:211], v[92:95]
v_mul_f32 v41, v57, v65
v_add_f32 v32, 1.0, v32
v_mfma_f32_16x16x32_bf16 v[96:99], v[252:255], v[208:211], v[96:99]
v_add_f32 v33, 1.0, v33
v_cvt_pk_bf16_f32 v45, v38, v39
v_rcp_f32 v32, v32
v_rcp_f32 v33, v33
v_mul_f32 v40, v40, v32
v_mul_f32 v41, v41, v33
v_mul_f32 v34, v58, v58
v_mul_f32 v35, v59, v59
v_fma_f32 v34, v34, s35, v26
v_fma_f32 v35, v35, s35, v26
v_mul_f32 v34, v58, v34
v_mul_f32 v35, v59, v35
v_exp_f32 v34, v34
v_exp_f32 v35, v35
v_mul_f32 v42, v58, v66
v_mul_f32 v43, v59, v67
v_add_f32 v34, 1.0, v34
v_add_f32 v35, 1.0, v35
v_rcp_f32 v34, v34
v_rcp_f32 v35, v35
v_cvt_pk_bf16_f32 v46, v40, v41
v_mul_f32 v42, v42, v34
v_mul_f32 v43, v43, v35
v_cvt_pk_bf16_f32 v47, v42, v43
buffer_store_dwordx4 v[44:47], v25, s[12:15], s32 offen sc1
s_add_u32 s32, s32, 147456
s_cmp_eq_u32 s32, s61
s_cselect_b32 s32, s59, s32
v_cmp_eq_u32 vcc, 0, v50
s_and_b64 vcc, vcc, 1
s_cbranch_vccz A_n0_x
s_mov_b32 s62, 0
A_n0_p:
buffer_load_dword v50, v27, s[88:91], 0 offen sc1
s_add_u32 s62, s62, 1
s_cmp_gt_u32 s62, 200000
s_cbranch_scc1 A_n0_x
s_waitcnt vmcnt(0)
v_cmp_eq_u32 vcc, 0, v50
s_and_b64 vcc, vcc, 1
s_cbranch_vccnz A_n0_p
A_n0_x:
v_readfirstlane_b32 s92, v50
s_and_b32 s92, s92, -16
v_pk_mul_f32 v[28:29], v[68:69], v[68:69]
v_pk_mul_f32 v[30:31], v[70:71], v[70:71]
v_pk_mul_f32 v[32:33], v[72:73], v[72:73]
v_pk_mul_f32 v[34:35], v[74:75], v[74:75]
v_pk_fma_f32 v[28:29], v[28:29], s[34:35], v[26:27] op_sel:[0,1,0] op_sel_hi:[1,1,0]
v_pk_fma_f32 v[30:31], v[30:31], s[34:35], v[26:27] op_sel:[0,1,0] op_sel_hi:[1,1,0]
v_pk_fma_f32 v[32:33], v[32:33], s[34:35], v[26:27] op_sel:[0,1,0] op_sel_hi:[1,1,0]
v_pk_fma_f32 v[34:35], v[34:35], s[34:35], v[26:27] op_sel:[0,1,0] op_sel_hi:[1,1,0]
v_pk_mul_f32 v[28:29], v[68:69], v[28:29]
v_pk_mul_f32 v[30:31], v[70:71], v[30:31]
v_pk_mul_f32 v[32:33], v[72:73], v[32:33]
v_pk_mul_f32 v[34:35], v[74:75], v[34:35]
v_exp_f32 v28, v28
v_exp_f32 v29, v29
v_exp_f32 v30, v30
v_exp_f32 v31, v31
v_exp_f32 v32, v32
v_exp_f32 v33, v33
v_exp_f32 v34, v34
v_exp_f32 v35, v35
v_pk_mul_f32 v[36:37], v[68:69], v[76:77]
v_pk_mul_f32 v[38:39], v[70:71], v[78:79]
v_pk_mul_f32 v[40:41], v[72:73], v[80:81]
v_pk_mul_f32 v[42:43], v[74:75], v[82:83]
v_pk_add_f32 v[28:29], v[28:29], 1.0 op_sel_hi:[1,0]
v_pk_add_f32 v[30:31], v[30:31], 1.0 op_sel_hi:[1,0]
v_pk_add_f32 v[32:33], v[32:33], 1.0 op_sel_hi:[1,0]
v_pk_add_f32 v[34:35], v[34:35], 1.0 op_sel_hi:[1,0]
v_rcp_f32 v28, v28
v_rcp_f32 v29, v29
v_rcp_f32 v30, v30
v_rcp_f32 v31, v31
v_rcp_f32 v32, v32
v_rcp_f32 v33, v33
v_rcp_f32 v34, v34
v_rcp_f32 v35, v35
s_nop 0
v_pk_mul_f32 v[36:37], v[36:37], v[28:29]
v_pk_mul_f32 v[38:39], v[38:39], v[30:31]
v_pk_mul_f32 v[40:41], v[40:41], v[32:33]
v_pk_mul_f32 v[42:43], v[42:43], v[34:35]
v_cvt_pk_bf16_f32 v48, v36, v37
v_cvt_pk_bf16_f32 v49, v38, v39
v_cvt_pk_bf16_f32 v50, v40, v41
v_cvt_pk_bf16_f32 v51, v42, v43
buffer_store_dwordx4 v[48:51], v25, s[12:15], s32 offen sc1
s_add_u32 s32, s32, 147456
s_cmp_eq_u32 s32, s61
s_cselect_b32 s32, s59, s32
v_pk_mul_f32 v[28:29], v[100:101], v[100:101]
v_pk_mul_f32 v[30:31], v[102:103], v[102:103]
v_pk_mul_f32 v[32:33], v[104:105], v[104:105]
v_pk_mul_f32 v[34:35], v[106:107], v[106:107]
v_pk_fma_f32 v[28:29], v[28:29], s[34:35], v[26:27] op_sel:[0,1,0] op_sel_hi:[1,1,0]
v_pk_fma_f32 v[30:31], v[30:31], s[34:35], v[26:27] op_sel:[0,1,0] op_sel_hi:[1,1,0]
v_pk_fma_f32 v[32:33], v[32:33], s[34:35], v[26:27] op_sel:[0,1,0] op_sel_hi:[1,1,0]
v_pk_fma_f32 v[34:35], v[34:35], s[34:35], v[26:27] op_sel:[0,1,0] op_sel_hi:[1,1,0]
v_pk_mul_f32 v[28:29], v[100:101], v[28:29]
v_pk_mul_f32 v[30:31], v[102:103], v[30:31]
v_pk_mul_f32 v[32:33], v[104:105], v[32:33]
v_pk_mul_f32 v[34:35], v[106:107], v[34:35]
v_exp_f32 v28, v28
v_exp_f32 v29, v29
v_exp_f32 v30, v30
v_exp_f32 v31, v31
v_exp_f32 v32, v32
v_exp_f32 v33, v33
v_exp_f32 v34, v34
v_exp_f32 v35, v35
v_pk_mul_f32 v[36:37], v[100:101], v[108:109]
v_pk_mul_f32 v[38:39], v[102:103], v[110:111]
v_pk_mul_f32 v[40:41], v[104:105], v[112:113]
v_pk_mul_f32 v[42:43], v[106:107], v[114:115]
v_pk_add_f32 v[28:29], v[28:29], 1.0 op_sel_hi:[1,0]
v_pk_add_f32 v[30:31], v[30:31], 1.0 op_sel_hi:[1,0]
v_pk_add_f32 v[32:33], v[32:33], 1.0 op_sel_hi:[1,0]
v_pk_add_f32 v[34:35], v[34:35], 1.0 op_sel_hi:[1,0]
v_rcp_f32 v28, v28
v_rcp_f32 v29, v29
v_rcp_f32 v30, v30
v_rcp_f32 v31, v31
v_rcp_f32 v32, v32
v_rcp_f32 v33, v33
v_rcp_f32 v34, v34
v_rcp_f32 v35, v35
s_nop 0
v_pk_mul_f32 v[36:37], v[36:37], v[28:29]
v_pk_mul_f32 v[38:39], v[38:39], v[30:31]
v_pk_mul_f32 v[40:41], v[40:41], v[32:33]
v_pk_mul_f32 v[42:43], v[42:43], v[34:35]
v_cvt_pk_bf16_f32 v44, v36, v37
v_cvt_pk_bf16_f32 v45, v38, v39
v_cvt_pk_bf16_f32 v46, v40, v41
v_cvt_pk_bf16_f32 v47, v42, v43
buffer_store_dwordx4 v[44:47], v25, s[12:15], s32 offen sc1
s_add_u32 s32, s32, 147456
s_cmp_eq_u32 s32, s61
s_cselect_b32 s32, s59, s32
v_pk_mul_f32 v[28:29], v[116:117], v[116:117]
v_pk_mul_f32 v[30:31], v[118:119], v[118:119]
v_pk_mul_f32 v[32:33], v[120:121], v[120:121]
v_pk_mul_f32 v[34:35], v[122:123], v[122:123]
v_pk_fma_f32 v[28:29], v[28:29], s[34:35], v[26:27] op_sel:[0,1,0] op_sel_hi:[1,1,0]
v_pk_fma_f32 v[30:31], v[30:31], s[34:35], v[26:27] op_sel:[0,1,0] op_sel_hi:[1,1,0]
v_pk_fma_f32 v[32:33], v[32:33], s[34:35], v[26:27] op_sel:[0,1,0] op_sel_hi:[1,1,0]
v_pk_fma_f32 v[34:35], v[34:35], s[34:35], v[26:27] op_sel:[0,1,0] op_sel_hi:[1,1,0]
v_pk_mul_f32 v[28:29], v[116:117], v[28:29]
v_pk_mul_f32 v[30:31], v[118:119], v[30:31]
v_pk_mul_f32 v[32:33], v[120:121], v[32:33]
v_pk_mul_f32 v[34:35], v[122:123], v[34:35]
v_exp_f32 v28, v28
v_exp_f32 v29, v29
v_exp_f32 v30, v30
v_exp_f32 v31, v31
v_exp_f32 v32, v32
v_exp_f32 v33, v33
v_exp_f32 v34, v34
v_exp_f32 v35, v35
v_pk_mul_f32 v[36:37], v[116:117], v[124:125]
v_pk_mul_f32 v[38:39], v[118:119], v[126:127]
v_pk_mul_f32 v[40:41], v[120:121], v[128:129]
v_pk_mul_f32 v[42:43], v[122:123], v[130:131]
v_pk_add_f32 v[28:29], v[28:29], 1.0 op_sel_hi:[1,0]
v_pk_add_f32 v[30:31], v[30:31], 1.0 op_sel_hi:[1,0]
v_pk_add_f32 v[32:33], v[32:33], 1.0 op_sel_hi:[1,0]
v_pk_add_f32 v[34:35], v[34:35], 1.0 op_sel_hi:[1,0]
v_rcp_f32 v28, v28
v_rcp_f32 v29, v29
v_rcp_f32 v30, v30
v_rcp_f32 v31, v31
v_rcp_f32 v32, v32
v_rcp_f32 v33, v33
v_rcp_f32 v34, v34
v_rcp_f32 v35, v35
s_nop 0
v_pk_mul_f32 v[36:37], v[36:37], v[28:29]
v_pk_mul_f32 v[38:39], v[38:39], v[30:31]
v_pk_mul_f32 v[40:41], v[40:41], v[32:33]
v_pk_mul_f32 v[42:43], v[42:43], v[34:35]
v_cvt_pk_bf16_f32 v48, v36, v37
v_cvt_pk_bf16_f32 v49, v38, v39
v_cvt_pk_bf16_f32 v50, v40, v41
v_cvt_pk_bf16_f32 v51, v42, v43
buffer_store_dwordx4 v[48:51], v25, s[12:15], s32 offen sc1
s_add_u32 s32, s32, 147456
s_cmp_eq_u32 s32, s61
s_cselect_b32 s32, s59, s32
v_mov_b32 v48, s92
v_add_u32 v217, 512, v3
s_movk_i32 s23, 1056
s_movk_i32 s34, 1152
s_mov_b32 s48, 2146435072
s_mov_b64 s[52:53], 0
v_lshlrev_b32 v220, 5, v0
s_add_u32 s41, s95, 15360
s_add_u32 s20, s95, 15872
s_mov_b32 s44, 2146435072
s_add_u32 s42, s95, 20480
s_add_u32 s21, s95, 20992
s_mov_b32 s45, 2146435072
s_add_u32 s43, s95, 0
s_add_u32 s22, s95, 512
s_add_u32 s46, s96, 0
s_cmp_ge_u32 s26, 4
s_cbranch_scc1 A_e4
s_and_b32 s50, s27, 15
s_lshl_b32 s50, s50, 2
s_add_u32 s50, s50, s24
s_lshr_b32 s51, s27, 4
s_lshl_b32 s60, s51, 7
s_mul_i32 s44, s50, 36864
s_add_u32 s44, s44, s60
s_mov_b32 s45, s44
s_cmp_eq_u32 s50, 0
s_cselect_b32 s63, 64, 40
v_and_b32 v28, 7, v0
v_lshrrev_b32 v29, 3, v0
v_mul_u32_u24 v29, 1152, v29
v_lshl_add_u32 v215, v28, 4, v29
v_cmp_gt_u32 vcc, s63, v0
v_mov_b32 v214, 2146435072
v_add_u32 v213, 9216, v215
v_cndmask_b32 v212, v215, v214, vcc
s_lshl_b32 s40, s51, 9
v_lshlrev_b32 v28, 3, v0
buffer_load_dwordx2 v[100:101], v28, s[80:83], s40 offen
s_add_u32 s20, s41, 1024
s_add_u32 s21, s42, 1024
s_movk_i32 s33, 1024
s_movk_i32 s36, 9216
A_l0:
A_loop:
s_waitcnt lgkmcnt(4)
v_mfma_f32_16x16x32_bf16 v[52:55], a[0:3], v[132:135], 0
ds_read_b128 v[156:159], v23 offset:11264
v_mfma_f32_16x16x32_bf16 v[56:59], a[4:7], v[132:135], 0
v_mfma_f32_16x16x32_bf16 v[60:63], a[8:11], v[132:135], 0
v_mul_f32 v28, v84, v84
v_mul_f32 v29, v85, v85
v_mfma_f32_16x16x32_bf16 v[64:67], a[12:15], v[132:135], 0
v_fma_f32 v28, v28, s35, v26
v_fma_f32 v29, v29, s35, v26
v_mfma_f32_16x16x32_bf16 v[52:55], a[16:19], v[136:139], v[52:55]
ds_read_b128 v[160:163], v24 offset:11264
s_mov_b32 m0, s41
v_mfma_f32_16x16x32_bf16 v[56:59], a[20:23], v[136:139], v[56:59]
s_mov_b32 s97, s44
buffer_load_dwordx4 v212, s[72:75], s97 offen sc1 lds
v_mfma_f32_16x16x32_bf16 v[60:63], a[24:27], v[136:139], v[60:63]
v_mul_f32 v28, v84, v28
v_mul_f32 v29, v85, v29
v_mfma_f32_16x16x32_bf16 v[64:67], a[28:31], v[136:139], v[64:67]
s_waitcnt lgkmcnt(4)
v_exp_f32 v28, v28
v_mfma_f32_16x16x32_bf16 v[52:55], a[32:35], v[140:143], v[52:55]
ds_read_b128 v[164:167], v23 offset:2048
v_mul_f32 v36, v84, v92
v_mfma_f32_16x16x32_bf16 v[56:59], a[36:39], v[140:143], v[56:59]
v_exp_f32 v29, v29
v_mfma_f32_16x16x32_bf16 v[60:63], a[40:43], v[140:143], v[60:63]
v_mul_f32 v37, v85, v93
v_add_f32 v28, 1.0, v28
v_mfma_f32_16x16x32_bf16 v[64:67], a[44:47], v[140:143], v[64:67]
v_add_f32 v29, 1.0, v29
v_mul_f32 v30, v86, v86
v_mfma_f32_16x16x32_bf16 v[52:55], a[48:51], v[144:147], v[52:55]
ds_read_b128 v[132:135], v24 offset:2048
v_mul_f32 v31, v87, v87
v_mfma_f32_16x16x32_bf16 v[56:59], a[52:55], v[144:147], v[56:59]
v_rcp_f32 v28, v28
v_mfma_f32_16x16x32_bf16 v[60:63], a[56:59], v[144:147], v[60:63]
s_mov_b32 m0, s20
s_nop 0
buffer_load_dwordx4 v213, s[72:75], s97 offen sc1 lds
v_mfma_f32_16x16x32_bf16 v[64:67], a[60:63], v[144:147], v[64:67]
s_waitcnt lgkmcnt(4)
v_rcp_f32 v29, v29
v_mfma_f32_16x16x32_bf16 v[52:55], a[64:67], v[148:151], v[52:55]
ds_read_b128 v[136:139], v23 offset:12288
v_mul_f32 v36, v36, v28
v_mfma_f32_16x16x32_bf16 v[56:59], a[68:71], v[148:151], v[56:59]
v_mul_f32 v37, v37, v29
v_fma_f32 v30, v30, s35, v26
v_mfma_f32_16x16x32_bf16 v[60:63], a[72:75], v[148:151], v[60:63]
v_fma_f32 v31, v31, s35, v26
v_mul_f32 v30, v86, v30
v_mfma_f32_16x16x32_bf16 v[64:67], a[76:79], v[148:151], v[64:67]
v_mul_f32 v31, v87, v31
v_mul_f32 v38, v86, v94
v_mfma_f32_16x16x32_bf16 v[52:55], a[80:83], v[152:155], v[52:55]
ds_read_b128 v[140:143], v24 offset:12288
v_mul_f32 v39, v87, v95
v_mfma_f32_16x16x32_bf16 v[56:59], a[84:87], v[152:155], v[56:59]
v_exp_f32 v30, v30
v_mfma_f32_16x16x32_bf16 v[60:63], a[88:91], v[152:155], v[60:63]
v_exp_f32 v31, v31
v_mfma_f32_16x16x32_bf16 v[64:67], a[92:95], v[152:155], v[64:67]
s_waitcnt lgkmcnt(4)
v_add_f32 v30, 1.0, v30
v_add_f32 v31, 1.0, v31
v_mfma_f32_16x16x32_bf16 v[52:55], a[96:99], v[156:159], v[52:55]
ds_read_b128 v[144:147], v23 offset:3072
s_add_u32 m0, m0, s33
v_mfma_f32_16x16x32_bf16 v[56:59], a[100:103], v[156:159], v[56:59]
s_add_u32 s97, s97, s36
buffer_load_dwordx4 v213, s[72:75], s97 offen sc1 lds
v_mfma_f32_16x16x32_bf16 v[60:63], a[104:107], v[156:159], v[60:63]
v_rcp_f32 v30, v30
v_mfma_f32_16x16x32_bf16 v[64:67], a[108:111], v[156:159], v[64:67]
v_rcp_f32 v31, v31
v_mfma_f32_16x16x32_bf16 v[52:55], a[112:115], v[160:163], v[52:55]
ds_read_b128 v[148:151], v24 offset:3072
v_cvt_pk_bf16_f32 v44, v36, v37
v_mfma_f32_16x16x32_bf16 v[56:59], a[116:119], v[160:163], v[56:59]
v_mul_f32 v38, v38, v30
v_mul_f32 v39, v39, v31
v_mfma_f32_16x16x32_bf16 v[60:63], a[120:123], v[160:163], v[60:63]
v_mul_f32 v32, v88, v88
v_mul_f32 v33, v89, v89
v_mfma_f32_16x16x32_bf16 v[64:67], a[124:127], v[160:163], v[64:67]
s_waitcnt lgkmcnt(4)
v_fma_f32 v32, v32, s35, v26
v_fma_f32 v33, v33, s35, v26
v_mfma_f32_16x16x32_bf16 v[52:55], a[128:131], v[164:167], v[52:55]
ds_read_b128 v[152:155], v23 offset:13312
v_mul_f32 v32, v88, v32
v_mfma_f32_16x16x32_bf16 v[56:59], a[132:135], v[164:167], v[56:59]
v_mul_f32 v33, v89, v33
v_mul_f32 v40, v88, v96
v_mfma_f32_16x16x32_bf16 v[60:63], a[136:139], v[164:167], v[60:63]
s_add_u32 m0, m0, s33
s_add_u32 s97, s97, s36
v_mul_f32 v41, v89, v97
v_mfma_f32_16x16x32_bf16 v[64:67], a[140:143], v[164:167], v[64:67]
buffer_load_dwordx4 v213, s[72:75], s97 offen sc1 lds
v_cvt_pk_bf16_f32 v45, v38, v39
v_mfma_f32_16x16x32_bf16 v[52:55], a[144:147], v[132:135], v[52:55]
ds_read_b128 v[156:159], v24 offset:13312
v_mfma_f32_16x16x32_bf16 v[56:59], a[148:151], v[132:135], v[56:59]
v_exp_f32 v32, v32
v_mfma_f32_16x16x32_bf16 v[60:63], a[152:155], v[132:135], v[60:63]
v_exp_f32 v33, v33
v_mfma_f32_16x16x32_bf16 v[64:67], a[156:159], v[132:135], v[64:67]
s_waitcnt lgkmcnt(4)
v_add_f32 v32, 1.0, v32
v_add_f32 v33, 1.0, v33
v_mfma_f32_16x16x32_bf16 v[52:55], a[160:163], v[136:139], v[52:55]
ds_read_b128 v[160:163], v23 offset:4096
v_mul_f32 v34, v90, v90
v_mfma_f32_16x16x32_bf16 v[56:59], a[164:167], v[136:139], v[56:59]
v_rcp_f32 v32, v32
v_mfma_f32_16x16x32_bf16 v[60:63], a[168:171], v[136:139], v[60:63]
v_rcp_f32 v33, v33
v_mfma_f32_16x16x32_bf16 v[64:67], a[172:175], v[136:139], v[64:67]
v_mul_f32 v40, v40, v32
v_mul_f32 v41, v41, v33
v_mfma_f32_16x16x32_bf16 v[52:55], a[176:179], v[140:143], v[52:55]
ds_read_b128 v[164:167], v24 offset:4096
s_add_u32 m0, m0, s33
v_mfma_f32_16x16x32_bf16 v[56:59], a[180:183], v[140:143], v[56:59]
s_add_u32 s97, s97, s36
buffer_load_dwordx4 v213, s[72:75], s97 offen sc1 lds
v_mfma_f32_16x16x32_bf16 v[60:63], a[184:187], v[140:143], v[60:63]
v_mul_f32 v35, v91, v91
v_fma_f32 v34, v34, s35, v26
v_mfma_f32_16x16x32_bf16 v[64:67], a[188:191], v[140:143], v[64:67]
s_waitcnt lgkmcnt(4)
v_fma_f32 v35, v35, s35, v26
v_mul_f32 v34, v90, v34
v_mfma_f32_16x16x32_bf16 v[52:55], a[192:195], v[144:147], v[52:55]
v_mul_f32 v35, v91, v35
v_mul_f32 v42, v90, v98
v_mfma_f32_16x16x32_bf16 v[56:59], a[196:199], v[144:147], v[56:59]
v_exp_f32 v34, v34
v_mfma_f32_16x16x32_bf16 v[60:63], a[200:203], v[144:147], v[60:63]
v_exp_f32 v35, v35
v_mfma_f32_16x16x32_bf16 v[64:67], a[204:207], v[144:147], v[64:67]
v_mul_f32 v43, v91, v99
v_add_f32 v34, 1.0, v34
v_mfma_f32_16x16x32_bf16 v[52:55], a[208:211], v[148:151], v[52:55]
v_add_f32 v35, 1.0, v35
v_cvt_pk_bf16_f32 v46, v40, v41
v_mfma_f32_16x16x32_bf16 v[56:59], a[212:215], v[148:151], v[56:59]
v_rcp_f32 v34, v34
v_mfma_f32_16x16x32_bf16 v[60:63], a[216:219], v[148:151], v[60:63]
s_waitcnt vmcnt(15) lgkmcnt(0)
s_barrier
v_mfma_f32_16x16x32_bf16 v[64:67], a[220:223], v[148:151], v[64:67]
v_rcp_f32 v35, v35
v_mfma_f32_16x16x32_bf16 v[52:55], a[224:227], v[152:155], v[52:55]
ds_read_b128 v[132:135], v23 offset:20480
v_mul_f32 v42, v42, v34
v_mfma_f32_16x16x32_bf16 v[56:59], a[228:231], v[152:155], v[56:59]
s_add_u32 m0, s54, 0
s_mov_b32 s31, s29
v_mul_f32 v43, v43, v35
v_mfma_f32_16x16x32_bf16 v[60:63], a[232:235], v[152:155], v[60:63]
ds_read_b128 v[136:139], v24 offset:20480
buffer_load_dwordx4 v9, s[4:7], s31 offen offset:0 lds
v_mfma_f32_16x16x32_bf16 v[64:67], a[236:239], v[152:155], v[64:67]
v_cvt_pk_bf16_f32 v47, v42, v43
v_mfma_f32_16x16x32_bf16 v[52:55], a[240:243], v[156:159], v[52:55]
buffer_store_dwordx4 v[44:47], v25, s[12:15], s32 offen sc1
ds_read_b128 v[140:143], v23 offset:30720
s_add_u32 s32, s32, 147456
v_mfma_f32_16x16x32_bf16 v[56:59], a[244:247], v[156:159], v[56:59]
s_cmp_eq_u32 s32, s61
s_cselect_b32 s32, s59, s32
v_mfma_f32_16x16x32_bf16 v[60:63], a[248:251], v[156:159], v[60:63]
ds_read_b128 v[144:147], v24 offset:30720
v_mfma_f32_16x16x32_bf16 v[64:67], a[252:255], v[156:159], v[64:67]
v_mfma_f32_16x16x32_bf16 v[52:55], v[224:227], v[160:163], v[52:55]
ds_read_b128 v[148:151], v23 offset:21504
buffer_load_dwordx4 v10, s[4:7], s31 offen offset:1024 lds
v_mfma_f32_16x16x32_bf16 v[56:59], v[228:231], v[160:163], v[56:59]
v_mfma_f32_16x16x32_bf16 v[60:63], v[232:235], v[160:163], v[60:63]
ds_read_b128 v[152:155], v24 offset:21504
v_mfma_f32_16x16x32_bf16 v[64:67], v[236:239], v[160:163], v[64:67]
v_mfma_f32_16x16x32_bf16 v[52:55], v[240:243], v[164:167], v[52:55]
v_mfma_f32_16x16x32_bf16 v[56:59], v[244:247], v[164:167], v[56:59]
v_mfma_f32_16x16x32_bf16 v[60:63], v[248:251], v[164:167], v[60:63]
v_add_u32 v49, 8, v48
v_mfma_f32_16x16x32_bf16 v[64:67], v[252:255], v[164:167], v[64:67]
s_waitcnt lgkmcnt(4)
s_add_u32 s29, s29, 18432
s_cmp_eq_u32 s29, s39
v_mfma_f32_16x16x32_bf16 v[68:71], a[0:3], v[132:135], 0
ds_read_b128 v[156:159], v23 offset:31744
s_cselect_b32 s29, s38, s29
v_mfma_f32_16x16x32_bf16 v[72:75], a[4:7], v[132:135], 0
s_waitcnt vmcnt(8)
buffer_store_dword v49, v27, s[12:15], s37 offen sc1
buffer_load_dwordx4 v11, s[4:7], s31 offen offset:2048 lds
v_mfma_f32_16x16x32_bf16 v[76:79], a[8:11], v[132:135], 0
s_mov_b32 s37, 2146435072
v_mul_f32 v28, v52, v52
v_mul_f32 v29, v53, v53
v_mfma_f32_16x16x32_bf16 v[80:83], a[12:15], v[132:135], 0
v_fma_f32 v28, v28, s35, v26
v_fma_f32 v29, v29, s35, v26
v_mfma_f32_16x16x32_bf16 v[68:71], a[16:19], v[136:139], v[68:71]
ds_read_b128 v[160:163], v24 offset:31744
v_mul_f32 v28, v52, v28
v_mfma_f32_16x16x32_bf16 v[72:75], a[20:23], v[136:139], v[72:75]
v_mul_f32 v29, v53, v29
v_mul_f32 v36, v52, v60
v_mfma_f32_16x16x32_bf16 v[76:79], a[24:27], v[136:139], v[76:79]
buffer_load_dwordx4 v12, s[4:7], s31 offen offset:3072 lds
v_mul_f32 v37, v53, v61
v_mfma_f32_16x16x32_bf16 v[80:83], a[28:31], v[136:139], v[80:83]
s_waitcnt lgkmcnt(4)
v_exp_f32 v28, v28
v_mfma_f32_16x16x32_bf16 v[68:71], a[32:35], v[140:143], v[68:71]
ds_read_b128 v[164:167], v23 offset:22528
v_add_f32 v28, 1.0, v28
v_mfma_f32_16x16x32_bf16 v[72:75], a[36:39], v[140:143], v[72:75]
v_exp_f32 v29, v29
v_mfma_f32_16x16x32_bf16 v[76:79], a[40:43], v[140:143], v[76:79]
v_add_f32 v29, 1.0, v29
v_mul_f32 v30, v54, v54
v_mfma_f32_16x16x32_bf16 v[80:83], a[44:47], v[140:143], v[80:83]
v_rcp_f32 v28, v28
v_mfma_f32_16x16x32_bf16 v[68:71], a[48:51], v[144:147], v[68:71]
ds_read_b128 v[132:135], v24 offset:22528
v_mul_f32 v36, v36, v28
v_mfma_f32_16x16x32_bf16 v[72:75], a[52:55], v[144:147], v[72:75]
s_add_u32 m0, s54, 4096
s_nop 0
buffer_load_dwordx4 v13, s[4:7], s31 offen offset:0 lds
v_mfma_f32_16x16x32_bf16 v[76:79], a[56:59], v[144:147], v[76:79]
v_rcp_f32 v29, v29
v_mfma_f32_16x16x32_bf16 v[80:83], a[60:63], v[144:147], v[80:83]
s_waitcnt lgkmcnt(4)
v_mul_f32 v37, v37, v29
v_mul_f32 v31, v55, v55
v_mfma_f32_16x16x32_bf16 v[68:71], a[64:67], v[148:151], v[68:71]
ds_read_b128 v[136:139], v23 offset:32768
v_fma_f32 v30, v30, s35, v26
v_mfma_f32_16x16x32_bf16 v[72:75], a[68:71], v[148:151], v[72:75]
v_fma_f32 v31, v31, s35, v26
v_mul_f32 v30, v54, v30
v_mfma_f32_16x16x32_bf16 v[76:79], a[72:75], v[148:151], v[76:79]
v_mul_f32 v31, v55, v31
v_mul_f32 v38, v54, v62
v_mfma_f32_16x16x32_bf16 v[80:83], a[76:79], v[148:151], v[80:83]
v_exp_f32 v30, v30
v_mfma_f32_16x16x32_bf16 v[68:71], a[80:83], v[152:155], v[68:71]
ds_read_b128 v[140:143], v24 offset:32768
v_mul_f32 v39, v55, v63
v_mfma_f32_16x16x32_bf16 v[72:75], a[84:87], v[152:155], v[72:75]
v_exp_f32 v31, v31
v_mfma_f32_16x16x32_bf16 v[76:79], a[88:91], v[152:155], v[76:79]
buffer_load_dword v221, v220, s[12:15], s48 offen sc1
v_add_f32 v30, 1.0, v30
v_mfma_f32_16x16x32_bf16 v[80:83], a[92:95], v[152:155], v[80:83]
s_waitcnt lgkmcnt(4)
v_add_f32 v31, 1.0, v31
v_cvt_pk_bf16_f32 v44, v36, v37
v_mfma_f32_16x16x32_bf16 v[68:71], a[96:99], v[156:159], v[68:71]
ds_read_b128 v[144:147], v23 offset:23552
s_mov_b32 m0, s42
v_mfma_f32_16x16x32_bf16 v[72:75], a[100:103], v[156:159], v[72:75]
s_mov_b32 s97, s45
buffer_load_dwordx4 v214, s[76:79], s97 offen sc1 lds
v_mfma_f32_16x16x32_bf16 v[76:79], a[104:107], v[156:159], v[76:79]
v_rcp_f32 v30, v30
v_mfma_f32_16x16x32_bf16 v[80:83], a[108:111], v[156:159], v[80:83]
v_rcp_f32 v31, v31
v_mfma_f32_16x16x32_bf16 v[68:71], a[112:115], v[160:163], v[68:71]
ds_read_b128 v[148:151], v24 offset:23552
v_mul_f32 v38, v38, v30
v_mfma_f32_16x16x32_bf16 v[72:75], a[116:119], v[160:163], v[72:75]
v_mul_f32 v39, v39, v31
v_mul_f32 v32, v56, v56
v_mfma_f32_16x16x32_bf16 v[76:79], a[120:123], v[160:163], v[76:79]
s_mov_b32 m0, s21
s_nop 0
buffer_load_dwordx4 v215, s[76:79], s97 offen sc1 lds
v_mfma_f32_16x16x32_bf16 v[80:83], a[124:127], v[160:163], v[80:83]
s_waitcnt lgkmcnt(4)
v_mul_f32 v33, v57, v57
v_fma_f32 v32, v32, s35, v26
v_mfma_f32_16x16x32_bf16 v[68:71], a[128:131], v[164:167], v[68:71]
ds_read_b128 v[152:155], v23 offset:33792
v_fma_f32 v33, v33, s35, v26
v_mfma_f32_16x16x32_bf16 v[72:75], a[132:135], v[164:167], v[72:75]
v_mul_f32 v32, v56, v32
v_mul_f32 v33, v57, v33
v_mfma_f32_16x16x32_bf16 v[76:79], a[136:139], v[164:167], v[76:79]
v_exp_f32 v32, v32
v_mfma_f32_16x16x32_bf16 v[80:83], a[140:143], v[164:167], v[80:83]
v_exp_f32 v33, v33
v_mfma_f32_16x16x32_bf16 v[68:71], a[144:147], v[132:135], v[68:71]
ds_read_b128 v[156:159], v24 offset:33792
s_add_u32 m0, m0, s33
v_mfma_f32_16x16x32_bf16 v[72:75], a[148:151], v[132:135], v[72:75]
s_add_u32 s97, s97, s36
buffer_load_dwordx4 v215, s[76:79], s97 offen sc1 lds
v_mfma_f32_16x16x32_bf16 v[76:79], a[152:155], v[132:135], v[76:79]
v_mul_f32 v40, v56, v64
v_mul_f32 v41, v57, v65
v_mfma_f32_16x16x32_bf16 v[80:83], a[156:159], v[132:135], v[80:83]
s_waitcnt lgkmcnt(4)
v_add_f32 v32, 1.0, v32
v_add_f32 v33, 1.0, v33
v_mfma_f32_16x16x32_bf16 v[68:71], a[160:163], v[136:139], v[68:71]
ds_read_b128 v[160:163], v23 offset:24576
v_cvt_pk_bf16_f32 v45, v38, v39
v_mfma_f32_16x16x32_bf16 v[72:75], a[164:167], v[136:139], v[72:75]
v_rcp_f32 v32, v32
v_mfma_f32_16x16x32_bf16 v[76:79], a[168:171], v[136:139], v[76:79]
s_add_u32 m0, m0, s33
s_add_u32 s97, s97, s36
v_mul_f32 v40, v40, v32
v_mfma_f32_16x16x32_bf16 v[80:83], a[172:175], v[136:139], v[80:83]
buffer_load_dwordx4 v215, s[76:79], s97 offen sc1 lds
v_mul_f32 v34, v58, v58
v_mfma_f32_16x16x32_bf16 v[68:71], a[176:179], v[140:143], v[68:71]
ds_read_b128 v[164:167], v24 offset:24576
v_mul_f32 v35, v59, v59
v_mfma_f32_16x16x32_bf16 v[72:75], a[180:183], v[140:143], v[72:75]
v_rcp_f32 v33, v33
v_mfma_f32_16x16x32_bf16 v[76:79], a[184:187], v[140:143], v[76:79]
v_mul_f32 v41, v41, v33
v_fma_f32 v34, v34, s35, v26
v_mfma_f32_16x16x32_bf16 v[80:83], a[188:191], v[140:143], v[80:83]
s_waitcnt lgkmcnt(4)
v_fma_f32 v35, v35, s35, v26
v_mul_f32 v34, v58, v34
v_mfma_f32_16x16x32_bf16 v[68:71], a[192:195], v[144:147], v[68:71]
s_add_u32 m0, m0, s33
s_add_u32 s97, s97, s36
v_mul_f32 v35, v59, v35
v_mfma_f32_16x16x32_bf16 v[72:75], a[196:199], v[144:147], v[72:75]
buffer_load_dwordx4 v215, s[76:79], s97 offen sc1 lds
v_mul_f32 v42, v58, v66
v_mfma_f32_16x16x32_bf16 v[76:79], a[200:203], v[144:147], v[76:79]
v_exp_f32 v34, v34
v_mfma_f32_16x16x32_bf16 v[80:83], a[204:207], v[144:147], v[80:83]
v_exp_f32 v35, v35
v_mfma_f32_16x16x32_bf16 v[68:71], a[208:211], v[148:151], v[68:71]
v_mul_f32 v43, v59, v67
v_add_f32 v34, 1.0, v34
v_mfma_f32_16x16x32_bf16 v[72:75], a[212:215], v[148:151], v[72:75]
v_add_f32 v35, 1.0, v35
v_cvt_pk_bf16_f32 v46, v40, v41
v_mfma_f32_16x16x32_bf16 v[76:79], a[216:219], v[148:151], v[76:79]
s_waitcnt vmcnt(23) lgkmcnt(0)
s_barrier
v_mfma_f32_16x16x32_bf16 v[80:83], a[220:223], v[148:151], v[80:83]
v_rcp_f32 v34, v34
v_mfma_f32_16x16x32_bf16 v[68:71], a[224:227], v[152:155], v[68:71]
ds_read_b128 v[132:135], v23 offset:40960
v_mul_f32 v42, v42, v34
v_mfma_f32_16x16x32_bf16 v[72:75], a[228:231], v[152:155], v[72:75]
s_add_u32 m0, s54, 20480
s_mov_b32 s31, s29
v_mfma_f32_16x16x32_bf16 v[76:79], a[232:235], v[152:155], v[76:79]
ds_read_b128 v[136:139], v24 offset:40960
buffer_load_dwordx4 v9, s[4:7], s31 offen offset:0 lds
v_mfma_f32_16x16x32_bf16 v[80:83], a[236:239], v[152:155], v[80:83]
v_rcp_f32 v35, v35
v_mfma_f32_16x16x32_bf16 v[68:71], a[240:243], v[156:159], v[68:71]
ds_read_b128 v[140:143], v23 offset:51200
v_mul_f32 v43, v43, v35
v_mfma_f32_16x16x32_bf16 v[72:75], a[244:247], v[156:159], v[72:75]
v_cvt_pk_bf16_f32 v47, v42, v43
v_mfma_f32_16x16x32_bf16 v[76:79], a[248:251], v[156:159], v[76:79]
buffer_store_dwordx4 v[44:47], v25, s[12:15], s32 offen sc1
ds_read_b128 v[144:147], v24 offset:51200
s_add_u32 s32, s32, 147456
v_mfma_f32_16x16x32_bf16 v[80:83], a[252:255], v[156:159], v[80:83]
s_cmp_eq_u32 s32, s61
s_cselect_b32 s32, s59, s32
v_mfma_f32_16x16x32_bf16 v[68:71], v[224:227], v[160:163], v[68:71]
ds_read_b128 v[148:151], v23 offset:41984
buffer_load_dwordx4 v10, s[4:7], s31 offen offset:1024 lds
v_mfma_f32_16x16x32_bf16 v[72:75], v[228:231], v[160:163], v[72:75]
v_mfma_f32_16x16x32_bf16 v[76:79], v[232:235], v[160:163], v[76:79]
ds_read_b128 v[152:155], v24 offset:41984
v_mfma_f32_16x16x32_bf16 v[80:83], v[236:239], v[160:163], v[80:83]
v_mfma_f32_16x16x32_bf16 v[68:71], v[240:243], v[164:167], v[68:71]
v_mfma_f32_16x16x32_bf16 v[72:75], v[244:247], v[164:167], v[72:75]
v_mfma_f32_16x16x32_bf16 v[76:79], v[248:251], v[164:167], v[76:79]
v_mfma_f32_16x16x32_bf16 v[80:83], v[252:255], v[164:167], v[80:83]
s_waitcnt lgkmcnt(4)
s_add_u32 s29, s29, 18432
s_cmp_eq_u32 s29, s39
v_mfma_f32_16x16x32_bf16 v[84:87], a[0:3], v[132:135], 0
ds_read_b128 v[156:159], v23 offset:52224
s_cselect_b32 s29, s38, s29
v_mfma_f32_16x16x32_bf16 v[88:91], a[4:7], v[132:135], 0
buffer_load_dwordx4 v11, s[4:7], s31 offen offset:2048 lds
v_mfma_f32_16x16x32_bf16 v[92:95], a[8:11], v[132:135], 0
v_mul_f32 v28, v68, v68
v_mul_f32 v29, v69, v69
v_mfma_f32_16x16x32_bf16 v[96:99], a[12:15], v[132:135], 0
v_fma_f32 v28, v28, s35, v26
v_fma_f32 v29, v29, s35, v26
v_mfma_f32_16x16x32_bf16 v[84:87], a[16:19], v[136:139], v[84:87]
ds_read_b128 v[160:163], v24 offset:52224
v_mul_f32 v28, v68, v28
v_mfma_f32_16x16x32_bf16 v[88:91], a[20:23], v[136:139], v[88:91]
v_mul_f32 v29, v69, v29
v_mul_f32 v36, v68, v76
v_mfma_f32_16x16x32_bf16 v[92:95], a[24:27], v[136:139], v[92:95]
buffer_load_dwordx4 v12, s[4:7], s31 offen offset:3072 lds
v_mul_f32 v37, v69, v77
v_mfma_f32_16x16x32_bf16 v[96:99], a[28:31], v[136:139], v[96:99]
s_waitcnt lgkmcnt(4)
v_exp_f32 v28, v28
v_mfma_f32_16x16x32_bf16 v[84:87], a[32:35], v[140:143], v[84:87]
ds_read_b128 v[164:167], v23 offset:43008
v_add_f32 v28, 1.0, v28
v_mfma_f32_16x16x32_bf16 v[88:91], a[36:39], v[140:143], v[88:91]
v_exp_f32 v29, v29
v_mfma_f32_16x16x32_bf16 v[92:95], a[40:43], v[140:143], v[92:95]
v_add_f32 v29, 1.0, v29
v_mul_f32 v30, v70, v70
v_mfma_f32_16x16x32_bf16 v[96:99], a[44:47], v[140:143], v[96:99]
v_rcp_f32 v28, v28
v_mfma_f32_16x16x32_bf16 v[84:87], a[48:51], v[144:147], v[84:87]
ds_read_b128 v[132:135], v24 offset:43008
v_mul_f32 v36, v36, v28
v_mfma_f32_16x16x32_bf16 v[88:91], a[52:55], v[144:147], v[88:91]
s_add_u32 m0, s54, 24576
s_nop 0
buffer_load_dwordx4 v13, s[4:7], s31 offen offset:0 lds
v_mfma_f32_16x16x32_bf16 v[92:95], a[56:59], v[144:147], v[92:95]
v_rcp_f32 v29, v29
v_mfma_f32_16x16x32_bf16 v[96:99], a[60:63], v[144:147], v[96:99]
s_waitcnt lgkmcnt(4)
v_mul_f32 v37, v37, v29
v_mul_f32 v31, v71, v71
v_mfma_f32_16x16x32_bf16 v[84:87], a[64:67], v[148:151], v[84:87]
ds_read_b128 v[136:139], v23 offset:53248
v_fma_f32 v30, v30, s35, v26
v_mfma_f32_16x16x32_bf16 v[88:91], a[68:71], v[148:151], v[88:91]
v_fma_f32 v31, v31, s35, v26
v_mul_f32 v30, v70, v30
v_mfma_f32_16x16x32_bf16 v[92:95], a[72:75], v[148:151], v[92:95]
v_mul_f32 v31, v71, v31
v_mul_f32 v38, v70, v78
v_mfma_f32_16x16x32_bf16 v[96:99], a[76:79], v[148:151], v[96:99]
v_exp_f32 v30, v30
v_mfma_f32_16x16x32_bf16 v[84:87], a[80:83], v[152:155], v[84:87]
ds_read_b128 v[140:143], v24 offset:53248
s_add_u32 s63, s92, 8
v_mfma_f32_16x16x32_bf16 v[88:91], a[84:87], v[152:155], v[88:91]
s_waitcnt vmcnt(11)
v_subrev_u32 v51, s63, v221
v_cmp_lt_u32 vcc, 7, v51
v_mfma_f32_16x16x32_bf16 v[92:95], a[88:91], v[152:155], v[92:95]
s_and_b64 vcc, vcc, s[52:53]
s_cbranch_vccnz A_s0
A_r0:
v_mfma_f32_16x16x32_bf16 v[96:99], a[92:95], v[152:155], v[96:99]
s_waitcnt lgkmcnt(4)
v_exp_f32 v31, v31
v_mfma_f32_16x16x32_bf16 v[84:87], a[96:99], v[156:159], v[84:87]
ds_read_b128 v[144:147], v23 offset:44032
s_mov_b32 m0, s43
v_mfma_f32_16x16x32_bf16 v[88:91], a[100:103], v[156:159], v[88:91]
s_mov_b32 s97, s46
buffer_load_dwordx4 v216, s[16:19], s97 offen sc1 lds
v_mfma_f32_16x16x32_bf16 v[92:95], a[104:107], v[156:159], v[92:95]
v_mul_f32 v39, v71, v79
v_add_f32 v30, 1.0, v30
v_mfma_f32_16x16x32_bf16 v[96:99], a[108:111], v[156:159], v[96:99]
v_add_f32 v31, 1.0, v31
v_cvt_pk_bf16_f32 v44, v36, v37
v_mfma_f32_16x16x32_bf16 v[84:87], a[112:115], v[160:163], v[84:87]
ds_read_b128 v[148:151], v24 offset:44032
v_mul_f32 v32, v72, v72
v_mfma_f32_16x16x32_bf16 v[88:91], a[116:119], v[160:163], v[88:91]
v_rcp_f32 v30, v30
v_mfma_f32_16x16x32_bf16 v[92:95], a[120:123], v[160:163], v[92:95]
s_mov_b32 m0, s22
s_nop 0
buffer_load_dwordx4 v217, s[16:19], s97 offen sc1 lds
v_mfma_f32_16x16x32_bf16 v[96:99], a[124:127], v[160:163], v[96:99]
s_waitcnt lgkmcnt(4)
v_rcp_f32 v31, v31
v_mfma_f32_16x16x32_bf16 v[84:87], a[128:131], v[164:167], v[84:87]
ds_read_b128 v[152:155], v23 offset:54272
v_mul_f32 v38, v38, v30
v_mfma_f32_16x16x32_bf16 v[88:91], a[132:135], v[164:167], v[88:91]
v_mul_f32 v39, v39, v31
v_mul_f32 v33, v73, v73
v_mfma_f32_16x16x32_bf16 v[92:95], a[136:139], v[164:167], v[92:95]
v_fma_f32 v32, v32, s35, v26
v_fma_f32 v33, v33, s35, v26
v_mfma_f32_16x16x32_bf16 v[96:99], a[140:143], v[164:167], v[96:99]
v_mul_f32 v32, v72, v32
v_mul_f32 v33, v73, v33
v_mfma_f32_16x16x32_bf16 v[84:87], a[144:147], v[132:135], v[84:87]
ds_read_b128 v[156:159], v24 offset:54272
s_add_u32 m0, m0, s23
v_mfma_f32_16x16x32_bf16 v[88:91], a[148:151], v[132:135], v[88:91]
s_add_u32 s97, s97, s34
buffer_load_dwordx4 v217, s[16:19], s97 offen sc1 lds
v_mfma_f32_16x16x32_bf16 v[92:95], a[152:155], v[132:135], v[92:95]
v_exp_f32 v32, v32
v_mfma_f32_16x16x32_bf16 v[96:99], a[156:159], v[132:135], v[96:99]
s_waitcnt lgkmcnt(4)
v_exp_f32 v33, v33
v_mfma_f32_16x16x32_bf16 v[84:87], a[160:163], v[136:139], v[84:87]
ds_read_b128 v[160:163], v23 offset:45056
v_mul_f32 v40, v72, v80
v_mfma_f32_16x16x32_bf16 v[88:91], a[164:167], v[136:139], v[88:91]
v_mul_f32 v41, v73, v81
v_add_f32 v32, 1.0, v32
v_mfma_f32_16x16x32_bf16 v[92:95], a[168:171], v[136:139], v[92:95]
s_add_u32 m0, m0, s23
s_add_u32 s97, s97, s34
v_add_f32 v33, 1.0, v33
v_mfma_f32_16x16x32_bf16 v[96:99], a[172:175], v[136:139], v[96:99]
buffer_load_dwordx4 v217, s[16:19], s97 offen sc1 lds
v_cvt_pk_bf16_f32 v45, v38, v39
v_mfma_f32_16x16x32_bf16 v[84:87], a[176:179], v[140:143], v[84:87]
ds_read_b128 v[164:167], v24 offset:45056
v_mul_f32 v34, v74, v74
v_mfma_f32_16x16x32_bf16 v[88:91], a[180:183], v[140:143], v[88:91]
v_rcp_f32 v32, v32
v_mfma_f32_16x16x32_bf16 v[92:95], a[184:187], v[140:143], v[92:95]
v_rcp_f32 v33, v33
v_mfma_f32_16x16x32_bf16 v[96:99], a[188:191], v[140:143], v[96:99]
s_waitcnt lgkmcnt(4)
v_mul_f32 v40, v40, v32
v_mul_f32 v41, v41, v33
v_mfma_f32_16x16x32_bf16 v[84:87], a[192:195], v[144:147], v[84:87]
s_add_u32 m0, m0, s23
s_add_u32 s97, s97, s34
v_mul_f32 v35, v75, v75
v_mfma_f32_16x16x32_bf16 v[88:91], a[196:199], v[144:147], v[88:91]
buffer_load_dwordx4 v217, s[16:19], s97 offen sc1 lds
v_fma_f32 v34, v34, s35, v26
v_mfma_f32_16x16x32_bf16 v[92:95], a[200:203], v[144:147], v[92:95]
v_fma_f32 v35, v35, s35, v26
v_mul_f32 v34, v74, v34
v_mfma_f32_16x16x32_bf16 v[96:99], a[204:207], v[144:147], v[96:99]
v_mul_f32 v35, v75, v35
v_mul_f32 v42, v74, v82
v_mfma_f32_16x16x32_bf16 v[84:87], a[208:211], v[148:151], v[84:87]
v_exp_f32 v34, v34
v_mfma_f32_16x16x32_bf16 v[88:91], a[212:215], v[148:151], v[88:91]
v_exp_f32 v35, v35
v_mfma_f32_16x16x32_bf16 v[92:95], a[216:219], v[148:151], v[92:95]
s_waitcnt lgkmcnt(0)
s_barrier
v_mfma_f32_16x16x32_bf16 v[96:99], a[220:223], v[148:151], v[96:99]
v_mul_f32 v43, v75, v83
v_add_f32 v34, 1.0, v34
v_mfma_f32_16x16x32_bf16 v[84:87], a[224:227], v[152:155], v[84:87]
ds_read_b128 v[132:135], v23 offset:0
v_add_f32 v35, 1.0, v35
v_mfma_f32_16x16x32_bf16 v[88:91], a[228:231], v[152:155], v[88:91]
s_add_u32 m0, s54, 40960
s_mov_b32 s31, s29
v_cvt_pk_bf16_f32 v46, v40, v41
v_mfma_f32_16x16x32_bf16 v[92:95], a[232:235], v[152:155], v[92:95]
ds_read_b128 v[136:139], v24 offset:0
buffer_load_dwordx4 v9, s[4:7], s31 offen offset:0 lds
v_mfma_f32_16x16x32_bf16 v[96:99], a[236:239], v[152:155], v[96:99]
v_rcp_f32 v34, v34
v_mfma_f32_16x16x32_bf16 v[84:87], a[240:243], v[156:159], v[84:87]
ds_read_b128 v[140:143], v23 offset:10240
buffer_load_dwordx4 v10, s[4:7], s31 offen offset:1024 lds
v_mfma_f32_16x16x32_bf16 v[88:91], a[244:247], v[156:159], v[88:91]
v_rcp_f32 v35, v35
v_mfma_f32_16x16x32_bf16 v[92:95], a[248:251], v[156:159], v[92:95]
ds_read_b128 v[144:147], v24 offset:10240
v_mul_f32 v42, v42, v34
v_mfma_f32_16x16x32_bf16 v[96:99], a[252:255], v[156:159], v[96:99]
s_add_u32 s29, s29, 18432
s_cmp_eq_u32 s29, s39
v_mfma_f32_16x16x32_bf16 v[84:87], v[224:227], v[160:163], v[84:87]
ds_read_b128 v[148:151], v23 offset:1024
s_cselect_b32 s29, s38, s29
v_mfma_f32_16x16x32_bf16 v[88:91], v[228:231], v[160:163], v[88:91]
buffer_load_dwordx4 v11, s[4:7], s31 offen offset:2048 lds
v_mul_f32 v43, v43, v35
v_mfma_f32_16x16x32_bf16 v[92:95], v[232:235], v[160:163], v[92:95]
ds_read_b128 v[152:155], v24 offset:1024
buffer_load_dwordx4 v12, s[4:7], s31 offen offset:3072 lds
v_mfma_f32_16x16x32_bf16 v[96:99], v[236:239], v[160:163], v[96:99]
v_cvt_pk_bf16_f32 v47, v42, v43
v_mfma_f32_16x16x32_bf16 v[84:87], v[240:243], v[164:167], v[84:87]
buffer_store_dwordx4 v[44:47], v25, s[12:15], s32 offen sc1
s_add_u32 s32, s32, 147456
s_cmp_eq_u32 s32, s61
v_mfma_f32_16x16x32_bf16 v[88:91], v[244:247], v[164:167], v[88:91]
s_cselect_b32 s32, s59, s32
s_add_u32 m0, s54, 45056
s_sub_u32 s28, s28, 1
v_mfma_f32_16x16x32_bf16 v[92:95], v[248:251], v[164:167], v[92:95]
buffer_load_dwordx4 v13, s[4:7], s31 offen offset:0 lds
s_cmp_eq_u32 s28, 0
v_mfma_f32_16x16x32_bf16 v[96:99], v[252:255], v[164:167], v[96:99]
s_cselect_b32 s40, s93, 2146435072
v_add_u32 v49, 6, v48
s_waitcnt vmcnt(15)
buffer_store_dword v49, v27, s[12:15], s40 offen sc1
s_cmp_eq_u32 s28, 2
s_cbranch_scc1 A_e2
s_cmp_eq_u32 s28, 1
s_cbranch_scc1 A_e1
s_cmp_eq_u32 s28, 3
s_cbranch_scc1 A_e3
s_waitcnt lgkmcnt(4)
v_mfma_f32_16x16x32_bf16 v[52:55], a[0:3], v[132:135], 0
ds_read_b128 v[156:159], v23 offset:11264
s_movk_i32 s40, 8316
v_mfma_f32_16x16x32_bf16 v[56:59], a[4:7], v[132:135], 0
s_cmp_ge_u32 s26, 4
s_cselect_b32 s40, 10240, s40
s_cselect_b32 s49, 36864, 0
v_mfma_f32_16x16x32_bf16 v[60:63], a[8:11], v[132:135], 0
s_add_u32 s42, s42, s40
s_add_u32 s21, s21, s40
s_add_u32 s45, s45, s49
v_mfma_f32_16x16x32_bf16 v[64:67], a[12:15], v[132:135], 0
s_add_u32 s43, s43, s40
s_add_u32 s22, s22, s40
s_add_u32 s46, s46, s49
v_mfma_f32_16x16x32_bf16 v[52:55], a[16:19], v[136:139], v[52:55]
ds_read_b128 v[160:163], v24 offset:11264
v_mul_f32 v28, v84, v84
v_mfma_f32_16x16x32_bf16 v[56:59], a[20:23], v[136:139], v[56:59]
s_mov_b32 m0, s42
s_mov_b32 s97, s45
v_mul_f32 v29, v85, v85
v_mfma_f32_16x16x32_bf16 v[60:63], a[24:27], v[136:139], v[60:63]
buffer_load_dwordx4 v214, s[76:79], s97 offen sc1 lds
v_fma_f32 v28, v28, s35, v26
v_mfma_f32_16x16x32_bf16 v[64:67], a[28:31], v[136:139], v[64:67]
s_waitcnt lgkmcnt(4)
v_fma_f32 v29, v29, s35, v26
v_mul_f32 v28, v84, v28
v_mfma_f32_16x16x32_bf16 v[52:55], a[32:35], v[140:143], v[52:55]
ds_read_b128 v[164:167], v23 offset:2048
v_mul_f32 v29, v85, v29
v_mfma_f32_16x16x32_bf16 v[56:59], a[36:39], v[140:143], v[56:59]
v_exp_f32 v28, v28
v_mfma_f32_16x16x32_bf16 v[60:63], a[40:43], v[140:143], v[60:63]
s_mov_b32 m0, s21
s_nop 0
buffer_load_dwordx4 v215, s[76:79], s97 offen sc1 lds
v_mfma_f32_16x16x32_bf16 v[64:67], a[44:47], v[140:143], v[64:67]
v_exp_f32 v29, v29
v_mfma_f32_16x16x32_bf16 v[52:55], a[48:51], v[144:147], v[52:55]
ds_read_b128 v[132:135], v24 offset:2048
v_mul_f32 v36, v84, v92
v_mfma_f32_16x16x32_bf16 v[56:59], a[52:55], v[144:147], v[56:59]
v_mul_f32 v37, v85, v93
v_add_f32 v28, 1.0, v28
v_mfma_f32_16x16x32_bf16 v[60:63], a[56:59], v[144:147], v[60:63]
v_add_f32 v29, 1.0, v29
v_mul_f32 v30, v86, v86
v_mfma_f32_16x16x32_bf16 v[64:67], a[60:63], v[144:147], v[64:67]
s_waitcnt lgkmcnt(4)
s_add_u32 m0, m0, s33
s_add_u32 s97, s97, s36
v_mfma_f32_16x16x32_bf16 v[52:55], a[64:67], v[148:151], v[52:55]
ds_read_b128 v[136:139], v23 offset:12288
buffer_load_dwordx4 v215, s[76:79], s97 offen sc1 lds
v_mfma_f32_16x16x32_bf16 v[56:59], a[68:71], v[148:151], v[56:59]
v_rcp_f32 v28, v28
v_mfma_f32_16x16x32_bf16 v[60:63], a[72:75], v[148:151], v[60:63]
v_rcp_f32 v29, v29
v_mfma_f32_16x16x32_bf16 v[64:67], a[76:79], v[148:151], v[64:67]
v_mul_f32 v36, v36, v28
v_mul_f32 v37, v37, v29
v_mfma_f32_16x16x32_bf16 v[52:55], a[80:83], v[152:155], v[52:55]
ds_read_b128 v[140:143], v24 offset:12288
s_add_u32 m0, m0, s33
v_mfma_f32_16x16x32_bf16 v[56:59], a[84:87], v[152:155], v[56:59]
s_add_u32 s97, s97, s36
buffer_load_dwordx4 v215, s[76:79], s97 offen sc1 lds
v_mfma_f32_16x16x32_bf16 v[60:63], a[88:91], v[152:155], v[60:63]
v_mul_f32 v31, v87, v87
v_fma_f32 v30, v30, s35, v26
v_mfma_f32_16x16x32_bf16 v[64:67], a[92:95], v[152:155], v[64:67]
s_waitcnt lgkmcnt(4)
v_fma_f32 v31, v31, s35, v26
v_mul_f32 v30, v86, v30
v_mfma_f32_16x16x32_bf16 v[52:55], a[96:99], v[156:159], v[52:55]
ds_read_b128 v[144:147], v23 offset:3072
v_mul_f32 v31, v87, v31
v_mfma_f32_16x16x32_bf16 v[56:59], a[100:103], v[156:159], v[56:59]
s_add_u32 m0, m0, s33
s_add_u32 s97, s97, s36
v_mul_f32 v38, v86, v94
v_mfma_f32_16x16x32_bf16 v[60:63], a[104:107], v[156:159], v[60:63]
buffer_load_dwordx4 v215, s[76:79], s97 offen sc1 lds
v_mul_f32 v39, v87, v95
v_mfma_f32_16x16x32_bf16 v[64:67], a[108:111], v[156:159], v[64:67]
v_exp_f32 v30, v30
v_mfma_f32_16x16x32_bf16 v[52:55], a[112:115], v[160:163], v[52:55]
ds_read_b128 v[148:151], v24 offset:3072
v_add_f32 v30, 1.0, v30
v_mfma_f32_16x16x32_bf16 v[56:59], a[116:119], v[160:163], v[56:59]
v_exp_f32 v31, v31
v_mfma_f32_16x16x32_bf16 v[60:63], a[120:123], v[160:163], v[60:63]
s_mov_b32 m0, s43
s_mov_b32 s97, s46
v_add_f32 v31, 1.0, v31
v_mfma_f32_16x16x32_bf16 v[64:67], a[124:127], v[160:163], v[64:67]
s_waitcnt lgkmcnt(4)
buffer_load_dwordx4 v216, s[16:19], s97 offen sc1 lds
v_cvt_pk_bf16_f32 v44, v36, v37
v_mfma_f32_16x16x32_bf16 v[52:55], a[128:131], v[164:167], v[52:55]
ds_read_b128 v[152:155], v23 offset:13312
v_mul_f32 v32, v88, v88
v_mfma_f32_16x16x32_bf16 v[56:59], a[132:135], v[164:167], v[56:59]
v_rcp_f32 v30, v30
v_mfma_f32_16x16x32_bf16 v[60:63], a[136:139], v[164:167], v[60:63]
v_rcp_f32 v31, v31
v_mfma_f32_16x16x32_bf16 v[64:67], a[140:143], v[164:167], v[64:67]
s_mov_b32 m0, s22
s_nop 0
buffer_load_dwordx4 v217, s[16:19], s97 offen sc1 lds
v_mfma_f32_16x16x32_bf16 v[52:55], a[144:147], v[132:135], v[52:55]
ds_read_b128 v[156:159], v24 offset:13312
v_mul_f32 v38, v38, v30
v_mfma_f32_16x16x32_bf16 v[56:59], a[148:151], v[132:135], v[56:59]
v_mul_f32 v39, v39, v31
v_mul_f32 v33, v89, v89
v_mfma_f32_16x16x32_bf16 v[60:63], a[152:155], v[132:135], v[60:63]
v_fma_f32 v32, v32, s35, v26
v_fma_f32 v33, v33, s35, v26
v_mfma_f32_16x16x32_bf16 v[64:67], a[156:159], v[132:135], v[64:67]
s_waitcnt lgkmcnt(4)
v_mul_f32 v32, v88, v32
v_mul_f32 v33, v89, v33
v_mfma_f32_16x16x32_bf16 v[52:55], a[160:163], v[136:139], v[52:55]
ds_read_b128 v[160:163], v23 offset:4096
s_add_u32 m0, m0, s23
v_mfma_f32_16x16x32_bf16 v[56:59], a[164:167], v[136:139], v[56:59]
s_add_u32 s97, s97, s34
buffer_load_dwordx4 v217, s[16:19], s97 offen sc1 lds
v_mfma_f32_16x16x32_bf16 v[60:63], a[168:171], v[136:139], v[60:63]
v_exp_f32 v32, v32
v_mfma_f32_16x16x32_bf16 v[64:67], a[172:175], v[136:139], v[64:67]
v_exp_f32 v33, v33
v_mfma_f32_16x16x32_bf16 v[52:55], a[176:179], v[140:143], v[52:55]
ds_read_b128 v[164:167], v24 offset:4096
v_mul_f32 v40, v88, v96
v_mfma_f32_16x16x32_bf16 v[56:59], a[180:183], v[140:143], v[56:59]
s_add_u32 m0, m0, s23
s_add_u32 s97, s97, s34
v_mul_f32 v41, v89, v97
v_mfma_f32_16x16x32_bf16 v[60:63], a[184:187], v[140:143], v[60:63]
buffer_load_dwordx4 v217, s[16:19], s97 offen sc1 lds
v_add_f32 v32, 1.0, v32
v_mfma_f32_16x16x32_bf16 v[64:67], a[188:191], v[140:143], v[64:67]
s_waitcnt lgkmcnt(4)
v_add_f32 v33, 1.0, v33
v_cvt_pk_bf16_f32 v45, v38, v39
v_mfma_f32_16x16x32_bf16 v[52:55], a[192:195], v[144:147], v[52:55]
v_rcp_f32 v32, v32
v_mfma_f32_16x16x32_bf16 v[56:59], a[196:199], v[144:147], v[56:59]
v_rcp_f32 v33, v33
v_mfma_f32_16x16x32_bf16 v[60:63], a[200:203], v[144:147], v[60:63]
s_add_u32 m0, m0, s23
s_add_u32 s97, s97, s34
v_mul_f32 v40, v40, v32
v_mfma_f32_16x16x32_bf16 v[64:67], a[204:207], v[144:147], v[64:67]
buffer_load_dwordx4 v217, s[16:19], s97 offen sc1 lds
v_mul_f32 v41, v41, v33
v_mfma_f32_16x16x32_bf16 v[52:55], a[208:211], v[148:151], v[52:55]
v_mul_f32 v34, v90, v90
v_mul_f32 v35, v91, v91
v_mfma_f32_16x16x32_bf16 v[56:59], a[212:215], v[148:151], v[56:59]
v_fma_f32 v34, v34, s35, v26
v_fma_f32 v35, v35, s35, v26
v_mfma_f32_16x16x32_bf16 v[60:63], a[216:219], v[148:151], v[60:63]
s_waitcnt vmcnt(22) lgkmcnt(0)
s_barrier
v_mfma_f32_16x16x32_bf16 v[64:67], a[220:223], v[148:151], v[64:67]
v_mul_f32 v34, v90, v34
v_mul_f32 v35, v91, v35
v_mfma_f32_16x16x32_bf16 v[52:55], a[224:227], v[152:155], v[52:55]
ds_read_b128 v[132:135], v23 offset:20480
s_add_u32 s63, s92, 8
v_mfma_f32_16x16x32_bf16 v[56:59], a[228:231], v[152:155], v[56:59]
v_subrev_u32 v51, s63, v223
v_cmp_lt_u32 vcc, 7, v51
v_mfma_f32_16x16x32_bf16 v[60:63], a[232:235], v[152:155], v[60:63]
ds_read_b128 v[136:139], v24 offset:20480
s_and_b64 vcc, vcc, 1
v_mfma_f32_16x16x32_bf16 v[64:67], a[236:239], v[152:155], v[64:67]
s_cbranch_vccnz A_s5
A_r5:
v_mfma_f32_16x16x32_bf16 v[52:55], a[240:243], v[156:159], v[52:55]
ds_read_b128 v[140:143], v23 offset:30720
s_add_u32 m0, s54, 0
v_mfma_f32_16x16x32_bf16 v[56:59], a[244:247], v[156:159], v[56:59]
s_add_u32 s97, s47, 0
buffer_load_dwordx4 v2, s[12:15], s97 offen sc1 lds
v_mfma_f32_16x16x32_bf16 v[60:63], a[248:251], v[156:159], v[60:63]
ds_read_b128 v[144:147], v24 offset:30720
v_mul_f32 v42, v90, v98
v_mfma_f32_16x16x32_bf16 v[64:67], a[252:255], v[156:159], v[64:67]
v_exp_f32 v34, v34
v_mfma_f32_16x16x32_bf16 v[52:55], v[224:227], v[160:163], v[52:55]
ds_read_b128 v[148:151], v23 offset:21504
v_mul_f32 v43, v91, v99
v_mfma_f32_16x16x32_bf16 v[56:59], v[228:231], v[160:163], v[56:59]
v_exp_f32 v35, v35
v_mfma_f32_16x16x32_bf16 v[60:63], v[232:235], v[160:163], v[60:63]
ds_read_b128 v[152:155], v24 offset:21504
v_add_f32 v34, 1.0, v34
v_mfma_f32_16x16x32_bf16 v[64:67], v[236:239], v[160:163], v[64:67]
v_add_f32 v35, 1.0, v35
v_cvt_pk_bf16_f32 v46, v40, v41
v_mfma_f32_16x16x32_bf16 v[52:55], v[240:243], v[164:167], v[52:55]
v_rcp_f32 v34, v34
v_mfma_f32_16x16x32_bf16 v[56:59], v[244:247], v[164:167], v[56:59]
v_rcp_f32 v35, v35
v_mfma_f32_16x16x32_bf16 v[60:63], v[248:251], v[164:167], v[60:63]
buffer_load_dwordx4 v3, s[64:67], s97 offen offset:512 lds
v_mul_f32 v42, v42, v34
v_mfma_f32_16x16x32_bf16 v[64:67], v[252:255], v[164:167], v[64:67]
s_waitcnt lgkmcnt(4)
v_mul_f32 v43, v43, v35
v_cvt_pk_bf16_f32 v47, v42, v43
v_mfma_f32_16x16x32_bf16 v[68:71], a[0:3], v[132:135], 0
buffer_store_dwordx4 v[44:47], v25, s[12:15], s32 offen sc1
ds_read_b128 v[156:159], v23 offset:31744
s_add_u32 s32, s32, 147456
v_mfma_f32_16x16x32_bf16 v[72:75], a[4:7], v[132:135], 0
s_cmp_eq_u32 s32, s61
s_cselect_b32 s32, s59, s32
v_mfma_f32_16x16x32_bf16 v[76:79], a[8:11], v[132:135], 0
v_mul_f32 v28, v52, v52
v_mul_f32 v29, v53, v53
v_mfma_f32_16x16x32_bf16 v[80:83], a[12:15], v[132:135], 0
v_fma_f32 v28, v28, s35, v26
v_fma_f32 v29, v29, s35, v26
v_mfma_f32_16x16x32_bf16 v[68:71], a[16:19], v[136:139], v[68:71]
ds_read_b128 v[160:163], v24 offset:31744
v_mul_f32 v28, v52, v28
v_mfma_f32_16x16x32_bf16 v[72:75], a[20:23], v[136:139], v[72:75]
v_mul_f32 v29, v53, v29
v_mul_f32 v36, v52, v60
v_mfma_f32_16x16x32_bf16 v[76:79], a[24:27], v[136:139], v[76:79]
v_exp_f32 v28, v28
v_mfma_f32_16x16x32_bf16 v[80:83], a[28:31], v[136:139], v[80:83]
s_waitcnt lgkmcnt(4)
v_exp_f32 v29, v29
v_mfma_f32_16x16x32_bf16 v[68:71], a[32:35], v[140:143], v[68:71]
ds_read_b128 v[164:167], v23 offset:22528
buffer_load_dwordx4 v4, s[64:67], s97 offen offset:1568 lds
v_mfma_f32_16x16x32_bf16 v[72:75], a[36:39], v[140:143], v[72:75]
v_mul_f32 v37, v53, v61
v_add_f32 v28, 1.0, v28
v_mfma_f32_16x16x32_bf16 v[76:79], a[40:43], v[140:143], v[76:79]
v_add_f32 v29, 1.0, v29
v_mul_f32 v30, v54, v54
v_mfma_f32_16x16x32_bf16 v[80:83], a[44:47], v[140:143], v[80:83]
v_rcp_f32 v28, v28
v_mfma_f32_16x16x32_bf16 v[68:71], a[48:51], v[144:147], v[68:71]
ds_read_b128 v[132:135], v24 offset:22528
v_mul_f32 v36, v36, v28
v_mfma_f32_16x16x32_bf16 v[72:75], a[52:55], v[144:147], v[72:75]
v_rcp_f32 v29, v29
v_mfma_f32_16x16x32_bf16 v[76:79], a[56:59], v[144:147], v[76:79]
v_mul_f32 v37, v37, v29
v_mul_f32 v31, v55, v55
v_mfma_f32_16x16x32_bf16 v[80:83], a[60:63], v[144:147], v[80:83]
s_waitcnt lgkmcnt(4)
v_fma_f32 v30, v30, s35, v26
v_fma_f32 v31, v31, s35, v26
v_mfma_f32_16x16x32_bf16 v[68:71], a[64:67], v[148:151], v[68:71]
ds_read_b128 v[136:139], v23 offset:32768
v_mul_f32 v30, v54, v30
v_mfma_f32_16x16x32_bf16 v[72:75], a[68:71], v[148:151], v[72:75]
v_mul_f32 v31, v55, v31
v_mul_f32 v38, v54, v62
v_mfma_f32_16x16x32_bf16 v[76:79], a[72:75], v[148:151], v[76:79]
buffer_load_dwordx4 v5, s[64:67], s97 offen offset:2624 lds
v_mul_f32 v39, v55, v63
v_mfma_f32_16x16x32_bf16 v[80:83], a[76:79], v[148:151], v[80:83]
v_exp_f32 v30, v30
v_mfma_f32_16x16x32_bf16 v[68:71], a[80:83], v[152:155], v[68:71]
ds_read_b128 v[140:143], v24 offset:32768
v_add_f32 v30, 1.0, v30
v_mfma_f32_16x16x32_bf16 v[72:75], a[84:87], v[152:155], v[72:75]
v_exp_f32 v31, v31
v_mfma_f32_16x16x32_bf16 v[76:79], a[88:91], v[152:155], v[76:79]
v_add_f32 v31, 1.0, v31
v_cvt_pk_bf16_f32 v44, v36, v37
v_mfma_f32_16x16x32_bf16 v[80:83], a[92:95], v[152:155], v[80:83]
s_waitcnt lgkmcnt(4)
v_rcp_f32 v30, v30
v_mfma_f32_16x16x32_bf16 v[68:71], a[96:99], v[156:159], v[68:71]
ds_read_b128 v[144:147], v23 offset:23552
v_mul_f32 v38, v38, v30
v_mfma_f32_16x16x32_bf16 v[72:75], a[100:103], v[156:159], v[72:75]
v_rcp_f32 v31, v31
v_mfma_f32_16x16x32_bf16 v[76:79], a[104:107], v[156:159], v[76:79]
v_mul_f32 v39, v39, v31
v_mul_f32 v32, v56, v56
v_mfma_f32_16x16x32_bf16 v[80:83], a[108:111], v[156:159], v[80:83]
v_mul_f32 v33, v57, v57
v_fma_f32 v32, v32, s35, v26
v_mfma_f32_16x16x32_bf16 v[68:71], a[112:115], v[160:163], v[68:71]
ds_read_b128 v[148:151], v24 offset:23552
buffer_load_dwordx4 v6, s[64:67], s97 offen offset:3680 lds
v_mfma_f32_16x16x32_bf16 v[72:75], a[116:119], v[160:163], v[72:75]
s_waitcnt vmcnt(6)
ds_read_b128 v[218:221], v20 offset:4608
ds_read_b64 v[222:223], v20 offset:4624
v_mfma_f32_16x16x32_bf16 v[76:79], a[120:123], v[160:163], v[76:79]
v_fma_f32 v33, v33, s35, v26
v_mul_f32 v32, v56, v32
v_mfma_f32_16x16x32_bf16 v[80:83], a[124:127], v[160:163], v[80:83]
s_waitcnt lgkmcnt(6)
v_mul_f32 v33, v57, v33
v_mul_f32 v40, v56, v64
v_mfma_f32_16x16x32_bf16 v[68:71], a[128:131], v[164:167], v[68:71]
ds_read_b128 v[152:155], v23 offset:33792
v_mul_f32 v41, v57, v65
v_mfma_f32_16x16x32_bf16 v[72:75], a[132:135], v[164:167], v[72:75]
v_exp_f32 v32, v32
v_mfma_f32_16x16x32_bf16 v[76:79], a[136:139], v[164:167], v[76:79]
s_waitcnt lgkmcnt(1)
v_alignbit_b32 v208, v219, v218, 16
v_alignbit_b32 v209, v220, v219, 16
v_mfma_f32_16x16x32_bf16 v[80:83], a[140:143], v[164:167], v[80:83]
v_alignbit_b32 v210, v221, v220, 16
v_alignbit_b32 v211, v222, v221, 16
v_mfma_f32_16x16x32_bf16 v[68:71], a[144:147], v[132:135], v[68:71]
ds_read_b128 v[156:159], v24 offset:33792
v_alignbit_b32 v10, v220, v219, 16
v_mfma_f32_16x16x32_bf16 v[72:75], a[148:151], v[132:135], v[72:75]
ds_write_b128 v20, v[208:211] offset:8768
v_mfma_f32_16x16x32_bf16 v[76:79], a[152:155], v[132:135], v[76:79]
v_alignbit_b32 v11, v221, v220, 16
v_alignbit_b32 v12, v222, v221, 16
v_mfma_f32_16x16x32_bf16 v[80:83], a[156:159], v[132:135], v[80:83]
v_alignbit_b32 v13, v223, v222, 16
v_add_f32 v32, 1.0, v32
v_mfma_f32_16x16x32_bf16 v[68:71], a[160:163], v[136:139], v[68:71]
ds_read_b128 v[160:163], v23 offset:24576
v_cvt_pk_bf16_f32 v45, v38, v39
v_mfma_f32_16x16x32_bf16 v[72:75], a[164:167], v[136:139], v[72:75]
ds_write_b128 v20, v[10:13] offset:17088
v_mfma_f32_16x16x32_bf16 v[76:79], a[168:171], v[136:139], v[76:79]
v_exp_f32 v33, v33
v_mfma_f32_16x16x32_bf16 v[80:83], a[172:175], v[136:139], v[80:83]
v_add_f32 v33, 1.0, v33
v_mul_f32 v34, v58, v58
v_mfma_f32_16x16x32_bf16 v[68:71], a[176:179], v[140:143], v[68:71]
ds_read_b128 v[164:167], v24 offset:24576
v_mul_f32 v35, v59, v59
v_mfma_f32_16x16x32_bf16 v[72:75], a[180:183], v[140:143], v[72:75]
v_rcp_f32 v32, v32
v_mfma_f32_16x16x32_bf16 v[76:79], a[184:187], v[140:143], v[76:79]
v_rcp_f32 v33, v33
v_mfma_f32_16x16x32_bf16 v[80:83], a[188:191], v[140:143], v[80:83]
v_mul_f32 v40, v40, v32
v_mul_f32 v41, v41, v33
v_mfma_f32_16x16x32_bf16 v[68:71], a[192:195], v[144:147], v[68:71]
v_fma_f32 v34, v34, s35, v26
v_fma_f32 v35, v35, s35, v26
v_mfma_f32_16x16x32_bf16 v[72:75], a[196:199], v[144:147], v[72:75]
v_mul_f32 v34, v58, v34
v_mul_f32 v35, v59, v35
v_mfma_f32_16x16x32_bf16 v[76:79], a[200:203], v[144:147], v[76:79]
v_exp_f32 v34, v34
v_mfma_f32_16x16x32_bf16 v[80:83], a[204:207], v[144:147], v[80:83]
v_exp_f32 v35, v35
v_mfma_f32_16x16x32_bf16 v[68:71], a[208:211], v[148:151], v[68:71]
v_mul_f32 v42, v58, v66
v_mul_f32 v43, v59, v67
v_mfma_f32_16x16x32_bf16 v[72:75], a[212:215], v[148:151], v[72:75]
v_add_f32 v34, 1.0, v34
v_add_f32 v35, 1.0, v35
v_mfma_f32_16x16x32_bf16 v[76:79], a[216:219], v[148:151], v[76:79]
s_waitcnt lgkmcnt(0)
s_barrier
v_mfma_f32_16x16x32_bf16 v[80:83], a[220:223], v[148:151], v[80:83]
ds_read_b128 v[218:221], v20 offset:5632
ds_read_b64 v[222:223], v20 offset:5648
v_mfma_f32_16x16x32_bf16 v[68:71], a[224:227], v[152:155], v[68:71]
ds_read_b128 v[132:135], v23 offset:40960
v_cvt_pk_bf16_f32 v46, v40, v41
v_mfma_f32_16x16x32_bf16 v[72:75], a[228:231], v[152:155], v[72:75]
s_add_u32 m0, s54, 20480
s_add_u32 s97, s47, 18432
v_mfma_f32_16x16x32_bf16 v[76:79], a[232:235], v[152:155], v[76:79]
ds_read_b128 v[136:139], v24 offset:40960
buffer_load_dwordx4 v2, s[12:15], s97 offen sc1 lds
v_mfma_f32_16x16x32_bf16 v[80:83], a[236:239], v[152:155], v[80:83]
v_rcp_f32 v34, v34
v_mfma_f32_16x16x32_bf16 v[68:71], a[240:243], v[156:159], v[68:71]
ds_read_b128 v[140:143], v23 offset:51200
v_mul_f32 v42, v42, v34
v_mfma_f32_16x16x32_bf16 v[72:75], a[244:247], v[156:159], v[72:75]
s_waitcnt lgkmcnt(3)
v_alignbit_b32 v208, v219, v218, 16
v_alignbit_b32 v209, v220, v219, 16
v_mfma_f32_16x16x32_bf16 v[76:79], a[248:251], v[156:159], v[76:79]
ds_read_b128 v[144:147], v24 offset:51200
v_alignbit_b32 v210, v221, v220, 16
v_mfma_f32_16x16x32_bf16 v[80:83], a[252:255], v[156:159], v[80:83]
v_alignbit_b32 v211, v222, v221, 16
v_alignbit_b32 v10, v220, v219, 16
v_mfma_f32_16x16x32_bf16 v[68:71], v[224:227], v[160:163], v[68:71]
ds_read_b128 v[148:151], v23 offset:41984
v_alignbit_b32 v11, v221, v220, 16
v_mfma_f32_16x16x32_bf16 v[72:75], v[228:231], v[160:163], v[72:75]
buffer_load_dwordx4 v3, s[64:67], s97 offen offset:512 lds
v_alignbit_b32 v12, v222, v221, 16
v_mfma_f32_16x16x32_bf16 v[76:79], v[232:235], v[160:163], v[76:79]
ds_read_b128 v[152:155], v24 offset:41984
v_alignbit_b32 v13, v223, v222, 16
v_mfma_f32_16x16x32_bf16 v[80:83], v[236:239], v[160:163], v[80:83]
ds_write_b128 v20, v[208:211] offset:9792
v_mfma_f32_16x16x32_bf16 v[68:71], v[240:243], v[164:167], v[68:71]
ds_write_b128 v20, v[10:13] offset:18112
v_mfma_f32_16x16x32_bf16 v[72:75], v[244:247], v[164:167], v[72:75]
v_rcp_f32 v35, v35
v_mfma_f32_16x16x32_bf16 v[76:79], v[248:251], v[164:167], v[76:79]
v_mul_f32 v43, v43, v35
v_cvt_pk_bf16_f32 v47, v42, v43
v_mfma_f32_16x16x32_bf16 v[80:83], v[252:255], v[164:167], v[80:83]
s_waitcnt lgkmcnt(6)
buffer_store_dwordx4 v[44:47], v25, s[12:15], s32 offen sc1
s_add_u32 s32, s32, 147456
s_cmp_eq_u32 s32, s61
v_mfma_f32_16x16x32_bf16 v[84:87], a[0:3], v[132:135], 0
ds_read_b128 v[156:159], v23 offset:52224
s_cselect_b32 s32, s59, s32
v_mfma_f32_16x16x32_bf16 v[88:91], a[4:7], v[132:135], 0
v_mfma_f32_16x16x32_bf16 v[92:95], a[8:11], v[132:135], 0
buffer_load_dwordx4 v4, s[64:67], s97 offen offset:1568 lds
v_mul_f32 v28, v68, v68
v_mfma_f32_16x16x32_bf16 v[96:99], a[12:15], v[132:135], 0
v_mul_f32 v29, v69, v69
v_fma_f32 v28, v28, s35, v26
v_mfma_f32_16x16x32_bf16 v[84:87], a[16:19], v[136:139], v[84:87]
ds_read_b128 v[160:163], v24 offset:52224
v_fma_f32 v29, v29, s35, v26
v_mfma_f32_16x16x32_bf16 v[88:91], a[20:23], v[136:139], v[88:91]
v_mul_f32 v28, v68, v28
v_mul_f32 v29, v69, v29
v_mfma_f32_16x16x32_bf16 v[92:95], a[24:27], v[136:139], v[92:95]
v_exp_f32 v28, v28
v_mfma_f32_16x16x32_bf16 v[96:99], a[28:31], v[136:139], v[96:99]
s_waitcnt lgkmcnt(6)
v_exp_f32 v29, v29
v_mfma_f32_16x16x32_bf16 v[84:87], a[32:35], v[140:143], v[84:87]
ds_read_b128 v[164:167], v23 offset:43008
ds_read_b128 v[218:221], v20 offset:6656
v_mfma_f32_16x16x32_bf16 v[88:91], a[36:39], v[140:143], v[88:91]
ds_read_b64 v[222:223], v20 offset:6672
v_mul_f32 v36, v68, v76
v_mfma_f32_16x16x32_bf16 v[92:95], a[40:43], v[140:143], v[92:95]
buffer_load_dwordx4 v5, s[64:67], s97 offen offset:2624 lds
v_mul_f32 v37, v69, v77
v_mfma_f32_16x16x32_bf16 v[96:99], a[44:47], v[140:143], v[96:99]
v_add_f32 v28, 1.0, v28
v_add_f32 v29, 1.0, v29
v_mfma_f32_16x16x32_bf16 v[84:87], a[48:51], v[144:147], v[84:87]
ds_read_b128 v[132:135], v24 offset:43008
v_mul_f32 v30, v70, v70
v_mfma_f32_16x16x32_bf16 v[88:91], a[52:55], v[144:147], v[88:91]
v_rcp_f32 v28, v28
v_mfma_f32_16x16x32_bf16 v[92:95], a[56:59], v[144:147], v[92:95]
s_waitcnt lgkmcnt(1)
v_alignbit_b32 v208, v219, v218, 16
v_alignbit_b32 v209, v220, v219, 16
v_mfma_f32_16x16x32_bf16 v[96:99], a[60:63], v[144:147], v[96:99]
v_alignbit_b32 v210, v221, v220, 16
v_alignbit_b32 v211, v222, v221, 16
v_mfma_f32_16x16x32_bf16 v[84:87], a[64:67], v[148:151], v[84:87]
ds_read_b128 v[136:139], v23 offset:53248
v_alignbit_b32 v10, v220, v219, 16
v_mfma_f32_16x16x32_bf16 v[88:91], a[68:71], v[148:151], v[88:91]
ds_write_b128 v20, v[208:211] offset:10816
v_mfma_f32_16x16x32_bf16 v[92:95], a[72:75], v[148:151], v[92:95]
v_alignbit_b32 v11, v221, v220, 16
v_alignbit_b32 v12, v222, v221, 16
v_mfma_f32_16x16x32_bf16 v[96:99], a[76:79], v[148:151], v[96:99]
buffer_load_dwordx4 v6, s[64:67], s97 offen offset:3680 lds
v_alignbit_b32 v13, v223, v222, 16
v_mfma_f32_16x16x32_bf16 v[84:87], a[80:83], v[152:155], v[84:87]
ds_read_b128 v[140:143], v24 offset:53248
v_mul_f32 v36, v36, v28
v_mfma_f32_16x16x32_bf16 v[88:91], a[84:87], v[152:155], v[88:91]
ds_write_b128 v20, v[10:13] offset:19136
v_mfma_f32_16x16x32_bf16 v[92:95], a[88:91], v[152:155], v[92:95]
v_rcp_f32 v29, v29
v_mfma_f32_16x16x32_bf16 v[96:99], a[92:95], v[152:155], v[96:99]
v_mul_f32 v37, v37, v29
v_mul_f32 v31, v71, v71
v_mfma_f32_16x16x32_bf16 v[84:87], a[96:99], v[156:159], v[84:87]
ds_read_b128 v[144:147], v23 offset:44032
v_fma_f32 v30, v30, s35, v26
v_mfma_f32_16x16x32_bf16 v[88:91], a[100:103], v[156:159], v[88:91]
v_fma_f32 v31, v31, s35, v26
v_mul_f32 v30, v70, v30
v_mfma_f32_16x16x32_bf16 v[92:95], a[104:107], v[156:159], v[92:95]
v_mul_f32 v31, v71, v31
v_mul_f32 v38, v70, v78
v_mfma_f32_16x16x32_bf16 v[96:99], a[108:111], v[156:159], v[96:99]
buffer_load_dword v8, v7, s[12:15], 0 offen sc1
v_mul_f32 v39, v71, v79
v_mfma_f32_16x16x32_bf16 v[84:87], a[112:115], v[160:163], v[84:87]
ds_read_b128 v[148:151], v24 offset:44032
v_cvt_pk_bf16_f32 v44, v36, v37
v_mfma_f32_16x16x32_bf16 v[88:91], a[116:119], v[160:163], v[88:91]
v_exp_f32 v30, v30
v_mfma_f32_16x16x32_bf16 v[92:95], a[120:123], v[160:163], v[92:95]
v_exp_f32 v31, v31
v_mfma_f32_16x16x32_bf16 v[96:99], a[124:127], v[160:163], v[96:99]
s_waitcnt lgkmcnt(6)
v_add_f32 v30, 1.0, v30
v_add_f32 v31, 1.0, v31
v_mfma_f32_16x16x32_bf16 v[84:87], a[128:131], v[164:167], v[84:87]
ds_read_b128 v[152:155], v23 offset:54272
v_mul_f32 v32, v72, v72
v_mfma_f32_16x16x32_bf16 v[88:91], a[132:135], v[164:167], v[88:91]
v_rcp_f32 v30, v30
v_mfma_f32_16x16x32_bf16 v[92:95], a[136:139], v[164:167], v[92:95]
ds_read_b128 v[218:221], v20 offset:7680
ds_read_b64 v[222:223], v20 offset:7696
v_mfma_f32_16x16x32_bf16 v[96:99], a[140:143], v[164:167], v[96:99]
v_rcp_f32 v31, v31
v_mfma_f32_16x16x32_bf16 v[84:87], a[144:147], v[132:135], v[84:87]
ds_read_b128 v[156:159], v24 offset:54272
v_mul_f32 v38, v38, v30
v_mfma_f32_16x16x32_bf16 v[88:91], a[148:151], v[132:135], v[88:91]
v_mul_f32 v39, v39, v31
v_mul_f32 v33, v73, v73
v_mfma_f32_16x16x32_bf16 v[92:95], a[152:155], v[132:135], v[92:95]
v_fma_f32 v32, v32, s35, v26
v_fma_f32 v33, v33, s35, v26
v_mfma_f32_16x16x32_bf16 v[96:99], a[156:159], v[132:135], v[96:99]
s_waitcnt lgkmcnt(7)
v_mul_f32 v32, v72, v32
v_mul_f32 v33, v73, v33
v_mfma_f32_16x16x32_bf16 v[84:87], a[160:163], v[136:139], v[84:87]
ds_read_b128 v[160:163], v23 offset:45056
v_mul_f32 v40, v72, v80
v_mfma_f32_16x16x32_bf16 v[88:91], a[164:167], v[136:139], v[88:91]
s_waitcnt lgkmcnt(2)
v_alignbit_b32 v208, v219, v218, 16
v_alignbit_b32 v209, v220, v219, 16
v_mfma_f32_16x16x32_bf16 v[92:95], a[168:171], v[136:139], v[92:95]
v_alignbit_b32 v210, v221, v220, 16
v_alignbit_b32 v211, v222, v221, 16
v_mfma_f32_16x16x32_bf16 v[96:99], a[172:175], v[136:139], v[96:99]
ds_write_b128 v20, v[208:211] offset:11840
v_mfma_f32_16x16x32_bf16 v[84:87], a[176:179], v[140:143], v[84:87]
ds_read_b128 v[164:167], v24 offset:45056
v_alignbit_b32 v10, v220, v219, 16
v_mfma_f32_16x16x32_bf16 v[88:91], a[180:183], v[140:143], v[88:91]
v_alignbit_b32 v11, v221, v220, 16
v_alignbit_b32 v12, v222, v221, 16
v_mfma_f32_16x16x32_bf16 v[92:95], a[184:187], v[140:143], v[92:95]
v_alignbit_b32 v13, v223, v222, 16
v_mul_f32 v41, v73, v81
v_mfma_f32_16x16x32_bf16 v[96:99], a[188:191], v[140:143], v[96:99]
ds_write_b128 v20, v[10:13] offset:20160
v_mfma_f32_16x16x32_bf16 v[84:87], a[192:195], v[144:147], v[84:87]
v_exp_f32 v32, v32
v_mfma_f32_16x16x32_bf16 v[88:91], a[196:199], v[144:147], v[88:91]
v_exp_f32 v33, v33
v_mfma_f32_16x16x32_bf16 v[92:95], a[200:203], v[144:147], v[92:95]
v_add_f32 v32, 1.0, v32
v_add_f32 v33, 1.0, v33
v_mfma_f32_16x16x32_bf16 v[96:99], a[204:207], v[144:147], v[96:99]
v_rcp_f32 v32, v32
v_mfma_f32_16x16x32_bf16 v[84:87], a[208:211], v[148:151], v[84:87]
v_rcp_f32 v33, v33
v_mfma_f32_16x16x32_bf16 v[88:91], a[212:215], v[148:151], v[88:91]
v_cvt_pk_bf16_f32 v45, v38, v39
v_mul_f32 v40, v40, v32
v_mfma_f32_16x16x32_bf16 v[92:95], a[216:219], v[148:151], v[92:95]
s_waitcnt lgkmcnt(1)
s_barrier
v_mfma_f32_16x16x32_bf16 v[96:99], a[220:223], v[148:151], v[96:99]
v_mul_f32 v41, v41, v33
v_mul_f32 v34, v74, v74
v_mfma_f32_16x16x32_bf16 v[84:87], a[224:227], v[152:155], v[84:87]
s_add_u32 m0, s54, 40960
s_add_u32 s97, s47, 36864
v_mul_f32 v35, v75, v75
v_mfma_f32_16x16x32_bf16 v[88:91], a[228:231], v[152:155], v[88:91]
buffer_load_dwordx4 v2, s[12:15], s97 offen sc1 lds
v_fma_f32 v34, v34, s35, v26
v_mfma_f32_16x16x32_bf16 v[92:95], a[232:235], v[152:155], v[92:95]
v_fma_f32 v35, v35, s35, v26
v_mul_f32 v34, v74, v34
v_mfma_f32_16x16x32_bf16 v[96:99], a[236:239], v[152:155], v[96:99]
buffer_load_dwordx4 v3, s[64:67], s97 offen offset:512 lds
v_mul_f32 v35, v75, v35
v_mfma_f32_16x16x32_bf16 v[84:87], a[240:243], v[156:159], v[84:87]
v_exp_f32 v34, v34
v_mfma_f32_16x16x32_bf16 v[88:91], a[244:247], v[156:159], v[88:91]
v_exp_f32 v35, v35
v_mfma_f32_16x16x32_bf16 v[92:95], a[248:251], v[156:159], v[92:95]
buffer_load_dwordx4 v4, s[64:67], s97 offen offset:1568 lds
v_mul_f32 v42, v74, v82
v_mfma_f32_16x16x32_bf16 v[96:99], a[252:255], v[156:159], v[96:99]
v_mul_f32 v43, v75, v83
v_add_f32 v34, 1.0, v34
v_mfma_f32_16x16x32_bf16 v[84:87], v[224:227], v[160:163], v[84:87]
v_add_f32 v35, 1.0, v35
v_cvt_pk_bf16_f32 v46, v40, v41
v_mfma_f32_16x16x32_bf16 v[88:91], v[228:231], v[160:163], v[88:91]
buffer_load_dwordx4 v5, s[64:67], s97 offen offset:2624 lds
v_mfma_f32_16x16x32_bf16 v[92:95], v[232:235], v[160:163], v[92:95]
v_rcp_f32 v34, v34
v_mfma_f32_16x16x32_bf16 v[96:99], v[236:239], v[160:163], v[96:99]
v_rcp_f32 v35, v35
v_mfma_f32_16x16x32_bf16 v[84:87], v[240:243], v[164:167], v[84:87]
buffer_load_dwordx4 v6, s[64:67], s97 offen offset:3680 lds
v_mul_f32 v42, v42, v34
v_mfma_f32_16x16x32_bf16 v[88:91], v[244:247], v[164:167], v[88:91]
v_mul_f32 v43, v43, v35
v_cvt_pk_bf16_f32 v47, v42, v43
v_mfma_f32_16x16x32_bf16 v[92:95], v[248:251], v[164:167], v[92:95]
buffer_store_dwordx4 v[44:47], v25, s[12:15], s32 offen sc1
s_add_u32 s32, s32, 147456
s_cmp_eq_u32 s32, s61
v_mfma_f32_16x16x32_bf16 v[96:99], v[252:255], v[164:167], v[96:99]
s_cselect_b32 s32, s59, s32
v_add_u32 v49, 7, v48
s_waitcnt vmcnt(10)
buffer_store_dword v49, v27, s[12:15], s93 offen sc1
s_cmp_lt_u32 s26, 4
s_cbranch_scc1 A_conv
A_nc:
ds_read_b64_tr_b16 a[0:1], v14 offset:0
ds_read_b64_tr_b16 a[4:5], v14 offset:32
ds_read_b64_tr_b16 a[8:9], v14 offset:64
ds_read_b64_tr_b16 a[12:13], v14 offset:96
ds_read_b64_tr_b16 a[16:17], v15 offset:128
ds_read_b64_tr_b16 a[20:21], v15 offset:160
ds_read_b64_tr_b16 a[24:25], v15 offset:192
ds_read_b64_tr_b16 a[28:29], v15 offset:224
ds_read_b64_tr_b16 a[32:33], v16 offset:0
ds_read_b64_tr_b16 a[74:75], v17 offset:0
ds_read_b64_tr_b16 a[78:79], v17 offset:32
ds_read_b64_tr_b16 a[82:83], v17 offset:64
ds_read_b64_tr_b16 a[86:87], v17 offset:96
ds_read_b64_tr_b16 a[90:91], v18 offset:128
ds_read_b64_tr_b16 a[94:95], v18 offset:160
ds_read_b64_tr_b16 a[98:99], v18 offset:192
ds_read_b64_tr_b16 a[102:103], v18 offset:224
ds_read_b64_tr_b16 a[106:107], v19 offset:0
s_add_u32 m0, s95, 0
s_add_u32 s97, s96, 221184
s_waitcnt lgkmcnt(9)
buffer_load_dwordx4 v2, s[12:15], s97 offen sc1 lds
buffer_load_dwordx4 v3, s[64:67], s97 offen offset:512 lds
buffer_load_dwordx4 v4, s[64:67], s97 offen offset:1568 lds
buffer_load_dwordx4 v5, s[64:67], s97 offen offset:2624 lds
buffer_load_dwordx4 v6, s[64:67], s97 offen offset:3680 lds
s_waitcnt vmcnt(13)
ds_read_b64_tr_b16 a[108:109], v17 offset:20480
ds_read_b64_tr_b16 a[112:113], v17 offset:20512
ds_read_b64_tr_b16 a[116:117], v17 offset:20544
ds_read_b64_tr_b16 a[120:121], v17 offset:20576
ds_read_b64_tr_b16 a[124:125], v18 offset:20608
ds_read_b64_tr_b16 a[128:129], v18 offset:20640
ds_read_b64_tr_b16 a[132:133], v18 offset:20672
ds_read_b64_tr_b16 a[136:137], v18 offset:20704
ds_read_b64_tr_b16 a[140:141], v19 offset:20480
s_add_u32 m0, s54, 0
s_add_u32 s97, s96, 239616
s_waitcnt lgkmcnt(9)
buffer_load_dwordx4 v2, s[12:15], s97 offen sc1 lds
buffer_load_dwordx4 v3, s[64:67], s97 offen offset:512 lds
buffer_load_dwordx4 v4, s[64:67], s97 offen offset:1568 lds
buffer_load_dwordx4 v5, s[64:67], s97 offen offset:2624 lds
buffer_load_dwordx4 v6, s[64:67], s97 offen offset:3680 lds
ds_read_b64_tr_b16 a[2:3], v14 offset:5120
ds_read_b64_tr_b16 a[6:7], v14 offset:5152
ds_read_b64_tr_b16 a[10:11], v14 offset:5184
ds_read_b64_tr_b16 a[14:15], v14 offset:5216
ds_read_b64_tr_b16 a[18:19], v15 offset:5248
ds_read_b64_tr_b16 a[22:23], v15 offset:5280
ds_read_b64_tr_b16 a[26:27], v15 offset:5312
ds_read_b64_tr_b16 a[30:31], v15 offset:5344
ds_read_b64_tr_b16 a[34:35], v16 offset:5120
s_add_u32 m0, s54, 20480
s_add_u32 s97, s96, 258048
s_waitcnt lgkmcnt(9)
buffer_load_dwordx4 v2, s[12:15], s97 offen sc1 lds
buffer_load_dwordx4 v3, s[64:67], s97 offen offset:512 lds
buffer_load_dwordx4 v4, s[64:67], s97 offen offset:1568 lds
buffer_load_dwordx4 v5, s[64:67], s97 offen offset:2624 lds
buffer_load_dwordx4 v6, s[64:67], s97 offen offset:3680 lds
ds_read_b64_tr_b16 a[36:37], v14 offset:10240
ds_read_b64_tr_b16 a[40:41], v14 offset:10272
ds_read_b64_tr_b16 a[44:45], v14 offset:10304
ds_read_b64_tr_b16 a[48:49], v14 offset:10336
ds_read_b64_tr_b16 a[52:53], v15 offset:10368
ds_read_b64_tr_b16 a[56:57], v15 offset:10400
ds_read_b64_tr_b16 a[60:61], v15 offset:10432
ds_read_b64_tr_b16 a[64:65], v15 offset:10464
ds_read_b64_tr_b16 a[68:69], v16 offset:10240
s_mul_i32 s40, s56, 36
s_mul_i32 s41, s24, 9
s_add_u32 s40, s40, s41
s_lshl_b32 s28, s40, 10
s_mul_i32 s40, s57, 1179648
s_add_u32 s28, s28, s40
s_add_u32 s30, s56, 1
s_and_b32 s30, s30, 3
s_mul_i32 s29, s30, 294912
s_add_u32 s29, s29, s28
v_lshlrev_b32 v9, 4, v0
v_add_u32 v10, 4096, v9
v_add_u32 v11, 8192, v9
s_add_u32 s63, s92, 6
s_waitcnt vmcnt(22)
v_subrev_u32 v60, s63, v8
v_cmp_lt_u32 vcc, 7, v60
s_and_b64 vcc, vcc, 262143
s_cbranch_vccnz A_c1
A_c1_r:
buffer_load_dwordx4 v[132:135], v9, s[12:15], s29 offen offset:0 sc1
buffer_load_dwordx4 v[136:139], v9, s[12:15], s29 offen offset:1024 sc1
buffer_load_dwordx4 v[140:143], v9, s[12:15], s29 offen offset:2048 sc1
buffer_load_dwordx4 v[144:147], v9, s[12:15], s29 offen offset:3072 sc1
buffer_load_dwordx4 v[148:151], v10, s[12:15], s29 offen offset:0 sc1
buffer_load_dwordx4 v[152:155], v10, s[12:15], s29 offen offset:1024 sc1
buffer_load_dwordx4 v[156:159], v10, s[12:15], s29 offen offset:2048 sc1
buffer_load_dwordx4 v[160:163], v10, s[12:15], s29 offen offset:3072 sc1
buffer_load_dwordx4 v[164:167], v11, s[12:15], s29 offen offset:0 sc1
s_add_u32 s29, s29, 147456
buffer_load_dword v8, v7, s[12:15], 0 offen sc1
s_waitcnt vmcnt(27)
ds_read_b64_tr_b16 a[110:111], v17 offset:40960
ds_read_b64_tr_b16 a[114:115], v17 offset:40992
ds_read_b64_tr_b16 a[118:119], v17 offset:41024
ds_read_b64_tr_b16 a[122:123], v17 offset:41056
ds_read_b64_tr_b16 a[126:127], v18 offset:41088
ds_read_b64_tr_b16 a[130:131], v18 offset:41120
ds_read_b64_tr_b16 a[134:135], v18 offset:41152
ds_read_b64_tr_b16 a[138:139], v18 offset:41184
ds_read_b64_tr_b16 a[142:143], v19 offset:40960
ds_read_b64_tr_b16 a[38:39], v14 offset:15360
ds_read_b64_tr_b16 a[42:43], v14 offset:15392
ds_read_b64_tr_b16 a[46:47], v14 offset:15424
ds_read_b64_tr_b16 a[50:51], v14 offset:15456
ds_read_b64_tr_b16 a[54:55], v15 offset:15488
ds_read_b64_tr_b16 a[58:59], v15 offset:15520
ds_read_b64_tr_b16 a[62:63], v15 offset:15552
ds_read_b64_tr_b16 a[66:67], v15 offset:15584
ds_read_b64_tr_b16 a[70:71], v16 offset:15360
s_add_u32 m0, s54, 40960
s_add_u32 s97, s96, 276480
s_waitcnt lgkmcnt(9)
buffer_load_dwordx4 v2, s[12:15], s97 offen sc1 lds
buffer_load_dwordx4 v3, s[64:67], s97 offen offset:512 lds
buffer_load_dwordx4 v4, s[64:67], s97 offen offset:1568 lds
buffer_load_dwordx4 v5, s[64:67], s97 offen offset:2624 lds
buffer_load_dwordx4 v6, s[64:67], s97 offen offset:3680 lds
ds_read_b64_tr_b16 a[72:73], v14 offset:20480
ds_read_b64_tr_b16 a[76:77], v14 offset:20512
ds_read_b64_tr_b16 a[80:81], v14 offset:20544
ds_read_b64_tr_b16 a[84:85], v14 offset:20576
ds_read_b64_tr_b16 a[88:89], v15 offset:20608
ds_read_b64_tr_b16 a[92:93], v15 offset:20640
ds_read_b64_tr_b16 a[96:97], v15 offset:20672
ds_read_b64_tr_b16 a[100:101], v15 offset:20704
ds_read_b64_tr_b16 a[104:105], v16 offset:20480
buffer_load_dwordx4 v[208:211], v9, s[12:15], s29 offen offset:0 sc1
buffer_load_dwordx4 v[212:215], v9, s[12:15], s29 offen offset:1024 sc1
buffer_load_dwordx4 v[216:219], v9, s[12:15], s29 offen offset:2048 sc1
buffer_load_dwordx4 v[220:223], v9, s[12:15], s29 offen offset:3072 sc1
buffer_load_dwordx4 v[224:227], v10, s[12:15], s29 offen offset:0 sc1
buffer_load_dwordx4 v[228:231], v10, s[12:15], s29 offen offset:1024 sc1
buffer_load_dwordx4 v[232:235], v10, s[12:15], s29 offen offset:2048 sc1
buffer_load_dwordx4 v[236:239], v10, s[12:15], s29 offen offset:3072 sc1
buffer_load_dwordx4 v[240:243], v11, s[12:15], s29 offen offset:0 sc1
s_cmp_eq_u32 s3, 63
s_cbranch_scc1 A_ne
v_pk_mul_f32 v[28:29], v[84:85], v[84:85]
v_pk_mul_f32 v[30:31], v[86:87], v[86:87]
v_pk_mul_f32 v[32:33], v[88:89], v[88:89]
v_pk_mul_f32 v[34:35], v[90:91], v[90:91]
v_pk_fma_f32 v[28:29], v[28:29], s[34:35], v[26:27] op_sel:[0,1,0] op_sel_hi:[1,1,0]
v_pk_fma_f32 v[30:31], v[30:31], s[34:35], v[26:27] op_sel:[0,1,0] op_sel_hi:[1,1,0]
v_pk_fma_f32 v[32:33], v[32:33], s[34:35], v[26:27] op_sel:[0,1,0] op_sel_hi:[1,1,0]
v_pk_fma_f32 v[34:35], v[34:35], s[34:35], v[26:27] op_sel:[0,1,0] op_sel_hi:[1,1,0]
v_pk_mul_f32 v[28:29], v[84:85], v[28:29]
v_pk_mul_f32 v[30:31], v[86:87], v[30:31]
v_pk_mul_f32 v[32:33], v[88:89], v[32:33]
v_pk_mul_f32 v[34:35], v[90:91], v[34:35]
v_exp_f32 v28, v28
v_exp_f32 v29, v29
v_exp_f32 v30, v30
v_exp_f32 v31, v31
v_exp_f32 v32, v32
v_exp_f32 v33, v33
v_exp_f32 v34, v34
v_exp_f32 v35, v35
v_pk_mul_f32 v[36:37], v[84:85], v[92:93]
v_pk_mul_f32 v[38:39], v[86:87], v[94:95]
v_pk_mul_f32 v[40:41], v[88:89], v[96:97]
v_pk_mul_f32 v[42:43], v[90:91], v[98:99]
v_pk_add_f32 v[28:29], v[28:29], 1.0 op_sel_hi:[1,0]
v_pk_add_f32 v[30:31], v[30:31], 1.0 op_sel_hi:[1,0]
v_pk_add_f32 v[32:33], v[32:33], 1.0 op_sel_hi:[1,0]
v_pk_add_f32 v[34:35], v[34:35], 1.0 op_sel_hi:[1,0]
v_rcp_f32 v28, v28
v_rcp_f32 v29, v29
v_rcp_f32 v30, v30
v_rcp_f32 v31, v31
v_rcp_f32 v32, v32
v_rcp_f32 v33, v33
v_rcp_f32 v34, v34
v_rcp_f32 v35, v35
s_nop 0
v_pk_mul_f32 v[36:37], v[36:37], v[28:29]
v_pk_mul_f32 v[38:39], v[38:39], v[30:31]
v_pk_mul_f32 v[40:41], v[40:41], v[32:33]
v_pk_mul_f32 v[42:43], v[42:43], v[34:35]
v_cvt_pk_bf16_f32 v44, v36, v37
v_cvt_pk_bf16_f32 v45, v38, v39
v_cvt_pk_bf16_f32 v46, v40, v41
v_cvt_pk_bf16_f32 v47, v42, v43
buffer_store_dwordx4 v[44:47], v25, s[12:15], s32 offen sc1
A_ne:
s_waitcnt vmcnt(34)
ds_read_b64_tr_b16 a[144:145], v14 offset:0
ds_read_b64_tr_b16 a[148:149], v14 offset:32
ds_read_b64_tr_b16 a[152:153], v14 offset:64
ds_read_b64_tr_b16 a[156:157], v14 offset:96
ds_read_b64_tr_b16 a[160:161], v15 offset:128
ds_read_b64_tr_b16 a[164:165], v15 offset:160
ds_read_b64_tr_b16 a[168:169], v15 offset:192
ds_read_b64_tr_b16 a[172:173], v15 offset:224
ds_read_b64_tr_b16 a[176:177], v16 offset:0
s_waitcnt lgkmcnt(0)
C_start:
s_waitcnt vmcnt(23)
v_mfma_f32_16x16x32_bf16 v[28:31], v[100:103], v[132:135], 0
ds_read_b64_tr_b16 a[146:147], v17 offset:0
ds_read_b64_tr_b16 a[150:151], v17 offset:32
v_mfma_f32_16x16x32_bf16 v[32:35], v[104:107], v[132:135], 0
ds_read_b64_tr_b16 a[154:155], v17 offset:64
ds_read_b64_tr_b16 a[158:159], v17 offset:96
v_mfma_f32_16x16x32_bf16 v[36:39], v[108:111], v[132:135], 0
ds_read_b64_tr_b16 a[162:163], v18 offset:128
ds_read_b64_tr_b16 a[166:167], v18 offset:160
v_mfma_f32_16x16x32_bf16 v[40:43], v[112:115], v[132:135], 0
ds_read_b64_tr_b16 a[170:171], v18 offset:192
ds_read_b64_tr_b16 a[174:175], v18 offset:224
v_mfma_f32_16x16x32_bf16 v[44:47], v[116:119], v[132:135], 0
ds_read_b64_tr_b16 a[178:179], v19 offset:0
ds_read_b64_tr_b16 a[180:181], v17 offset:20480
v_mfma_f32_16x16x32_bf16 v[48:51], v[120:123], v[132:135], 0
ds_read_b64_tr_b16 a[184:185], v17 offset:20512
ds_read_b64_tr_b16 a[188:189], v17 offset:20544
v_mfma_f32_16x16x32_bf16 v[52:55], v[124:127], v[132:135], 0
ds_read_b64_tr_b16 a[192:193], v17 offset:20576
ds_read_b64_tr_b16 a[196:197], v18 offset:20608
v_mfma_f32_16x16x32_bf16 v[56:59], v[128:131], v[132:135], 0
ds_read_b64_tr_b16 a[200:201], v18 offset:20640
ds_read_b64_tr_b16 a[204:205], v18 offset:20672
v_mfma_f32_16x16x32_bf16 v[60:63], v[168:171], v[132:135], 0
s_waitcnt vmcnt(22)
ds_read_b64_tr_b16 a[208:209], v18 offset:20704
ds_read_b64_tr_b16 a[212:213], v19 offset:20480
v_mfma_f32_16x16x32_bf16 v[28:31], v[172:175], v[136:139], v[28:31]
v_mfma_f32_16x16x32_bf16 v[32:35], v[176:179], v[136:139], v[32:35]
v_mfma_f32_16x16x32_bf16 v[36:39], v[180:183], v[136:139], v[36:39]
s_add_u32 m0, s54, 0
s_add_u32 s97, s96, 294912
v_mfma_f32_16x16x32_bf16 v[40:43], v[184:187], v[136:139], v[40:43]
s_waitcnt lgkmcnt(9)
buffer_load_dwordx4 v2, s[12:15], s97 offen sc1 lds
v_mfma_f32_16x16x32_bf16 v[44:47], v[188:191], v[136:139], v[44:47]
v_mfma_f32_16x16x32_bf16 v[48:51], v[192:195], v[136:139], v[48:51]
buffer_load_dwordx4 v3, s[64:67], s97 offen offset:512 lds
v_mfma_f32_16x16x32_bf16 v[52:55], v[196:199], v[136:139], v[52:55]
v_mfma_f32_16x16x32_bf16 v[56:59], v[200:203], v[136:139], v[56:59]
v_mfma_f32_16x16x32_bf16 v[60:63], v[204:207], v[136:139], v[60:63]
s_waitcnt vmcnt(23)
v_mfma_f32_16x16x32_bf16 v[28:31], a[0:3], v[140:143], v[28:31]
buffer_load_dwordx4 v4, s[64:67], s97 offen offset:1568 lds
v_mfma_f32_16x16x32_bf16 v[32:35], a[4:7], v[140:143], v[32:35]
v_mfma_f32_16x16x32_bf16 v[36:39], a[8:11], v[140:143], v[36:39]
v_mfma_f32_16x16x32_bf16 v[40:43], a[12:15], v[140:143], v[40:43]
v_mfma_f32_16x16x32_bf16 v[44:47], a[16:19], v[140:143], v[44:47]
buffer_load_dwordx4 v5, s[64:67], s97 offen offset:2624 lds
v_mfma_f32_16x16x32_bf16 v[48:51], a[20:23], v[140:143], v[48:51]
v_mfma_f32_16x16x32_bf16 v[52:55], a[24:27], v[140:143], v[52:55]
v_mfma_f32_16x16x32_bf16 v[56:59], a[28:31], v[140:143], v[56:59]
v_mfma_f32_16x16x32_bf16 v[60:63], a[32:35], v[140:143], v[60:63]
s_waitcnt vmcnt(24)
buffer_load_dwordx4 v6, s[64:67], s97 offen offset:3680 lds
v_mfma_f32_16x16x32_bf16 v[28:31], a[36:39], v[144:147], v[28:31]
v_mfma_f32_16x16x32_bf16 v[32:35], a[40:43], v[144:147], v[32:35]
v_mfma_f32_16x16x32_bf16 v[36:39], a[44:47], v[144:147], v[36:39]
v_mfma_f32_16x16x32_bf16 v[40:43], a[48:51], v[144:147], v[40:43]
s_add_u32 m0, s54, 20480
s_add_u32 s97, s96, 313344
v_mfma_f32_16x16x32_bf16 v[44:47], a[52:55], v[144:147], v[44:47]
s_waitcnt lgkmcnt(0)
buffer_load_dwordx4 v2, s[12:15], s97 offen sc1 lds
v_mfma_f32_16x16x32_bf16 v[48:51], a[56:59], v[144:147], v[48:51]
v_mfma_f32_16x16x32_bf16 v[52:55], a[60:63], v[144:147], v[52:55]
v_mfma_f32_16x16x32_bf16 v[56:59], a[64:67], v[144:147], v[56:59]
buffer_load_dwordx4 v3, s[64:67], s97 offen offset:512 lds
v_mfma_f32_16x16x32_bf16 v[60:63], a[68:71], v[144:147], v[60:63]
s_waitcnt vmcnt(26)
v_mfma_f32_16x16x32_bf16 v[28:31], a[72:75], v[148:151], v[28:31]
v_mfma_f32_16x16x32_bf16 v[32:35], a[76:79], v[148:151], v[32:35]
v_mfma_f32_16x16x32_bf16 v[36:39], a[80:83], v[148:151], v[36:39]
buffer_load_dwordx4 v4, s[64:67], s97 offen offset:1568 lds
v_mfma_f32_16x16x32_bf16 v[40:43], a[84:87], v[148:151], v[40:43]
v_mfma_f32_16x16x32_bf16 v[44:47], a[88:91], v[148:151], v[44:47]
v_mfma_f32_16x16x32_bf16 v[48:51], a[92:95], v[148:151], v[48:51]
v_mfma_f32_16x16x32_bf16 v[52:55], a[96:99], v[148:151], v[52:55]
buffer_load_dwordx4 v5, s[64:67], s97 offen offset:2624 lds
v_mfma_f32_16x16x32_bf16 v[56:59], a[100:103], v[148:151], v[56:59]
v_mfma_f32_16x16x32_bf16 v[60:63], a[104:107], v[148:151], v[60:63]
s_waitcnt vmcnt(27)
v_mfma_f32_16x16x32_bf16 v[28:31], a[108:111], v[152:155], v[28:31]
v_mfma_f32_16x16x32_bf16 v[32:35], a[112:115], v[152:155], v[32:35]
buffer_load_dwordx4 v6, s[64:67], s97 offen offset:3680 lds
v_mfma_f32_16x16x32_bf16 v[36:39], a[116:119], v[152:155], v[36:39]
s_add_u32 s63, s92, 7
s_waitcnt vmcnt(24)
v_subrev_u32 v244, s63, v8
v_mfma_f32_16x16x32_bf16 v[40:43], a[120:123], v[152:155], v[40:43]
v_cmp_lt_u32 vcc, 7, v244
s_and_b64 vcc, vcc, 262143
v_mfma_f32_16x16x32_bf16 v[44:47], a[124:127], v[152:155], v[44:47]
s_cbranch_vccnz C_s1
C_r1:
v_mfma_f32_16x16x32_bf16 v[48:51], a[128:131], v[152:155], v[48:51]
s_mul_i32 s37, s30, 1966080
s_add_u32 s30, s30, 1
s_and_b32 s30, s30, 3
v_mfma_f32_16x16x32_bf16 v[52:55], a[132:135], v[152:155], v[52:55]
s_mul_i32 s29, s30, 294912
s_add_u32 s29, s29, s28
v_mov_b32 v12, s92
v_mfma_f32_16x16x32_bf16 v[56:59], a[136:139], v[152:155], v[56:59]
buffer_load_dwordx4 v[132:135], v9, s[12:15], s29 offen offset:0 sc1
s_bfe_u32 s48, s92, 0x80004
v_mfma_f32_16x16x32_bf16 v[60:63], a[140:143], v[152:155], v[60:63]
s_waitcnt vmcnt(19)
ds_read_b64_tr_b16 a[182:183], v17 offset:40960
v_mfma_f32_16x16x32_bf16 v[64:67], v[100:103], v[208:211], 0
s_lshl_b32 s52, s48, 8
ds_read_b64_tr_b16 a[186:187], v17 offset:40992
ds_read_b64_tr_b16 a[190:191], v17 offset:41024
v_mfma_f32_16x16x32_bf16 v[68:71], v[104:107], v[208:211], 0
ds_read_b64_tr_b16 a[194:195], v17 offset:41056
ds_read_b64_tr_b16 a[198:199], v18 offset:41088
v_add_u32 v12, 8, v12
v_mfma_f32_16x16x32_bf16 v[72:75], v[108:111], v[208:211], 0
s_mul_i32 s40, s24, 7168
ds_read_b64_tr_b16 a[202:203], v18 offset:41120
ds_read_b64_tr_b16 a[206:207], v18 offset:41152
v_lshl_add_u32 v23, v0, 3, s40
v_mfma_f32_16x16x32_bf16 v[76:79], v[112:115], v[208:211], 0
s_xor_b32 s40, s24, 1
ds_read_b64_tr_b16 a[210:211], v18 offset:41184
ds_read_b64_tr_b16 a[214:215], v19 offset:40960
s_mul_i32 s40, s40, 7168
v_mfma_f32_16x16x32_bf16 v[80:83], v[116:119], v[208:211], 0
buffer_load_dwordx4 v[136:139], v9, s[12:15], s29 offen offset:1024 sc1
v_lshl_add_u32 v2, v0, 3, s40
s_xor_b32 s40, s24, 2
v_mfma_f32_16x16x32_bf16 v[84:87], v[120:123], v[208:211], 0
s_mul_i32 s40, s40, 7168
v_lshl_add_u32 v3, v0, 3, s40
s_xor_b32 s40, s24, 3
v_mfma_f32_16x16x32_bf16 v[88:91], v[124:127], v[208:211], 0
s_mul_i32 s40, s40, 7168
v_lshl_add_u32 v4, v0, 3, s40
v_and_b32 v244, 15, v0
v_mfma_f32_16x16x32_bf16 v[92:95], v[128:131], v[208:211], 0
v_lshrrev_b32 v245, 4, v0
v_lshrrev_b32 v246, 2, v0
v_mfma_f32_16x16x32_bf16 v[96:99], v[168:171], v[208:211], 0
s_waitcnt vmcnt(19)
v_and_b32 v251, 3, v0
s_lshl_b32 s40, s24, 7
v_mfma_f32_16x16x32_bf16 v[64:67], v[172:175], v[212:215], v[64:67]
buffer_load_dwordx4 v[140:143], v9, s[12:15], s29 offen offset:2048 sc1
v_lshl_add_u32 v247, v246, 3, s40
v_mfma_f32_16x16x32_bf16 v[68:71], v[176:179], v[212:215], v[68:71]
v_and_b32 v248, 1, v0
v_lshl_add_u32 v247, v248, 2, v247
v_mfma_f32_16x16x32_bf16 v[72:75], v[180:183], v[212:215], v[72:75]
v_and_b32 v248, 2, v0
v_lshl_add_u32 v5, v248, 8, v247
v_mfma_f32_16x16x32_bf16 v[76:79], v[184:187], v[212:215], v[76:79]
v_lshlrev_b32 v6, 2, v0
s_lshl_b32 s40, s58, 2
v_mfma_f32_16x16x32_bf16 v[80:83], v[188:191], v[212:215], v[80:83]
s_add_u32 s40, s40, s24
s_lshl_b32 s49, s40, 3
v_add_u32 v245, s49, v245
v_mfma_f32_16x16x32_bf16 v[84:87], v[192:195], v[212:215], v[84:87]
buffer_load_dwordx4 v[144:147], v9, s[12:15], s29 offen offset:3072 sc1
s_add_u32 s40, s40, 128
v_mfma_f32_16x16x32_bf16 v[88:91], v[196:199], v[212:215], v[88:91]
v_mul_u32_u24 v247, 1152, v244
v_and_b32 v248, 16, v0
v_mfma_f32_16x16x32_bf16 v[92:95], v[200:203], v[212:215], v[92:95]
v_lshrrev_b32 v249, 1, v0
v_and_b32 v249, 16, v249
v_mfma_f32_16x16x32_bf16 v[96:99], v[204:207], v[212:215], v[96:99]
s_waitcnt vmcnt(20)
v_lshl_add_u32 v248, v248, 1, v249
s_lshl_b32 s51, s49, 3
v_mfma_f32_16x16x32_bf16 v[64:67], a[0:3], v[216:219], v[64:67]
v_add3_u32 v14, v247, v248, s51
v_mul_u32_u24 v248, 1152, v246
v_mfma_f32_16x16x32_bf16 v[68:71], a[4:7], v[216:219], v[68:71]
buffer_load_dwordx4 v[148:151], v10, s[12:15], s29 offen offset:0 sc1
v_lshl_add_u32 v249, v251, 4, v248
v_mfma_f32_16x16x32_bf16 v[72:75], a[8:11], v[216:219], v[72:75]
v_add_u32 v250, s51, v249
v_lshl_add_u32 v248, v251, 1, v248
v_mfma_f32_16x16x32_bf16 v[76:79], a[12:15], v[216:219], v[76:79]
v_lshl_add_u32 v15, s40, 3, v248
v_lshrrev_b32 v248, 1, v0
v_mfma_f32_16x16x32_bf16 v[80:83], a[16:19], v[216:219], v[80:83]
s_waitcnt vmcnt(10)
ds_read_b64_tr_b16 a[216:217], v17 offset:0
ds_read_b64_tr_b16 a[220:221], v17 offset:32
v_mfma_f32_16x16x32_bf16 v[84:87], a[20:23], v[216:219], v[84:87]
ds_read_b64_tr_b16 a[224:225], v17 offset:64
ds_read_b64_tr_b16 a[228:229], v17 offset:96
v_and_b32 v248, 24, v248
v_lshl_add_u32 v248, v244, 6, v248
v_mfma_f32_16x16x32_bf16 v[88:91], a[24:27], v[216:219], v[88:91]
s_lshl_b32 s51, s24, 11
ds_read_b64_tr_b16 a[232:233], v18 offset:128
ds_read_b64_tr_b16 a[236:237], v18 offset:160
s_add_u32 s51, s51, 94208
v_mfma_f32_16x16x32_bf16 v[92:95], a[28:31], v[216:219], v[92:95]
ds_read_b64_tr_b16 a[240:241], v18 offset:192
ds_read_b64_tr_b16 a[244:245], v18 offset:224
v_add_u32 v26, s51, v248
v_lshlrev_b32 v247, 3, v244
v_mfma_f32_16x16x32_bf16 v[96:99], a[32:35], v[216:219], v[96:99]
ds_read_b64_tr_b16 a[248:249], v19 offset:0
v_lshl_add_u32 v16, v245, 14, v247
v_lshlrev_b32 v247, 1, v0
v_mfma_f32_16x16x32_bf16 v[28:31], a[144:147], v[156:159], v[28:31]
buffer_load_dwordx4 v[152:155], v10, s[12:15], s29 offen offset:1024 sc1
v_lshl_add_u32 v247, s40, 14, v247
v_and_b32 v21, 60, v0
v_mfma_f32_16x16x32_bf16 v[32:35], a[148:151], v[156:159], v[32:35]
s_lshl_b32 s40, s57, 2
s_add_u32 s40, s40, s56
s_lshl_b32 s40, s40, 5
v_mfma_f32_16x16x32_bf16 v[36:39], a[152:155], v[156:159], v[36:39]
s_mul_i32 s38, s40, 1152
s_lshl_b32 s42, s40, 2
s_add_u32 s42, s42, 23666688
v_mfma_f32_16x16x32_bf16 v[40:43], a[156:159], v[156:159], v[40:43]
s_lshl_b32 s41, s40, 3
s_add_u32 s41, s41, 21307392
s_mov_b32 s31, 1
v_mfma_f32_16x16x32_bf16 v[44:47], a[160:163], v[156:159], v[44:47]
s_waitcnt vmcnt(6)
ds_read_b64_tr_b16 a[218:219], v17 offset:20480
ds_read_b64_tr_b16 a[222:223], v17 offset:20512
v_mfma_f32_16x16x32_bf16 v[48:51], a[164:167], v[156:159], v[48:51]
s_add_u32 s43, s92, 8
ds_read_b64_tr_b16 a[226:227], v17 offset:20544
ds_read_b64_tr_b16 a[230:231], v17 offset:20576
v_mfma_f32_16x16x32_bf16 v[52:55], a[168:171], v[156:159], v[52:55]
s_mov_b64 s[44:45], 0
ds_read_b64_tr_b16 a[234:235], v18 offset:20608
ds_read_b64_tr_b16 a[238:239], v18 offset:20640
v_mfma_f32_16x16x32_bf16 v[56:59], a[172:175], v[156:159], v[56:59]
s_mul_i32 s50, s3, 24
ds_read_b64_tr_b16 a[242:243], v18 offset:20672
ds_read_b64_tr_b16 a[246:247], v18 offset:20704
s_add_u32 s50, s50, s24
v_mfma_f32_16x16x32_bf16 v[60:63], a[176:179], v[156:159], v[60:63]
s_waitcnt lgkmcnt(15)
ds_read_b64_tr_b16 a[250:251], v19 offset:20480
s_mul_i32 s50, s50, 1280
s_add_u32 s50, s50, 24002560
v_mfma_f32_16x16x32_bf16 v[28:31], a[180:183], v[160:163], v[28:31]
s_mul_i32 s47, s56, 1966080
s_add_u32 s47, s47, s50
s_add_u32 s37, s37, s50
v_mfma_f32_16x16x32_bf16 v[32:35], a[184:187], v[160:163], v[32:35]
buffer_load_dwordx4 v[156:159], v10, s[12:15], s29 offen offset:2048 sc1
s_add_u32 s40, s38, 4096
v_mfma_f32_16x16x32_bf16 v[36:39], a[188:191], v[160:163], v[36:39]
s_add_u32 s49, s38, 21504
v_mov_b32 v17, v247
v_lshlrev_b32 v18, 2, v244
v_mfma_f32_16x16x32_bf16 v[40:43], a[192:195], v[160:163], v[40:43]
v_mfma_f32_16x16x32_bf16 v[44:47], a[196:199], v[160:163], v[44:47]
v_mfma_f32_16x16x32_bf16 v[48:51], a[200:203], v[160:163], v[48:51]
v_mfma_f32_16x16x32_bf16 v[52:55], a[204:207], v[160:163], v[52:55]
v_mfma_f32_16x16x32_bf16 v[56:59], a[208:211], v[160:163], v[56:59]
v_mfma_f32_16x16x32_bf16 v[60:63], a[212:215], v[160:163], v[60:63]
s_waitcnt lgkmcnt(0)
v_mfma_f32_16x16x32_bf16 v[28:31], a[216:219], v[164:167], v[28:31]
buffer_load_dwordx4 v[160:163], v10, s[12:15], s29 offen offset:3072 sc1
v_mfma_f32_16x16x32_bf16 v[32:35], a[220:223], v[164:167], v[32:35]
s_barrier
v_mfma_f32_16x16x32_bf16 v[36:39], a[224:227], v[164:167], v[36:39]
s_mov_b32 m0, s51
buffer_store_dword v12, v27, s[12:15], s94 offen sc1
v_mfma_f32_16x16x32_bf16 v[40:43], a[228:231], v[164:167], v[40:43]
buffer_load_dwordx4 v250, s[4:7], s40 offen lds
v_mfma_f32_16x16x32_bf16 v[44:47], a[232:235], v[164:167], v[44:47]
v_mfma_f32_16x16x32_bf16 v[48:51], a[236:239], v[164:167], v[48:51]
v_mfma_f32_16x16x32_bf16 v[52:55], a[240:243], v[164:167], v[52:55]
buffer_load_dwordx4 v250, s[4:7], s49 offen offset:1024 lds
v_mfma_f32_16x16x32_bf16 v[56:59], a[244:247], v[164:167], v[56:59]
v_mfma_f32_16x16x32_bf16 v[60:63], a[248:251], v[164:167], v[60:63]
v_mfma_f32_16x16x32_bf16 v[64:67], a[36:39], v[220:223], v[64:67]
buffer_load_dwordx4 v[164:167], v11, s[12:15], s29 offen offset:0 sc1
s_add_u32 s29, s29, 147456
v_mfma_f32_16x16x32_bf16 v[68:71], a[40:43], v[220:223], v[68:71]
ds_write_b64 v23, v[36:37] offset:0
v_mfma_f32_16x16x32_bf16 v[72:75], a[44:47], v[220:223], v[72:75]
ds_write_b64 v23, v[38:39] offset:512
v_mfma_f32_16x16x32_bf16 v[76:79], a[48:51], v[220:223], v[76:79]
ds_write_b64 v23, v[40:41] offset:1024
v_mfma_f32_16x16x32_bf16 v[80:83], a[52:55], v[220:223], v[80:83]
ds_write_b64 v23, v[42:43] offset:1536
v_mfma_f32_16x16x32_bf16 v[84:87], a[56:59], v[220:223], v[84:87]
ds_write_b64 v23, v[44:45] offset:2048
v_mfma_f32_16x16x32_bf16 v[88:91], a[60:63], v[220:223], v[88:91]
buffer_load_dwordx4 v[208:211], v9, s[12:15], s29 offen offset:0 sc1
v_mfma_f32_16x16x32_bf16 v[92:95], a[64:67], v[220:223], v[92:95]
ds_write_b64 v23, v[46:47] offset:2560
v_mfma_f32_16x16x32_bf16 v[96:99], a[68:71], v[220:223], v[96:99]
ds_write_b64 v23, v[48:49] offset:3072
v_mfma_f32_16x16x32_bf16 v[64:67], a[72:75], v[224:227], v[64:67]
ds_write_b64 v23, v[50:51] offset:3584
v_mfma_f32_16x16x32_bf16 v[68:71], a[76:79], v[224:227], v[68:71]
ds_write_b64 v23, v[52:53] offset:4096
v_mfma_f32_16x16x32_bf16 v[72:75], a[80:83], v[224:227], v[72:75]
ds_write_b64 v23, v[54:55] offset:4608
v_mfma_f32_16x16x32_bf16 v[76:79], a[84:87], v[224:227], v[76:79]
buffer_load_dwordx4 v[212:215], v9, s[12:15], s29 offen offset:1024 sc1
v_mfma_f32_16x16x32_bf16 v[80:83], a[88:91], v[224:227], v[80:83]
ds_write_b64 v23, v[56:57] offset:5120
v_mfma_f32_16x16x32_bf16 v[84:87], a[92:95], v[224:227], v[84:87]
ds_write_b64 v23, v[58:59] offset:5632
v_mfma_f32_16x16x32_bf16 v[88:91], a[96:99], v[224:227], v[88:91]
ds_write_b64 v23, v[60:61] offset:6144
v_mfma_f32_16x16x32_bf16 v[92:95], a[100:103], v[224:227], v[92:95]
ds_write_b64 v23, v[62:63] offset:6656
v_mfma_f32_16x16x32_bf16 v[96:99], a[104:107], v[224:227], v[96:99]
v_mfma_f32_16x16x32_bf16 v[64:67], a[108:111], v[228:231], v[64:67]
buffer_load_dwordx4 v[216:219], v9, s[12:15], s29 offen offset:2048 sc1
v_mfma_f32_16x16x32_bf16 v[68:71], a[112:115], v[228:231], v[68:71]
v_mfma_f32_16x16x32_bf16 v[72:75], a[116:119], v[228:231], v[72:75]
v_mfma_f32_16x16x32_bf16 v[76:79], a[120:123], v[228:231], v[76:79]
s_waitcnt lgkmcnt(0)
s_barrier
v_mfma_f32_16x16x32_bf16 v[80:83], a[124:127], v[228:231], v[80:83]
ds_read2st64_b64 v[244:247], v2 offset0:0 offset1:1
v_mfma_f32_16x16x32_bf16 v[84:87], a[128:131], v[228:231], v[84:87]
ds_read2st64_b64 v[248:251], v3 offset0:4 offset1:5
ds_read2st64_b64 v[252:255], v4 offset0:8 offset1:9
v_mfma_f32_16x16x32_bf16 v[88:91], a[132:135], v[228:231], v[88:91]
buffer_load_dwordx4 v[220:223], v9, s[12:15], s29 offen offset:3072 sc1
ds_read2st64_b64 v[36:39], v2 offset0:2 offset1:3
v_mfma_f32_16x16x32_bf16 v[92:95], a[136:139], v[228:231], v[92:95]
ds_read2st64_b64 v[40:43], v3 offset0:6 offset1:7
ds_read2st64_b64 v[44:47], v4 offset0:10 offset1:11
v_mfma_f32_16x16x32_bf16 v[96:99], a[140:143], v[228:231], v[96:99]
ds_read2st64_b32 v[60:61], v5 offset0:24 offset1:52
ds_read2st64_b32 v[62:63], v5 offset0:80 offset1:108
v_mfma_f32_16x16x32_bf16 v[64:67], a[144:147], v[232:235], v[64:67]
v_mfma_f32_16x16x32_bf16 v[68:71], a[148:151], v[232:235], v[68:71]
v_mfma_f32_16x16x32_bf16 v[72:75], a[152:155], v[232:235], v[72:75]
v_mfma_f32_16x16x32_bf16 v[76:79], a[156:159], v[232:235], v[76:79]
buffer_load_dwordx4 v[224:227], v10, s[12:15], s29 offen offset:0 sc1
v_mfma_f32_16x16x32_bf16 v[80:83], a[160:163], v[232:235], v[80:83]
s_waitcnt lgkmcnt(5)
v_add_f32 v244, v244, v248
v_mfma_f32_16x16x32_bf16 v[84:87], a[164:167], v[232:235], v[84:87]
v_add_f32 v245, v245, v249
v_add_f32 v246, v246, v250
v_mfma_f32_16x16x32_bf16 v[88:91], a[168:171], v[232:235], v[88:91]
v_add_f32 v247, v247, v251
v_add_f32 v28, v28, v252
v_mfma_f32_16x16x32_bf16 v[92:95], a[172:175], v[232:235], v[92:95]
v_add_f32 v29, v29, v253
v_add_f32 v30, v30, v254
v_mfma_f32_16x16x32_bf16 v[96:99], a[176:179], v[232:235], v[96:99]
v_add_f32 v31, v31, v255
v_add_f32 v28, v28, v244
v_mfma_f32_16x16x32_bf16 v[64:67], a[180:183], v[236:239], v[64:67]
buffer_load_dwordx4 v[228:231], v10, s[12:15], s29 offen offset:1024 sc1
v_add_f32 v29, v29, v245
v_mfma_f32_16x16x32_bf16 v[68:71], a[184:187], v[236:239], v[68:71]
v_add_f32 v30, v30, v246
v_add_f32 v31, v31, v247
v_mfma_f32_16x16x32_bf16 v[72:75], a[188:191], v[236:239], v[72:75]
s_waitcnt lgkmcnt(0)
v_add_f32 v36, v36, v40
v_add_f32 v37, v37, v41
v_mfma_f32_16x16x32_bf16 v[76:79], a[192:195], v[236:239], v[76:79]
v_add_f32 v38, v38, v42
v_add_f32 v39, v39, v43
v_mfma_f32_16x16x32_bf16 v[80:83], a[196:199], v[236:239], v[80:83]
v_add_f32 v32, v32, v44
v_add_f32 v33, v33, v45
v_mfma_f32_16x16x32_bf16 v[84:87], a[200:203], v[236:239], v[84:87]
v_add_f32 v34, v34, v46
v_add_f32 v35, v35, v47
v_mfma_f32_16x16x32_bf16 v[88:91], a[204:207], v[236:239], v[88:91]
buffer_load_dwordx4 v[232:235], v10, s[12:15], s29 offen offset:2048 sc1
v_add_f32 v32, v32, v36
v_mfma_f32_16x16x32_bf16 v[92:95], a[208:211], v[236:239], v[92:95]
v_add_f32 v33, v33, v37
v_add_f32 v34, v34, v38
v_mfma_f32_16x16x32_bf16 v[96:99], a[212:215], v[236:239], v[96:99]
v_add_f32 v35, v35, v39
v_add_f32 v60, v60, v61
v_mfma_f32_16x16x32_bf16 v[64:67], a[216:219], v[240:243], v[64:67]
v_add_f32 v62, v62, v63
v_add_f32 v60, v60, v62
v_mfma_f32_16x16x32_bf16 v[68:71], a[220:223], v[240:243], v[68:71]
v_cvt_pk_bf16_f32 v244, v28, v29
v_cvt_pk_bf16_f32 v245, v30, v31
v_mfma_f32_16x16x32_bf16 v[72:75], a[224:227], v[240:243], v[72:75]
v_cvt_pk_bf16_f32 v246, v32, v33
v_cvt_pk_bf16_f32 v247, v34, v35
v_mfma_f32_16x16x32_bf16 v[76:79], a[228:231], v[240:243], v[76:79]
buffer_load_dwordx4 v[236:239], v10, s[12:15], s29 offen offset:3072 sc1
v_cvt_pk_bf16_f32 v248, 0, v60
v_mfma_f32_16x16x32_bf16 v[80:83], a[232:235], v[240:243], v[80:83]
v_xor_b32 v244, s52, v244
v_bitop3_b32 v248, v248, v247, s48 bitop3:0x96
v_mfma_f32_16x16x32_bf16 v[84:87], a[236:239], v[240:243], v[84:87]
v_bitop3_b32 v249, v244, v245, v246 bitop3:0x96
v_xor_b32 v248, v248, v249
v_mfma_f32_16x16x32_bf16 v[88:91], a[240:243], v[240:243], v[88:91]
buffer_store_dwordx4 v[244:247], v9, s[12:15], s37 offen sc1
buffer_store_dword v248, v6, s[12:15], s37 offen offset:1024 sc1
v_mfma_f32_16x16x32_bf16 v[92:95], a[244:247], v[240:243], v[92:95]
v_mfma_f32_16x16x32_bf16 v[96:99], a[248:251], v[240:243], v[96:99]
buffer_load_dwordx4 v[240:243], v11, s[12:15], s29 offen offset:0 sc1
C_loop:
s_waitcnt vmcnt(21)
v_mfma_f32_16x16x32_bf16 v[28:31], v[100:103], v[132:135], 0
v_subrev_u32 v244, s43, v8
v_cmp_lt_u32 vcc, 7, v244
v_mfma_f32_16x16x32_bf16 v[32:35], v[104:107], v[132:135], 0
s_and_b64 vcc, vcc, s[44:45]
s_cbranch_vccnz C_s2
C_r2:
v_mfma_f32_16x16x32_bf16 v[36:39], v[108:111], v[132:135], 0
buffer_load_dword v8, v7, s[12:15], 0 offen sc1
s_mov_b32 s44, 0x3ffff
v_mfma_f32_16x16x32_bf16 v[40:43], v[112:115], v[132:135], 0
s_add_u32 s36, s37, 5120
s_mul_i32 s40, s30, 1966080
s_add_u32 s40, s40, s50
v_mfma_f32_16x16x32_bf16 v[44:47], v[116:119], v[132:135], 0
s_mul_i32 s49, s31, 10240
s_add_u32 s37, s40, s49
s_add_u32 s30, s30, 1
v_mfma_f32_16x16x32_bf16 v[48:51], v[120:123], v[132:135], 0
s_and_b32 s30, s30, 3
s_mul_i32 s29, s30, 294912
s_add_u32 s29, s29, s28
ds_write_b32 v23, v72 offset:28672
v_mfma_f32_16x16x32_bf16 v[52:55], v[124:127], v[132:135], 0
ds_write_b32 v23, v73 offset:28676
v_mfma_f32_16x16x32_bf16 v[56:59], v[128:131], v[132:135], 0
ds_write_b32 v23, v74 offset:29184
v_mfma_f32_16x16x32_bf16 v[60:63], v[168:171], v[132:135], 0
s_waitcnt vmcnt(21)
ds_write_b32 v23, v75 offset:29188
v_mfma_f32_16x16x32_bf16 v[28:31], v[172:175], v[136:139], v[28:31]
buffer_load_dwordx4 v[132:135], v9, s[12:15], s29 offen offset:0 sc1
ds_write_b32 v23, v76 offset:29696
v_mfma_f32_16x16x32_bf16 v[32:35], v[176:179], v[136:139], v[32:35]
ds_write_b32 v23, v77 offset:29700
v_mfma_f32_16x16x32_bf16 v[36:39], v[180:183], v[136:139], v[36:39]
ds_write_b32 v23, v78 offset:30208
v_mfma_f32_16x16x32_bf16 v[40:43], v[184:187], v[136:139], v[40:43]
ds_write_b32 v23, v79 offset:30212
v_mfma_f32_16x16x32_bf16 v[44:47], v[188:191], v[136:139], v[44:47]
ds_write_b32 v23, v80 offset:30720
v_mfma_f32_16x16x32_bf16 v[48:51], v[192:195], v[136:139], v[48:51]
ds_write_b32 v23, v81 offset:30724
v_mfma_f32_16x16x32_bf16 v[52:55], v[196:199], v[136:139], v[52:55]
ds_write_b32 v23, v82 offset:31232
v_mfma_f32_16x16x32_bf16 v[56:59], v[200:203], v[136:139], v[56:59]
ds_write_b32 v23, v83 offset:31236
v_mfma_f32_16x16x32_bf16 v[60:63], v[204:207], v[136:139], v[60:63]
s_waitcnt vmcnt(21)
ds_write_b32 v23, v84 offset:31744
v_mfma_f32_16x16x32_bf16 v[28:31], a[0:3], v[140:143], v[28:31]
buffer_load_dwordx4 v[136:139], v9, s[12:15], s29 offen offset:1024 sc1
v_mfma_f32_16x16x32_bf16 v[32:35], a[4:7], v[140:143], v[32:35]
ds_write_b32 v23, v85 offset:31748
v_mfma_f32_16x16x32_bf16 v[36:39], a[8:11], v[140:143], v[36:39]
ds_write_b32 v23, v86 offset:32256
v_mfma_f32_16x16x32_bf16 v[40:43], a[12:15], v[140:143], v[40:43]
ds_write_b32 v23, v87 offset:32260
v_mfma_f32_16x16x32_bf16 v[44:47], a[16:19], v[140:143], v[44:47]
ds_write_b32 v23, v88 offset:32768
v_mfma_f32_16x16x32_bf16 v[48:51], a[20:23], v[140:143], v[48:51]
ds_write_b32 v23, v89 offset:32772
v_mfma_f32_16x16x32_bf16 v[52:55], a[24:27], v[140:143], v[52:55]
ds_write_b32 v23, v90 offset:33280
v_mfma_f32_16x16x32_bf16 v[56:59], a[28:31], v[140:143], v[56:59]
ds_write_b32 v23, v91 offset:33284
v_mfma_f32_16x16x32_bf16 v[60:63], a[32:35], v[140:143], v[60:63]
s_waitcnt vmcnt(21)
ds_write_b32 v23, v92 offset:33792
v_mfma_f32_16x16x32_bf16 v[28:31], a[36:39], v[144:147], v[28:31]
buffer_load_dwordx4 v[140:143], v9, s[12:15], s29 offen offset:2048 sc1
v_mfma_f32_16x16x32_bf16 v[32:35], a[40:43], v[144:147], v[32:35]
ds_write_b32 v23, v93 offset:33796
v_mfma_f32_16x16x32_bf16 v[36:39], a[44:47], v[144:147], v[36:39]
ds_write_b32 v23, v94 offset:34304
v_mfma_f32_16x16x32_bf16 v[40:43], a[48:51], v[144:147], v[40:43]
ds_write_b32 v23, v95 offset:34308
v_mfma_f32_16x16x32_bf16 v[44:47], a[52:55], v[144:147], v[44:47]
ds_write_b32 v23, v96 offset:34816
v_mfma_f32_16x16x32_bf16 v[48:51], a[56:59], v[144:147], v[48:51]
ds_write_b32 v23, v97 offset:34820
v_mfma_f32_16x16x32_bf16 v[52:55], a[60:63], v[144:147], v[52:55]
ds_write_b32 v23, v98 offset:35328
v_mfma_f32_16x16x32_bf16 v[56:59], a[64:67], v[144:147], v[56:59]
ds_write_b32 v23, v99 offset:35332
v_mfma_f32_16x16x32_bf16 v[60:63], a[68:71], v[144:147], v[60:63]
s_waitcnt vmcnt(21)
v_mfma_f32_16x16x32_bf16 v[28:31], a[72:75], v[148:151], v[28:31]
buffer_load_dwordx4 v[144:147], v9, s[12:15], s29 offen offset:3072 sc1
v_mfma_f32_16x16x32_bf16 v[32:35], a[76:79], v[148:151], v[32:35]
s_waitcnt lgkmcnt(0)
s_barrier
v_mfma_f32_16x16x32_bf16 v[36:39], a[80:83], v[148:151], v[36:39]
ds_read2st64_b64 v[244:247], v2 offset0:56 offset1:57
v_mfma_f32_16x16x32_bf16 v[40:43], a[84:87], v[148:151], v[40:43]
ds_read2st64_b64 v[248:251], v3 offset0:60 offset1:61
ds_read2st64_b64 v[252:255], v4 offset0:64 offset1:65
v_mfma_f32_16x16x32_bf16 v[44:47], a[88:91], v[148:151], v[44:47]
ds_read2st64_b64 v[72:75], v2 offset0:58 offset1:59
ds_read2st64_b64 v[76:79], v3 offset0:62 offset1:63
v_mfma_f32_16x16x32_bf16 v[48:51], a[92:95], v[148:151], v[48:51]
ds_read2st64_b64 v[80:83], v4 offset0:66 offset1:67
ds_read2st64_b32 v[96:97], v5 offset0:136 offset1:164
v_mfma_f32_16x16x32_bf16 v[52:55], a[96:99], v[148:151], v[52:55]
ds_read2st64_b32 v[98:99], v5 offset0:192 offset1:220
v_mfma_f32_16x16x32_bf16 v[56:59], a[100:103], v[148:151], v[56:59]
v_mfma_f32_16x16x32_bf16 v[60:63], a[104:107], v[148:151], v[60:63]
s_waitcnt vmcnt(21)
v_mfma_f32_16x16x32_bf16 v[28:31], a[108:111], v[152:155], v[28:31]
buffer_load_dwordx4 v[148:151], v10, s[12:15], s29 offen offset:0 sc1
v_mfma_f32_16x16x32_bf16 v[32:35], a[112:115], v[152:155], v[32:35]
v_mfma_f32_16x16x32_bf16 v[36:39], a[116:119], v[152:155], v[36:39]
s_waitcnt lgkmcnt(5)
v_add_f32 v244, v244, v248
v_mfma_f32_16x16x32_bf16 v[40:43], a[120:123], v[152:155], v[40:43]
v_add_f32 v245, v245, v249
v_add_f32 v246, v246, v250
v_mfma_f32_16x16x32_bf16 v[44:47], a[124:127], v[152:155], v[44:47]
v_add_f32 v247, v247, v251
v_add_f32 v64, v64, v252
v_mfma_f32_16x16x32_bf16 v[48:51], a[128:131], v[152:155], v[48:51]
v_add_f32 v65, v65, v253
v_add_f32 v66, v66, v254
v_mfma_f32_16x16x32_bf16 v[52:55], a[132:135], v[152:155], v[52:55]
v_add_f32 v67, v67, v255
v_add_f32 v64, v64, v244
v_mfma_f32_16x16x32_bf16 v[56:59], a[136:139], v[152:155], v[56:59]
v_add_f32 v65, v65, v245
v_add_f32 v66, v66, v246
v_mfma_f32_16x16x32_bf16 v[60:63], a[140:143], v[152:155], v[60:63]
s_waitcnt vmcnt(21)
v_add_f32 v67, v67, v247
v_mfma_f32_16x16x32_bf16 v[28:31], a[144:147], v[156:159], v[28:31]
buffer_load_dwordx4 v[152:155], v10, s[12:15], s29 offen offset:1024 sc1
v_mfma_f32_16x16x32_bf16 v[32:35], a[148:151], v[156:159], v[32:35]
s_waitcnt lgkmcnt(0)
v_add_f32 v72, v72, v76
v_add_f32 v73, v73, v77
v_mfma_f32_16x16x32_bf16 v[36:39], a[152:155], v[156:159], v[36:39]
v_add_f32 v74, v74, v78
v_add_f32 v75, v75, v79
v_mfma_f32_16x16x32_bf16 v[40:43], a[156:159], v[156:159], v[40:43]
v_add_f32 v68, v68, v80
v_add_f32 v69, v69, v81
v_mfma_f32_16x16x32_bf16 v[44:47], a[160:163], v[156:159], v[44:47]
v_add_f32 v70, v70, v82
v_add_f32 v71, v71, v83
v_mfma_f32_16x16x32_bf16 v[48:51], a[164:167], v[156:159], v[48:51]
v_add_f32 v68, v68, v72
v_add_f32 v69, v69, v73
v_mfma_f32_16x16x32_bf16 v[52:55], a[168:171], v[156:159], v[52:55]
v_add_f32 v70, v70, v74
v_add_f32 v71, v71, v75
v_mfma_f32_16x16x32_bf16 v[56:59], a[172:175], v[156:159], v[56:59]
v_add_f32 v96, v96, v97
v_add_f32 v98, v98, v99
v_mfma_f32_16x16x32_bf16 v[60:63], a[176:179], v[156:159], v[60:63]
s_waitcnt vmcnt(19)
v_add_f32 v96, v96, v98
v_cvt_pk_bf16_f32 v244, v64, v65
v_mfma_f32_16x16x32_bf16 v[28:31], a[180:183], v[160:163], v[28:31]
buffer_load_dwordx4 v[156:159], v10, s[12:15], s29 offen offset:2048 sc1
v_cvt_pk_bf16_f32 v245, v66, v67
v_mfma_f32_16x16x32_bf16 v[32:35], a[184:187], v[160:163], v[32:35]
v_cvt_pk_bf16_f32 v246, v68, v69
v_cvt_pk_bf16_f32 v247, v70, v71
v_mfma_f32_16x16x32_bf16 v[36:39], a[188:191], v[160:163], v[36:39]
v_cvt_pk_bf16_f32 v248, 0, v96
v_xor_b32 v244, s52, v244
v_mfma_f32_16x16x32_bf16 v[40:43], a[192:195], v[160:163], v[40:43]
v_bitop3_b32 v248, v248, v247, s48 bitop3:0x96
v_bitop3_b32 v249, v244, v245, v246 bitop3:0x96
v_mfma_f32_16x16x32_bf16 v[44:47], a[196:199], v[160:163], v[44:47]
buffer_store_dwordx4 v[244:247], v9, s[12:15], s36 offen sc1
v_xor_b32 v248, v248, v249
v_mfma_f32_16x16x32_bf16 v[48:51], a[200:203], v[160:163], v[48:51]
buffer_store_dword v248, v6, s[12:15], s36 offen offset:1024 sc1
v_mfma_f32_16x16x32_bf16 v[52:55], a[204:207], v[160:163], v[52:55]
v_mfma_f32_16x16x32_bf16 v[56:59], a[208:211], v[160:163], v[56:59]
v_mfma_f32_16x16x32_bf16 v[60:63], a[212:215], v[160:163], v[60:63]
s_waitcnt vmcnt(21)
v_mfma_f32_16x16x32_bf16 v[28:31], a[216:219], v[164:167], v[28:31]
buffer_load_dwordx4 v[160:163], v10, s[12:15], s29 offen offset:3072 sc1
v_mfma_f32_16x16x32_bf16 v[32:35], a[220:223], v[164:167], v[32:35]
v_mfma_f32_16x16x32_bf16 v[36:39], a[224:227], v[164:167], v[36:39]
v_mfma_f32_16x16x32_bf16 v[40:43], a[228:231], v[164:167], v[40:43]
v_mfma_f32_16x16x32_bf16 v[44:47], a[232:235], v[164:167], v[44:47]
v_mfma_f32_16x16x32_bf16 v[48:51], a[236:239], v[164:167], v[48:51]
v_mfma_f32_16x16x32_bf16 v[52:55], a[240:243], v[164:167], v[52:55]
v_mfma_f32_16x16x32_bf16 v[56:59], a[244:247], v[164:167], v[56:59]
v_mfma_f32_16x16x32_bf16 v[60:63], a[248:251], v[164:167], v[60:63]
s_waitcnt vmcnt(21)
v_mfma_f32_16x16x32_bf16 v[64:67], v[100:103], v[208:211], 0
buffer_load_dwordx4 v[164:167], v11, s[12:15], s29 offen offset:0 sc1
s_add_u32 s29, s29, 147456
v_mfma_f32_16x16x32_bf16 v[68:71], v[104:107], v[208:211], 0
ds_write_b32 v23, v36 offset:0
v_mfma_f32_16x16x32_bf16 v[72:75], v[108:111], v[208:211], 0
ds_write_b32 v23, v37 offset:4
v_mfma_f32_16x16x32_bf16 v[76:79], v[112:115], v[208:211], 0
ds_write_b32 v23, v38 offset:512
v_mfma_f32_16x16x32_bf16 v[80:83], v[116:119], v[208:211], 0
ds_write_b32 v23, v39 offset:516
v_mfma_f32_16x16x32_bf16 v[84:87], v[120:123], v[208:211], 0
ds_write_b32 v23, v40 offset:1024
v_mfma_f32_16x16x32_bf16 v[88:91], v[124:127], v[208:211], 0
ds_write_b32 v23, v41 offset:1028
v_mfma_f32_16x16x32_bf16 v[92:95], v[128:131], v[208:211], 0
v_mfma_f32_16x16x32_bf16 v[96:99], v[168:171], v[208:211], 0
s_waitcnt vmcnt(21)
ds_write_b32 v23, v42 offset:1536
v_mfma_f32_16x16x32_bf16 v[64:67], v[172:175], v[212:215], v[64:67]
buffer_load_dwordx4 v[208:211], v9, s[12:15], s29 offen offset:0 sc1
v_mfma_f32_16x16x32_bf16 v[68:71], v[176:179], v[212:215], v[68:71]
ds_write_b32 v23, v43 offset:1540
v_mfma_f32_16x16x32_bf16 v[72:75], v[180:183], v[212:215], v[72:75]
ds_write_b32 v23, v44 offset:2048
v_mfma_f32_16x16x32_bf16 v[76:79], v[184:187], v[212:215], v[76:79]
ds_write_b32 v23, v45 offset:2052
v_mfma_f32_16x16x32_bf16 v[80:83], v[188:191], v[212:215], v[80:83]
ds_write_b32 v23, v46 offset:2560
v_mfma_f32_16x16x32_bf16 v[84:87], v[192:195], v[212:215], v[84:87]
ds_write_b32 v23, v47 offset:2564
v_mfma_f32_16x16x32_bf16 v[88:91], v[196:199], v[212:215], v[88:91]
ds_write_b32 v23, v48 offset:3072
v_mfma_f32_16x16x32_bf16 v[92:95], v[200:203], v[212:215], v[92:95]
ds_write_b32 v23, v49 offset:3076
v_mfma_f32_16x16x32_bf16 v[96:99], v[204:207], v[212:215], v[96:99]
s_waitcnt vmcnt(21)
ds_write_b32 v23, v50 offset:3584
v_mfma_f32_16x16x32_bf16 v[64:67], a[0:3], v[216:219], v[64:67]
buffer_load_dwordx4 v[212:215], v9, s[12:15], s29 offen offset:1024 sc1
v_mfma_f32_16x16x32_bf16 v[68:71], a[4:7], v[216:219], v[68:71]
ds_write_b32 v23, v51 offset:3588
v_mfma_f32_16x16x32_bf16 v[72:75], a[8:11], v[216:219], v[72:75]
ds_write_b32 v23, v52 offset:4096
v_mfma_f32_16x16x32_bf16 v[76:79], a[12:15], v[216:219], v[76:79]
ds_write_b32 v23, v53 offset:4100
v_mfma_f32_16x16x32_bf16 v[80:83], a[16:19], v[216:219], v[80:83]
ds_write_b32 v23, v54 offset:4608
v_mfma_f32_16x16x32_bf16 v[84:87], a[20:23], v[216:219], v[84:87]
ds_write_b32 v23, v55 offset:4612
v_mfma_f32_16x16x32_bf16 v[88:91], a[24:27], v[216:219], v[88:91]
ds_write_b32 v23, v56 offset:5120
v_mfma_f32_16x16x32_bf16 v[92:95], a[28:31], v[216:219], v[92:95]
ds_write_b32 v23, v57 offset:5124
v_mfma_f32_16x16x32_bf16 v[96:99], a[32:35], v[216:219], v[96:99]
s_waitcnt vmcnt(21)
ds_write_b32 v23, v58 offset:5632
v_mfma_f32_16x16x32_bf16 v[64:67], a[36:39], v[220:223], v[64:67]
buffer_load_dwordx4 v[216:219], v9, s[12:15], s29 offen offset:2048 sc1
v_mfma_f32_16x16x32_bf16 v[68:71], a[40:43], v[220:223], v[68:71]
ds_write_b32 v23, v59 offset:5636
v_mfma_f32_16x16x32_bf16 v[72:75], a[44:47], v[220:223], v[72:75]
ds_write_b32 v23, v60 offset:6144
v_mfma_f32_16x16x32_bf16 v[76:79], a[48:51], v[220:223], v[76:79]
ds_write_b32 v23, v61 offset:6148
v_mfma_f32_16x16x32_bf16 v[80:83], a[52:55], v[220:223], v[80:83]
ds_write_b32 v23, v62 offset:6656
v_mfma_f32_16x16x32_bf16 v[84:87], a[56:59], v[220:223], v[84:87]
ds_write_b32 v23, v63 offset:6660
v_mfma_f32_16x16x32_bf16 v[88:91], a[60:63], v[220:223], v[88:91]
v_mfma_f32_16x16x32_bf16 v[92:95], a[64:67], v[220:223], v[92:95]
v_mfma_f32_16x16x32_bf16 v[96:99], a[68:71], v[220:223], v[96:99]
s_waitcnt vmcnt(21)
v_mfma_f32_16x16x32_bf16 v[64:67], a[72:75], v[224:227], v[64:67]
buffer_load_dwordx4 v[220:223], v9, s[12:15], s29 offen offset:3072 sc1
v_mfma_f32_16x16x32_bf16 v[68:71], a[76:79], v[224:227], v[68:71]
s_waitcnt lgkmcnt(0)
s_barrier
v_mfma_f32_16x16x32_bf16 v[72:75], a[80:83], v[224:227], v[72:75]
ds_read2st64_b64 v[244:247], v2 offset0:0 offset1:1
v_mfma_f32_16x16x32_bf16 v[76:79], a[84:87], v[224:227], v[76:79]
ds_read2st64_b64 v[248:251], v3 offset0:4 offset1:5
ds_read2st64_b64 v[252:255], v4 offset0:8 offset1:9
v_mfma_f32_16x16x32_bf16 v[80:83], a[88:91], v[224:227], v[80:83]
ds_read2st64_b64 v[36:39], v2 offset0:2 offset1:3
ds_read2st64_b64 v[40:43], v3 offset0:6 offset1:7
v_mfma_f32_16x16x32_bf16 v[84:87], a[92:95], v[224:227], v[84:87]
ds_read2st64_b64 v[44:47], v4 offset0:10 offset1:11
ds_read2st64_b32 v[60:61], v5 offset0:24 offset1:52
v_mfma_f32_16x16x32_bf16 v[88:91], a[96:99], v[224:227], v[88:91]
ds_read2st64_b32 v[62:63], v5 offset0:80 offset1:108
v_mfma_f32_16x16x32_bf16 v[92:95], a[100:103], v[224:227], v[92:95]
v_mfma_f32_16x16x32_bf16 v[96:99], a[104:107], v[224:227], v[96:99]
s_waitcnt vmcnt(21)
v_mfma_f32_16x16x32_bf16 v[64:67], a[108:111], v[228:231], v[64:67]
buffer_load_dwordx4 v[224:227], v10, s[12:15], s29 offen offset:0 sc1
v_mfma_f32_16x16x32_bf16 v[68:71], a[112:115], v[228:231], v[68:71]
v_mfma_f32_16x16x32_bf16 v[72:75], a[116:119], v[228:231], v[72:75]
s_waitcnt lgkmcnt(5)
v_add_f32 v244, v244, v248
v_mfma_f32_16x16x32_bf16 v[76:79], a[120:123], v[228:231], v[76:79]
v_add_f32 v245, v245, v249
v_add_f32 v246, v246, v250
v_mfma_f32_16x16x32_bf16 v[80:83], a[124:127], v[228:231], v[80:83]
v_add_f32 v247, v247, v251
v_add_f32 v28, v28, v252
v_mfma_f32_16x16x32_bf16 v[84:87], a[128:131], v[228:231], v[84:87]
v_add_f32 v29, v29, v253
v_add_f32 v30, v30, v254
v_mfma_f32_16x16x32_bf16 v[88:91], a[132:135], v[228:231], v[88:91]
v_add_f32 v31, v31, v255
v_add_f32 v28, v28, v244
v_mfma_f32_16x16x32_bf16 v[92:95], a[136:139], v[228:231], v[92:95]
v_add_f32 v29, v29, v245
v_add_f32 v30, v30, v246
v_mfma_f32_16x16x32_bf16 v[96:99], a[140:143], v[228:231], v[96:99]
s_waitcnt vmcnt(21)
v_add_f32 v31, v31, v247
v_mfma_f32_16x16x32_bf16 v[64:67], a[144:147], v[232:235], v[64:67]
buffer_load_dwordx4 v[228:231], v10, s[12:15], s29 offen offset:1024 sc1
v_mfma_f32_16x16x32_bf16 v[68:71], a[148:151], v[232:235], v[68:71]
s_waitcnt lgkmcnt(0)
v_add_f32 v36, v36, v40
v_add_f32 v37, v37, v41
v_mfma_f32_16x16x32_bf16 v[72:75], a[152:155], v[232:235], v[72:75]
v_add_f32 v38, v38, v42
v_add_f32 v39, v39, v43
v_mfma_f32_16x16x32_bf16 v[76:79], a[156:159], v[232:235], v[76:79]
v_add_f32 v32, v32, v44
v_add_f32 v33, v33, v45
v_mfma_f32_16x16x32_bf16 v[80:83], a[160:163], v[232:235], v[80:83]
v_add_f32 v34, v34, v46
v_add_f32 v35, v35, v47
v_mfma_f32_16x16x32_bf16 v[84:87], a[164:167], v[232:235], v[84:87]
v_add_f32 v32, v32, v36
v_add_f32 v33, v33, v37
v_mfma_f32_16x16x32_bf16 v[88:91], a[168:171], v[232:235], v[88:91]
v_add_f32 v34, v34, v38
v_add_f32 v35, v35, v39
v_mfma_f32_16x16x32_bf16 v[92:95], a[172:175], v[232:235], v[92:95]
v_add_f32 v60, v60, v61
v_add_f32 v62, v62, v63
v_mfma_f32_16x16x32_bf16 v[96:99], a[176:179], v[232:235], v[96:99]
s_waitcnt vmcnt(19)
v_add_f32 v60, v60, v62
v_cvt_pk_bf16_f32 v244, v28, v29
v_mfma_f32_16x16x32_bf16 v[64:67], a[180:183], v[236:239], v[64:67]
buffer_load_dwordx4 v[232:235], v10, s[12:15], s29 offen offset:2048 sc1
v_cvt_pk_bf16_f32 v245, v30, v31
v_mfma_f32_16x16x32_bf16 v[68:71], a[184:187], v[236:239], v[68:71]
v_cvt_pk_bf16_f32 v246, v32, v33
v_cvt_pk_bf16_f32 v247, v34, v35
v_mfma_f32_16x16x32_bf16 v[72:75], a[188:191], v[236:239], v[72:75]
v_cvt_pk_bf16_f32 v248, 0, v60
v_xor_b32 v244, s52, v244
v_mfma_f32_16x16x32_bf16 v[76:79], a[192:195], v[236:239], v[76:79]
v_bitop3_b32 v248, v248, v247, s48 bitop3:0x96
v_bitop3_b32 v249, v244, v245, v246 bitop3:0x96
v_mfma_f32_16x16x32_bf16 v[80:83], a[196:199], v[236:239], v[80:83]
buffer_store_dwordx4 v[244:247], v9, s[12:15], s37 offen sc1
v_xor_b32 v248, v248, v249
v_mfma_f32_16x16x32_bf16 v[84:87], a[200:203], v[236:239], v[84:87]
buffer_store_dword v248, v6, s[12:15], s37 offen offset:1024 sc1
v_mfma_f32_16x16x32_bf16 v[88:91], a[204:207], v[236:239], v[88:91]
v_mfma_f32_16x16x32_bf16 v[92:95], a[208:211], v[236:239], v[92:95]
v_mfma_f32_16x16x32_bf16 v[96:99], a[212:215], v[236:239], v[96:99]
s_waitcnt vmcnt(21)
v_mfma_f32_16x16x32_bf16 v[64:67], a[216:219], v[240:243], v[64:67]
buffer_load_dwordx4 v[236:239], v10, s[12:15], s29 offen offset:3072 sc1
v_mfma_f32_16x16x32_bf16 v[68:71], a[220:223], v[240:243], v[68:71]
v_mfma_f32_16x16x32_bf16 v[72:75], a[224:227], v[240:243], v[72:75]
v_mfma_f32_16x16x32_bf16 v[76:79], a[228:231], v[240:243], v[76:79]
v_mfma_f32_16x16x32_bf16 v[80:83], a[232:235], v[240:243], v[80:83]
v_mfma_f32_16x16x32_bf16 v[84:87], a[236:239], v[240:243], v[84:87]
v_mfma_f32_16x16x32_bf16 v[88:91], a[240:243], v[240:243], v[88:91]
v_mfma_f32_16x16x32_bf16 v[92:95], a[244:247], v[240:243], v[92:95]
s_add_u32 s31, s31, 1
v_mfma_f32_16x16x32_bf16 v[96:99], a[248:251], v[240:243], v[96:99]
buffer_load_dwordx4 v[240:243], v11, s[12:15], s29 offen offset:0 sc1
s_cmp_lg_u32 s31, 3
s_cbranch_scc1 C_loop
s_waitcnt vmcnt(21)
v_mfma_f32_16x16x32_bf16 v[28:31], v[100:103], v[132:135], 0
v_subrev_u32 v244, s43, v8
v_cmp_lt_u32 vcc, 7, v244
v_mfma_f32_16x16x32_bf16 v[32:35], v[104:107], v[132:135], 0
s_mov_b64 s[44:45], -1
s_cbranch_vccnz C_s3
C_r3:
v_mfma_f32_16x16x32_bf16 v[36:39], v[108:111], v[132:135], 0
s_add_u32 s36, s37, 5120
s_movk_i32 s55, 0x3f80
s_add_u32 s49, s41, 65536
v_mfma_f32_16x16x32_bf16 v[40:43], v[112:115], v[132:135], 0
buffer_load_dword v19, v18, s[12:15], s42 offen offset:0 sc1
buffer_load_dword v20, v18, s[12:15], s42 offen offset:64 sc1
v_mfma_f32_16x16x32_bf16 v[44:47], v[116:119], v[132:135], 0
buffer_load_dword v24, v21, s[12:15], s42 offen offset:0 sc1
buffer_load_dword v25, v21, s[12:15], s42 offen offset:64 sc1
v_mfma_f32_16x16x32_bf16 v[48:51], v[120:123], v[132:135], 0
ds_write_b64 v23, v[72:73] offset:28672
v_mfma_f32_16x16x32_bf16 v[52:55], v[124:127], v[132:135], 0
ds_write_b64 v23, v[74:75] offset:29184
v_mfma_f32_16x16x32_bf16 v[56:59], v[128:131], v[132:135], 0
ds_write_b64 v23, v[76:77] offset:29696
v_mfma_f32_16x16x32_bf16 v[60:63], v[168:171], v[132:135], 0
s_waitcnt vmcnt(24)
ds_write_b64 v23, v[78:79] offset:30208
v_mfma_f32_16x16x32_bf16 v[28:31], v[172:175], v[136:139], v[28:31]
buffer_load_dwordx2 v[132:133], v16, s[12:15], s41 offen offset:0 sc1
buffer_load_dwordx2 v[134:135], v16, s[12:15], s49 offen offset:0 sc1
v_mfma_f32_16x16x32_bf16 v[32:35], v[176:179], v[136:139], v[32:35]
buffer_load_ushort v18, v17, s[12:15], s41 offen offset:0 sc1
v_mfma_f32_16x16x32_bf16 v[36:39], v[180:183], v[136:139], v[36:39]
ds_write_b64 v23, v[80:81] offset:30720
v_mfma_f32_16x16x32_bf16 v[40:43], v[184:187], v[136:139], v[40:43]
ds_write_b64 v23, v[82:83] offset:31232
v_mfma_f32_16x16x32_bf16 v[44:47], v[188:191], v[136:139], v[44:47]
ds_write_b64 v23, v[84:85] offset:31744
v_mfma_f32_16x16x32_bf16 v[48:51], v[192:195], v[136:139], v[48:51]
ds_write_b64 v23, v[86:87] offset:32256
v_mfma_f32_16x16x32_bf16 v[52:55], v[196:199], v[136:139], v[52:55]
ds_write_b64 v23, v[88:89] offset:32768
v_mfma_f32_16x16x32_bf16 v[56:59], v[200:203], v[136:139], v[56:59]
ds_write_b64 v23, v[90:91] offset:33280
v_mfma_f32_16x16x32_bf16 v[60:63], v[204:207], v[136:139], v[60:63]
s_waitcnt vmcnt(26)
ds_write_b64 v23, v[92:93] offset:33792
v_mfma_f32_16x16x32_bf16 v[28:31], a[0:3], v[140:143], v[28:31]
buffer_load_dwordx2 v[136:137], v16, s[12:15], s41 offen offset:128 sc1
buffer_load_dwordx2 v[138:139], v16, s[12:15], s49 offen offset:128 sc1
v_mfma_f32_16x16x32_bf16 v[32:35], a[4:7], v[140:143], v[32:35]
buffer_load_ushort v21, v17, s[12:15], s41 offen offset:128 sc1
v_mfma_f32_16x16x32_bf16 v[36:39], a[8:11], v[140:143], v[36:39]
ds_write_b64 v23, v[94:95] offset:34304
v_mfma_f32_16x16x32_bf16 v[40:43], a[12:15], v[140:143], v[40:43]
ds_write_b64 v23, v[96:97] offset:34816
v_mfma_f32_16x16x32_bf16 v[44:47], a[16:19], v[140:143], v[44:47]
ds_write_b64 v23, v[98:99] offset:35328
v_mfma_f32_16x16x32_bf16 v[48:51], a[20:23], v[140:143], v[48:51]
v_mfma_f32_16x16x32_bf16 v[52:55], a[24:27], v[140:143], v[52:55]
v_mfma_f32_16x16x32_bf16 v[56:59], a[28:31], v[140:143], v[56:59]
v_mfma_f32_16x16x32_bf16 v[60:63], a[32:35], v[140:143], v[60:63]
s_waitcnt vmcnt(28)
s_waitcnt lgkmcnt(0)
s_barrier
v_mfma_f32_16x16x32_bf16 v[28:31], a[36:39], v[144:147], v[28:31]
ds_read_b64 v[140:141], v26 offset:0
ds_read_b64 v[142:143], v26 offset:32
v_mfma_f32_16x16x32_bf16 v[32:35], a[40:43], v[144:147], v[32:35]
ds_read2st64_b64 v[244:247], v2 offset0:56 offset1:57
ds_read2st64_b64 v[248:251], v3 offset0:60 offset1:61
v_mfma_f32_16x16x32_bf16 v[36:39], a[44:47], v[144:147], v[36:39]
ds_read2st64_b64 v[252:255], v4 offset0:64 offset1:65
ds_read2st64_b64 v[72:75], v2 offset0:58 offset1:59
v_mfma_f32_16x16x32_bf16 v[40:43], a[48:51], v[144:147], v[40:43]
ds_read2st64_b64 v[76:79], v3 offset0:62 offset1:63
ds_read2st64_b64 v[80:83], v4 offset0:66 offset1:67
v_mfma_f32_16x16x32_bf16 v[44:47], a[52:55], v[144:147], v[44:47]
ds_read2st64_b32 v[96:97], v5 offset0:136 offset1:164
ds_read2st64_b32 v[98:99], v5 offset0:192 offset1:220
v_mfma_f32_16x16x32_bf16 v[48:51], a[56:59], v[144:147], v[48:51]
v_mfma_f32_16x16x32_bf16 v[52:55], a[60:63], v[144:147], v[52:55]
v_mfma_f32_16x16x32_bf16 v[56:59], a[64:67], v[144:147], v[56:59]
v_mfma_f32_16x16x32_bf16 v[60:63], a[68:71], v[144:147], v[60:63]
s_waitcnt vmcnt(27)
v_mfma_f32_16x16x32_bf16 v[28:31], a[72:75], v[148:151], v[28:31]
ds_read_b64 v[144:145], v26 offset:1024
ds_read_b64 v[146:147], v26 offset:1056
v_mfma_f32_16x16x32_bf16 v[32:35], a[76:79], v[148:151], v[32:35]
s_waitcnt lgkmcnt(7)
v_add_f32 v244, v244, v248
v_add_f32 v245, v245, v249
v_mfma_f32_16x16x32_bf16 v[36:39], a[80:83], v[148:151], v[36:39]
v_add_f32 v246, v246, v250
v_add_f32 v247, v247, v251
v_mfma_f32_16x16x32_bf16 v[40:43], a[84:87], v[148:151], v[40:43]
v_add_f32 v64, v64, v252
v_add_f32 v65, v65, v253
v_mfma_f32_16x16x32_bf16 v[44:47], a[88:91], v[148:151], v[44:47]
v_add_f32 v66, v66, v254
v_add_f32 v67, v67, v255
v_mfma_f32_16x16x32_bf16 v[48:51], a[92:95], v[148:151], v[48:51]
v_add_f32 v64, v64, v244
v_add_f32 v65, v65, v245
v_mfma_f32_16x16x32_bf16 v[52:55], a[96:99], v[148:151], v[52:55]
v_add_f32 v66, v66, v246
v_add_f32 v67, v67, v247
v_mfma_f32_16x16x32_bf16 v[56:59], a[100:103], v[148:151], v[56:59]
s_waitcnt lgkmcnt(2)
v_add_f32 v72, v72, v76
v_add_f32 v73, v73, v77
v_mfma_f32_16x16x32_bf16 v[60:63], a[104:107], v[148:151], v[60:63]
s_waitcnt vmcnt(26)
v_add_f32 v74, v74, v78
v_add_f32 v75, v75, v79
v_mfma_f32_16x16x32_bf16 v[28:31], a[108:111], v[152:155], v[28:31]
s_add_u32 s40, s38, 4096
buffer_load_ushort v148, v15, s[4:7], s40 offen
v_mfma_f32_16x16x32_bf16 v[32:35], a[112:115], v[152:155], v[32:35]
s_add_u32 s40, s38, 22528
buffer_load_ushort v149, v15, s[4:7], s40 offen
v_mfma_f32_16x16x32_bf16 v[36:39], a[116:119], v[152:155], v[36:39]
v_add_f32 v68, v68, v80
v_add_f32 v69, v69, v81
v_mfma_f32_16x16x32_bf16 v[40:43], a[120:123], v[152:155], v[40:43]
v_add_f32 v70, v70, v82
v_add_f32 v71, v71, v83
v_mfma_f32_16x16x32_bf16 v[44:47], a[124:127], v[152:155], v[44:47]
v_add_f32 v68, v68, v72
v_add_f32 v69, v69, v73
v_mfma_f32_16x16x32_bf16 v[48:51], a[128:131], v[152:155], v[48:51]
v_add_f32 v70, v70, v74
v_add_f32 v71, v71, v75
v_mfma_f32_16x16x32_bf16 v[52:55], a[132:135], v[152:155], v[52:55]
v_add_f32 v96, v96, v97
v_add_f32 v98, v98, v99
v_mfma_f32_16x16x32_bf16 v[56:59], a[136:139], v[152:155], v[56:59]
v_add_f32 v96, v96, v98
v_cvt_pk_bf16_f32 v244, v64, v65
v_mfma_f32_16x16x32_bf16 v[60:63], a[140:143], v[152:155], v[60:63]
s_waitcnt vmcnt(27)
v_cvt_pk_bf16_f32 v245, v66, v67
v_cvt_pk_bf16_f32 v246, v68, v69
v_mfma_f32_16x16x32_bf16 v[28:31], a[144:147], v[156:159], v[28:31]
v_cvt_pk_bf16_f32 v247, v70, v71
v_cvt_pk_bf16_f32 v248, 0, v96
v_mfma_f32_16x16x32_bf16 v[32:35], a[148:151], v[156:159], v[32:35]
v_xor_b32 v244, s52, v244
v_bitop3_b32 v248, v248, v247, s48 bitop3:0x96
v_mfma_f32_16x16x32_bf16 v[36:39], a[152:155], v[156:159], v[36:39]
v_bitop3_b32 v249, v244, v245, v246 bitop3:0x96
v_xor_b32 v248, v248, v249
v_mfma_f32_16x16x32_bf16 v[40:43], a[156:159], v[156:159], v[40:43]
buffer_store_dwordx4 v[244:247], v9, s[12:15], s36 offen sc1
buffer_store_dword v248, v6, s[12:15], s36 offen offset:1024 sc1
v_mfma_f32_16x16x32_bf16 v[44:47], a[160:163], v[156:159], v[44:47]
s_waitcnt vmcnt(8)
v_lshlrev_b32 v22, 16, v140
v_lshlrev_b32 v13, 16, v132
v_mfma_f32_16x16x32_bf16 v[48:51], a[164:167], v[156:159], v[48:51]
v_and_b32 v140, 0xffff0000, v140
v_and_b32 v132, 0xffff0000, v132
v_mfma_f32_16x16x32_bf16 v[52:55], a[168:171], v[156:159], v[52:55]
v_mul_f32 v22, v22, v19
v_mul_f32 v140, v140, v19
v_mfma_f32_16x16x32_bf16 v[56:59], a[172:175], v[156:159], v[56:59]
v_mul_f32 v140, v140, v132
v_mul_f32 v132, v22, v13
v_mfma_f32_16x16x32_bf16 v[60:63], a[176:179], v[156:159], v[60:63]
v_lshlrev_b32 v22, 16, v141
v_lshlrev_b32 v13, 16, v133
v_mfma_f32_16x16x32_bf16 v[28:31], a[180:183], v[160:163], v[28:31]
s_add_u32 s53, s47, 0
buffer_load_dwordx4 v[156:159], v9, s[12:15], s53 offen sc1
v_mfma_f32_16x16x32_bf16 v[32:35], a[184:187], v[160:163], v[32:35]
buffer_load_dword v10, v6, s[12:15], s53 offen offset:1024 sc1
v_and_b32 v141, 0xffff0000, v141
v_mfma_f32_16x16x32_bf16 v[36:39], a[188:191], v[160:163], v[36:39]
v_and_b32 v133, 0xffff0000, v133
v_mul_f32 v22, v22, v19
v_mfma_f32_16x16x32_bf16 v[40:43], a[192:195], v[160:163], v[40:43]
v_mul_f32 v141, v141, v19
v_mul_f32 v141, v141, v133
v_mfma_f32_16x16x32_bf16 v[44:47], a[196:199], v[160:163], v[44:47]
v_mul_f32 v133, v22, v13
v_lshlrev_b32 v22, 16, v142
v_mfma_f32_16x16x32_bf16 v[48:51], a[200:203], v[160:163], v[48:51]
v_lshlrev_b32 v13, 16, v134
v_and_b32 v142, 0xffff0000, v142
v_mfma_f32_16x16x32_bf16 v[52:55], a[204:207], v[160:163], v[52:55]
v_and_b32 v134, 0xffff0000, v134
v_mul_f32 v22, v22, v19
v_mfma_f32_16x16x32_bf16 v[56:59], a[208:211], v[160:163], v[56:59]
v_mul_f32 v142, v142, v19
v_mul_f32 v142, v142, v134
v_mfma_f32_16x16x32_bf16 v[60:63], a[212:215], v[160:163], v[60:63]
v_mul_f32 v134, v22, v13
v_lshlrev_b32 v22, 16, v143
v_mfma_f32_16x16x32_bf16 v[28:31], a[216:219], v[164:167], v[28:31]
s_add_u32 s53, s47, 10240
buffer_load_dwordx4 v[160:163], v9, s[12:15], s53 offen sc1
v_mfma_f32_16x16x32_bf16 v[32:35], a[220:223], v[164:167], v[32:35]
buffer_load_dword v11, v6, s[12:15], s53 offen offset:1024 sc1
v_lshlrev_b32 v13, 16, v135
v_mfma_f32_16x16x32_bf16 v[36:39], a[224:227], v[164:167], v[36:39]
v_and_b32 v143, 0xffff0000, v143
v_and_b32 v135, 0xffff0000, v135
v_mfma_f32_16x16x32_bf16 v[40:43], a[228:231], v[164:167], v[40:43]
v_mul_f32 v22, v22, v19
v_mul_f32 v143, v143, v19
v_mfma_f32_16x16x32_bf16 v[44:47], a[232:235], v[164:167], v[44:47]
v_mul_f32 v143, v143, v135
v_mul_f32 v135, v22, v13
v_mfma_f32_16x16x32_bf16 v[48:51], a[236:239], v[164:167], v[48:51]
v_sub_f32 v19, 1.0, v19
v_bfe_u32 v22, v0, 2, 2
v_mfma_f32_16x16x32_bf16 v[52:55], a[240:243], v[164:167], v[52:55]
v_lshrrev_b32 v13, 4, v0
v_cmp_eq_u32 vcc, v22, v13
v_mfma_f32_16x16x32_bf16 v[56:59], a[244:247], v[164:167], v[56:59]
v_lshlrev_b32 v22, 4, v0
v_lshlrev_b32 v22, v22, s55
v_mfma_f32_16x16x32_bf16 v[60:63], a[248:251], v[164:167], v[60:63]
v_mov_b32 v150, 0
v_cndmask_b32 v22, 0, v22, vcc
v_mfma_f32_16x16x32_bf16 v[72:75], v[108:111], v[208:211], 0
s_add_u32 s53, s47, 20480
buffer_load_dwordx4 v[164:167], v9, s[12:15], s53 offen sc1
v_mfma_f32_16x16x32_bf16 v[72:75], v[180:183], v[212:215], v[72:75]
buffer_load_dword v12, v6, s[12:15], s53 offen offset:1024 sc1
v_and_b32 v13, 2, v0
v_mfma_f32_16x16x32_bf16 v[72:75], a[8:11], v[216:219], v[72:75]
ds_write_b64 v23, v[36:37] offset:0
v_mfma_f32_16x16x32_bf16 v[72:75], a[44:47], v[220:223], v[72:75]
ds_write_b64 v23, v[38:39] offset:512
v_mfma_f32_16x16x32_bf16 v[72:75], a[80:83], v[224:227], v[72:75]
ds_write_b64 v23, v[40:41] offset:1024
v_mfma_f32_16x16x32_bf16 v[72:75], a[116:119], v[228:231], v[72:75]
ds_write_b64 v23, v[42:43] offset:1536
v_mfma_f32_16x16x32_bf16 v[72:75], a[152:155], v[232:235], v[72:75]
ds_write_b64 v23, v[44:45] offset:2048
v_mfma_f32_16x16x32_bf16 v[72:75], a[188:191], v[236:239], v[72:75]
ds_write_b64 v23, v[46:47] offset:2560
v_mfma_f32_16x16x32_bf16 v[72:75], a[224:227], v[240:243], v[72:75]
ds_write_b64 v23, v[48:49] offset:3072
v_mfma_f32_16x16x32_bf16 v[76:79], v[112:115], v[208:211], 0
ds_write_b64 v23, v[50:51] offset:3584
v_mfma_f32_16x16x32_bf16 v[76:79], v[184:187], v[212:215], v[76:79]
ds_write_b64 v23, v[52:53] offset:4096
v_mfma_f32_16x16x32_bf16 v[76:79], a[12:15], v[216:219], v[76:79]
ds_write_b64 v23, v[54:55] offset:4608
v_mfma_f32_16x16x32_bf16 v[76:79], a[48:51], v[220:223], v[76:79]
ds_write_b64 v23, v[56:57] offset:5120
v_mfma_f32_16x16x32_bf16 v[76:79], a[84:87], v[224:227], v[76:79]
ds_write_b64 v23, v[58:59] offset:5632
v_mfma_f32_16x16x32_bf16 v[76:79], a[120:123], v[228:231], v[76:79]
ds_write_b64 v23, v[60:61] offset:6144
v_mfma_f32_16x16x32_bf16 v[76:79], a[156:159], v[232:235], v[76:79]
ds_write_b64 v23, v[62:63] offset:6656
v_mfma_f32_16x16x32_bf16 v[76:79], a[192:195], v[236:239], v[76:79]
v_cmp_eq_u32 vcc, 0, v13
v_mov_b32 v151, 0
v_mfma_f32_16x16x32_bf16 v[76:79], a[228:231], v[240:243], v[76:79]
v_mov_b32 v154, 0
v_cndmask_b32 v152, 0, v22, vcc
v_mfma_f32_16x16x32_bf16 v[80:83], v[116:119], v[208:211], 0
v_mov_b32 v155, 0
v_xor_b32 v153, v22, v152
v_mfma_f32_16x16x32_bf16 v[80:83], v[188:191], v[212:215], v[80:83]
s_waitcnt lgkmcnt(0)
s_barrier
v_mfma_f32_16x16x32_bf16 v[80:83], a[16:19], v[216:219], v[80:83]
ds_read2st64_b64 v[244:247], v2 offset0:0 offset1:1
v_mfma_f32_16x16x32_bf16 v[80:83], a[52:55], v[220:223], v[80:83]
ds_read2st64_b64 v[248:251], v3 offset0:4 offset1:5
ds_read2st64_b64 v[252:255], v4 offset0:8 offset1:9
v_mfma_f32_16x16x32_bf16 v[80:83], a[88:91], v[224:227], v[80:83]
s_add_u32 s53, s47, 5120
ds_read2st64_b64 v[36:39], v2 offset0:2 offset1:3
buffer_load_dwordx4 v[48:51], v9, s[12:15], s53 offen sc1
v_mfma_f32_16x16x32_bf16 v[80:83], a[124:127], v[228:231], v[80:83]
buffer_load_dword v16, v6, s[12:15], s53 offen offset:1024 sc1
ds_read2st64_b64 v[40:43], v3 offset0:6 offset1:7
v_mfma_f32_16x16x32_bf16 v[80:83], a[160:163], v[232:235], v[80:83]
ds_write_b64 v23, v[72:73] offset:28672
v_mfma_f32_16x16x32_bf16 v[80:83], a[196:199], v[236:239], v[80:83]
ds_write_b64 v23, v[74:75] offset:29184
v_mfma_f32_16x16x32_bf16 v[80:83], a[232:235], v[240:243], v[80:83]
ds_write_b64 v23, v[76:77] offset:29696
v_mfma_f32_16x16x32_bf16 v[84:87], v[120:123], v[208:211], 0
ds_write_b64 v23, v[78:79] offset:30208
v_mfma_f32_16x16x32_bf16 v[84:87], v[192:195], v[212:215], v[84:87]
ds_read2st64_b64 v[44:47], v4 offset0:10 offset1:11
ds_read2st64_b32 v[60:61], v5 offset0:24 offset1:52
v_mfma_f32_16x16x32_bf16 v[84:87], a[20:23], v[216:219], v[84:87]
ds_write_b64 v23, v[80:81] offset:30720
ds_read2st64_b32 v[62:63], v5 offset0:80 offset1:108
v_mfma_f32_16x16x32_bf16 v[84:87], a[56:59], v[220:223], v[84:87]
s_waitcnt lgkmcnt(10)
v_add_f32 v244, v244, v248
v_add_f32 v245, v245, v249
v_mfma_f32_16x16x32_bf16 v[84:87], a[92:95], v[224:227], v[84:87]
s_add_u32 s53, s47, 15360
buffer_load_dwordx4 v[52:55], v9, s[12:15], s53 offen sc1
v_mfma_f32_16x16x32_bf16 v[84:87], a[128:131], v[228:231], v[84:87]
buffer_load_dword v17, v6, s[12:15], s53 offen offset:1024 sc1
v_add_f32 v246, v246, v250
v_mfma_f32_16x16x32_bf16 v[84:87], a[164:167], v[232:235], v[84:87]
ds_write_b64 v23, v[82:83] offset:31232
v_mfma_f32_16x16x32_bf16 v[84:87], a[200:203], v[236:239], v[84:87]
v_add_f32 v247, v247, v251
v_add_f32 v28, v28, v252
v_mfma_f32_16x16x32_bf16 v[84:87], a[236:239], v[240:243], v[84:87]
v_add_f32 v29, v29, v253
v_add_f32 v30, v30, v254
v_mfma_f32_16x16x32_bf16 v[88:91], v[124:127], v[208:211], 0
v_add_f32 v31, v31, v255
v_add_f32 v28, v28, v244
v_mfma_f32_16x16x32_bf16 v[88:91], v[196:199], v[212:215], v[88:91]
v_add_f32 v29, v29, v245
v_add_f32 v30, v30, v246
v_mfma_f32_16x16x32_bf16 v[88:91], a[24:27], v[216:219], v[88:91]
ds_write_b64 v23, v[84:85] offset:31744
v_mfma_f32_16x16x32_bf16 v[88:91], a[60:63], v[220:223], v[88:91]
ds_write_b64 v23, v[86:87] offset:32256
v_mfma_f32_16x16x32_bf16 v[88:91], a[96:99], v[224:227], v[88:91]
s_add_u32 s53, s47, 25600
buffer_load_dwordx4 v[56:59], v9, s[12:15], s53 offen sc1
v_add_f32 v31, v31, v247
s_waitcnt lgkmcnt(3)
v_add_f32 v36, v36, v40
s_waitcnt vmcnt(5)
v_bitop3_b32 v8, v156, v157, v158 bitop3:0x96
v_bitop3_b32 v10, v10, v159, s48 bitop3:0x96
v_mfma_f32_16x16x32_bf16 v[88:91], a[132:135], v[228:231], v[88:91]
buffer_load_dword v26, v6, s[12:15], s53 offen offset:1024 sc1
v_add_f32 v37, v37, v41
v_add_f32 v38, v38, v42
v_xor_b32 v10, v10, v8
v_mfma_f32_16x16x32_bf16 v[88:91], a[168:171], v[232:235], v[88:91]
v_add_f32 v39, v39, v43
v_add_f32 v32, v32, v44
v_xor_b32 v156, s52, v156
v_mfma_f32_16x16x32_bf16 v[88:91], a[204:207], v[236:239], v[88:91]
v_add_f32 v33, v33, v45
v_add_f32 v34, v34, v46
v_bitop3_b32 v8, v160, v161, v162 bitop3:0x96
v_mfma_f32_16x16x32_bf16 v[88:91], a[240:243], v[240:243], v[88:91]
v_add_f32 v35, v35, v47
v_add_f32 v32, v32, v36
v_bitop3_b32 v11, v11, v163, s48 bitop3:0x96
v_xor_b32 v11, v11, v8
v_mfma_f32_16x16x32_bf16 v[92:95], v[128:131], v[208:211], 0
v_add_f32 v33, v33, v37
v_add_f32 v34, v34, v38
v_xor_b32 v160, s52, v160
v_mfma_f32_16x16x32_bf16 v[92:95], v[200:203], v[212:215], v[92:95]
v_add_f32 v35, v35, v39
v_add_f32 v60, v60, v61
v_bitop3_b32 v8, v164, v165, v166 bitop3:0x96
v_mfma_f32_16x16x32_bf16 v[92:95], a[28:31], v[216:219], v[92:95]
ds_write_b64 v23, v[88:89] offset:32768
v_add_f32 v62, v62, v63
v_add_f32 v60, v60, v62
v_bitop3_b32 v12, v12, v167, s48 bitop3:0x96
v_mfma_f32_16x16x32_bf16 v[92:95], a[64:67], v[220:223], v[92:95]
ds_write_b64 v23, v[90:91] offset:33280
v_xor_b32 v12, v12, v8
v_mfma_f32_16x16x32_bf16 v[92:95], a[100:103], v[224:227], v[92:95]
v_xor_b32 v164, s52, v164
v_or3_b32 v8, v10, v11, v12
v_mfma_f32_16x16x32_bf16 v[92:95], a[136:139], v[228:231], v[92:95]
v_lshlrev_b32 v22, 16, v144
v_cmp_ne_u16 vcc, 0, v8
v_mfma_f32_16x16x32_bf16 v[92:95], a[172:175], v[232:235], v[92:95]
s_cbranch_vccnz C_t0
C_t0_r:
v_mfma_f32_16x16x32_bf16 v[92:95], a[208:211], v[236:239], v[92:95]
v_add_f32 v10, v10, v11
v_add_f32 v10, v10, v12
v_mfma_f32_16x16x32_bf16 v[92:95], a[244:247], v[240:243], v[92:95]
v_lshlrev_b32 v13, 16, v136
v_and_b32 v144, 0xffff0000, v144
v_mfma_f32_16x16x32_bf16 v[28:31], v[152:155], v[156:159], v[28:31]
v_and_b32 v136, 0xffff0000, v136
v_mul_f32 v22, v22, v20
v_mfma_f32_16x16x32_bf16 v[32:35], v[150:153], v[156:159], v[32:35]
v_mul_f32 v144, v144, v20
v_mul_f32 v144, v144, v136
v_mfma_f32_16x16x32_bf16 v[28:31], v[152:155], v[160:163], v[28:31]
ds_write_b64 v23, v[92:93] offset:33792
v_mfma_f32_16x16x32_bf16 v[32:35], v[150:153], v[160:163], v[32:35]
ds_write_b64 v23, v[94:95] offset:34304
v_mfma_f32_16x16x32_bf16 v[28:31], v[152:155], v[164:167], v[28:31]
v_mul_f32 v136, v22, v13
v_lshlrev_b32 v22, 16, v145
v_mfma_f32_16x16x32_bf16 v[32:35], v[150:153], v[164:167], v[32:35]
v_lshlrev_b32 v13, 16, v137
v_and_b32 v145, 0xffff0000, v145
v_mfma_f32_16x16x32_bf16 v[96:99], v[168:171], v[208:211], 0
v_and_b32 v137, 0xffff0000, v137
v_mul_f32 v22, v22, v20
v_mfma_f32_16x16x32_bf16 v[96:99], v[204:207], v[212:215], v[96:99]
v_mul_f32 v145, v145, v20
v_mul_f32 v145, v145, v137
v_mfma_f32_16x16x32_bf16 v[96:99], a[32:35], v[216:219], v[96:99]
v_mul_f32 v137, v22, v13
v_lshlrev_b32 v22, 16, v146
v_mfma_f32_16x16x32_bf16 v[96:99], a[68:71], v[220:223], v[96:99]
v_lshlrev_b32 v13, 16, v138
v_and_b32 v146, 0xffff0000, v146
v_mfma_f32_16x16x32_bf16 v[96:99], a[104:107], v[224:227], v[96:99]
v_and_b32 v138, 0xffff0000, v138
v_mul_f32 v22, v22, v20
v_mfma_f32_16x16x32_bf16 v[96:99], a[140:143], v[228:231], v[96:99]
v_mul_f32 v146, v146, v20
v_mul_f32 v146, v146, v138
v_mfma_f32_16x16x32_bf16 v[96:99], a[176:179], v[232:235], v[96:99]
v_mul_f32 v138, v22, v13
v_lshlrev_b32 v22, 16, v147
v_mfma_f32_16x16x32_bf16 v[96:99], a[212:215], v[236:239], v[96:99]
v_lshlrev_b32 v13, 16, v139
v_and_b32 v147, 0xffff0000, v147
v_mfma_f32_16x16x32_bf16 v[96:99], a[248:251], v[240:243], v[96:99]
v_and_b32 v139, 0xffff0000, v139
v_mul_f32 v22, v22, v20
v_mfma_f32_16x16x32_bf16 v[64:67], v[100:103], v[208:211], 0
v_mul_f32 v147, v147, v20
v_mul_f32 v147, v147, v139
v_mfma_f32_16x16x32_bf16 v[64:67], v[172:175], v[212:215], v[64:67]
v_mul_f32 v139, v22, v13
v_sub_f32 v20, 1.0, v20
v_mfma_f32_16x16x32_bf16 v[64:67], a[0:3], v[216:219], v[64:67]
ds_write_b64 v23, v[96:97] offset:34816
v_mfma_f32_16x16x32_bf16 v[64:67], a[36:39], v[220:223], v[64:67]
ds_write_b64 v23, v[98:99] offset:35328
v_mfma_f32_16x16x32_bf16 v[64:67], a[72:75], v[224:227], v[64:67]
s_waitcnt vmcnt(0)
v_bitop3_b32 v8, v48, v49, v50 bitop3:0x96
v_bitop3_b32 v16, v16, v51, s48 bitop3:0x96
v_mfma_f32_16x16x32_bf16 v[64:67], a[108:111], v[228:231], v[64:67]
v_xor_b32 v16, v16, v8
v_xor_b32 v48, s52, v48
v_mfma_f32_16x16x32_bf16 v[64:67], a[144:147], v[232:235], v[64:67]
v_bitop3_b32 v8, v52, v53, v54 bitop3:0x96
v_bitop3_b32 v17, v17, v55, s48 bitop3:0x96
v_mfma_f32_16x16x32_bf16 v[64:67], a[180:183], v[236:239], v[64:67]
s_waitcnt lgkmcnt(0)
s_barrier
v_mfma_f32_16x16x32_bf16 v[64:67], a[216:219], v[240:243], v[64:67]
ds_read2st64_b64 v[244:247], v2 offset0:56 offset1:57
ds_read2st64_b64 v[248:251], v3 offset0:60 offset1:61
v_mfma_f32_16x16x32_bf16 v[68:71], v[104:107], v[208:211], 0
ds_read2st64_b64 v[252:255], v4 offset0:64 offset1:65
ds_read2st64_b64 v[72:75], v2 offset0:58 offset1:59
v_mfma_f32_16x16x32_bf16 v[68:71], v[176:179], v[212:215], v[68:71]
ds_read2st64_b64 v[76:79], v3 offset0:62 offset1:63
ds_read2st64_b64 v[80:83], v4 offset0:66 offset1:67
v_mfma_f32_16x16x32_bf16 v[68:71], a[4:7], v[216:219], v[68:71]
ds_read2st64_b32 v[96:97], v5 offset0:136 offset1:164
ds_read2st64_b32 v[98:99], v5 offset0:192 offset1:220
v_mfma_f32_16x16x32_bf16 v[68:71], a[40:43], v[220:223], v[68:71]
v_xor_b32 v17, v17, v8
v_xor_b32 v52, s52, v52
v_mfma_f32_16x16x32_bf16 v[68:71], a[76:79], v[224:227], v[68:71]
v_bitop3_b32 v8, v56, v57, v58 bitop3:0x96
v_bitop3_b32 v26, v26, v59, s48 bitop3:0x96
v_mfma_f32_16x16x32_bf16 v[68:71], a[112:115], v[228:231], v[68:71]
v_xor_b32 v26, v26, v8
v_xor_b32 v56, s52, v56
v_mfma_f32_16x16x32_bf16 v[68:71], a[148:151], v[232:235], v[68:71]
v_or3_b32 v8, v16, v17, v26
v_cmp_ne_u16 vcc, 0, v8
v_mfma_f32_16x16x32_bf16 v[68:71], a[184:187], v[236:239], v[68:71]
s_waitcnt lgkmcnt(5)
v_add_f32 v244, v244, v248
v_add_f32 v245, v245, v249
s_cbranch_vccnz C_t1
C_t1_r:
v_add_f32 v16, v16, v17
v_mfma_f32_16x16x32_bf16 v[68:71], a[220:223], v[240:243], v[68:71]
v_add_f32 v246, v246, v250
v_add_f32 v247, v247, v251
v_add_f32 v16, v16, v26
v_mfma_f32_16x16x32_bf16 v[64:67], v[152:155], v[48:51], v[64:67]
v_add_f32 v244, v244, v252
v_add_f32 v245, v245, v253
v_mfma_f32_16x16x32_bf16 v[68:71], v[150:153], v[48:51], v[68:71]
v_add_f32 v246, v246, v254
v_add_f32 v247, v247, v255
v_mfma_f32_16x16x32_bf16 v[64:67], v[152:155], v[52:55], v[64:67]
s_waitcnt lgkmcnt(0)
v_add_f32 v72, v72, v76
v_add_f32 v73, v73, v77
v_mfma_f32_16x16x32_bf16 v[68:71], v[150:153], v[52:55], v[68:71]
v_add_f32 v74, v74, v78
v_add_f32 v75, v75, v79
v_add_f32 v72, v72, v80
v_add_f32 v73, v73, v81
v_add_f32 v74, v74, v82
v_add_f32 v75, v75, v83
v_add_f32 v96, v96, v97
v_add_f32 v98, v98, v99
v_add_f32 v96, v96, v98
v_fma_f32 v136, v244, v20, v136
v_fma_f32 v144, v245, v20, v144
v_fma_f32 v137, v246, v20, v137
v_fma_f32 v145, v247, v20, v145
v_fma_f32 v138, v72, v20, v138
v_fma_f32 v146, v73, v20, v146
v_fma_f32 v139, v74, v20, v139
v_fma_f32 v147, v75, v20, v147
v_mfma_f32_16x16x32_bf16 v[64:67], v[152:155], v[56:59], v[64:67]
v_lshlrev_b32 v148, 16, v148
v_lshlrev_b32 v18, 16, v18
v_mfma_f32_16x16x32_bf16 v[68:71], v[150:153], v[56:59], v[68:71]
v_mul_f32 v148, v148, v24
v_sub_f32 v24, 1.0, v24
v_mul_f32 v148, v148, v18
v_lshlrev_b32 v149, 16, v149
v_lshlrev_b32 v21, 16, v21
v_mul_f32 v149, v149, v25
v_sub_f32 v25, 1.0, v25
v_mul_f32 v149, v149, v21
v_add_f32 v60, v60, v10
v_fma_f32 v60, v60, v24, v148
v_cvt_pk_bf16_f32 v60, v60, v60
s_add_u32 s59, s38, 0
buffer_store_short v60, v15, s[68:71], s59 offen
v_fma_f32 v132, v28, v19, v132
v_fma_f32 v140, v29, v19, v140
v_fma_f32 v133, v30, v19, v133
v_fma_f32 v141, v31, v19, v141
v_fma_f32 v134, v32, v19, v134
v_fma_f32 v142, v33, v19, v142
v_fma_f32 v135, v34, v19, v135
v_fma_f32 v143, v35, v19, v143
v_cvt_pk_bf16_f32 v132, v132, v140
v_cvt_pk_bf16_f32 v133, v133, v141
v_cvt_pk_bf16_f32 v134, v134, v142
v_cvt_pk_bf16_f32 v135, v135, v143
s_nop 0
v_permlane16_swap_b32 v132, v134
v_permlane16_swap_b32 v133, v135
buffer_store_dwordx4 v[132:135], v14, s[68:71], s59 offen
v_add_f32 v96, v96, v16
v_fma_f32 v96, v96, v25, v149
v_cvt_pk_bf16_f32 v96, v96, v96
s_add_u32 s61, s38, 18432
buffer_store_short v96, v15, s[68:71], s61 offen
v_fma_f32 v136, v64, v20, v136
v_fma_f32 v144, v65, v20, v144
v_fma_f32 v137, v66, v20, v137
v_fma_f32 v145, v67, v20, v145
v_fma_f32 v138, v68, v20, v138
v_fma_f32 v146, v69, v20, v146
v_fma_f32 v139, v70, v20, v139
v_fma_f32 v147, v71, v20, v147
v_cvt_pk_bf16_f32 v136, v136, v144
v_cvt_pk_bf16_f32 v137, v137, v145
v_cvt_pk_bf16_f32 v138, v138, v146
v_cvt_pk_bf16_f32 v139, v139, v147
s_nop 0
v_permlane16_swap_b32 v136, v138
v_permlane16_swap_b32 v137, v139
buffer_store_dwordx4 v[136:139], v14, s[68:71], s61 offen
K_end:
s_endpgm
A_c1:
s_mov_b32 s62, 0
A_c1_p:
buffer_load_dword v8, v7, s[12:15], 0 offen sc1
s_add_u32 s62, s62, 1
s_cmp_gt_u32 s62, 200000
s_cbranch_scc1 A_c1_x
s_waitcnt vmcnt(0)
s_add_u32 s63, s92, 6
v_subrev_u32 v60, s63, v8
v_cmp_lt_u32 vcc, 7, v60
s_and_b64 vcc, vcc, 262143
s_cbranch_vccnz A_c1_p
A_c1_x:
s_branch A_c1_r
A_c0:
s_mov_b32 s62, 0
A_c0_p:
buffer_load_dword v8, v7, s[12:15], 0 offen sc1
s_add_u32 s62, s62, 1
s_cmp_gt_u32 s62, 200000
s_cbranch_scc1 A_c0_x
s_waitcnt vmcnt(0)
s_add_u32 s63, s92, 6
v_subrev_u32 v132, s63, v8
v_cmp_lt_u32 vcc, 7, v132
s_and_b64 vcc, vcc, 262143
s_cbranch_vccnz A_c0_p
A_c0_x:
s_branch A_c0_r
C_s1:
s_mov_b32 s62, 0
C_s1_p:
buffer_load_dword v8, v7, s[12:15], 0 offen sc1
s_add_u32 s62, s62, 1
s_cmp_gt_u32 s62, 200000
s_cbranch_scc1 C_s1_x
s_waitcnt vmcnt(0)
s_add_u32 s63, s92, 7
v_subrev_u32 v244, s63, v8
v_cmp_lt_u32 vcc, 7, v244
s_and_b64 vcc, vcc, 262143
s_cbranch_vccnz C_s1_p
C_s1_x:
s_branch C_r1
C_t0:
s_mov_b32 s62, 0
C_t0_p:
s_add_u32 s60, s47, 0
buffer_load_dwordx4 v[156:159], v9, s[12:15], s60 offen sc1
buffer_load_dword v10, v6, s[12:15], s60 offen offset:1024 sc1
s_add_u32 s60, s47, 10240
buffer_load_dwordx4 v[160:163], v9, s[12:15], s60 offen sc1
buffer_load_dword v11, v6, s[12:15], s60 offen offset:1024 sc1
s_add_u32 s60, s47, 20480
buffer_load_dwordx4 v[164:167], v9, s[12:15], s60 offen sc1
buffer_load_dword v12, v6, s[12:15], s60 offen offset:1024 sc1
s_add_u32 s62, s62, 1
s_cmp_gt_u32 s62, 200000
s_cbranch_scc1 C_t0_x
s_waitcnt vmcnt(0)
v_bitop3_b32 v8, v156, v157, v158 bitop3:0x96
v_bitop3_b32 v10, v10, v159, s48 bitop3:0x96
v_xor_b32 v10, v10, v8
v_xor_b32 v156, s52, v156
v_bitop3_b32 v8, v160, v161, v162 bitop3:0x96
v_bitop3_b32 v11, v11, v163, s48 bitop3:0x96
v_xor_b32 v11, v11, v8
v_xor_b32 v160, s52, v160
v_bitop3_b32 v8, v164, v165, v166 bitop3:0x96
v_bitop3_b32 v12, v12, v167, s48 bitop3:0x96
v_xor_b32 v12, v12, v8
v_xor_b32 v164, s52, v164
v_or3_b32 v8, v10, v11, v12
v_cmp_ne_u16 vcc, 0, v8
s_cbranch_vccnz C_t0_p
C_t0_x:
s_branch C_t0_r
C_t1:
s_mov_b32 s62, 0
C_t1_p:
s_add_u32 s60, s47, 5120
buffer_load_dwordx4 v[48:51], v9, s[12:15], s60 offen sc1
buffer_load_dword v16, v6, s[12:15], s60 offen offset:1024 sc1
s_add_u32 s60, s47, 15360
buffer_load_dwordx4 v[52:55], v9, s[12:15], s60 offen sc1
buffer_load_dword v17, v6, s[12:15], s60 offen offset:1024 sc1
s_add_u32 s60, s47, 25600
buffer_load_dwordx4 v[56:59], v9, s[12:15], s60 offen sc1
buffer_load_dword v26, v6, s[12:15], s60 offen offset:1024 sc1
s_add_u32 s62, s62, 1
s_cmp_gt_u32 s62, 200000
s_cbranch_scc1 C_t1_x
s_waitcnt vmcnt(0)
v_bitop3_b32 v8, v48, v49, v50 bitop3:0x96
v_bitop3_b32 v16, v16, v51, s48 bitop3:0x96
v_xor_b32 v16, v16, v8
v_xor_b32 v48, s52, v48
v_bitop3_b32 v8, v52, v53, v54 bitop3:0x96
v_bitop3_b32 v17, v17, v55, s48 bitop3:0x96
v_xor_b32 v17, v17, v8
v_xor_b32 v52, s52, v52
v_bitop3_b32 v8, v56, v57, v58 bitop3:0x96
v_bitop3_b32 v26, v26, v59, s48 bitop3:0x96
v_xor_b32 v26, v26, v8
v_xor_b32 v56, s52, v56
v_or3_b32 v8, v16, v17, v26
v_cmp_ne_u16 vcc, 0, v8
s_cbranch_vccnz C_t1_p
C_t1_x:
s_branch C_t1_r
C_s2:
s_mov_b32 s62, 0
C_s2_p:
buffer_load_dword v8, v7, s[12:15], 0 offen sc1
s_add_u32 s62, s62, 1
s_cmp_gt_u32 s62, 200000
s_cbranch_scc1 C_s2_x
s_waitcnt vmcnt(0)
v_subrev_u32 v244, s43, v8
v_cmp_lt_u32 vcc, 7, v244
s_and_b64 vcc, vcc, s[44:45]
s_cbranch_vccnz C_s2_p
C_s2_x:
s_branch C_r2
C_s3:
s_mov_b32 s62, 0
C_s3_p:
buffer_load_dword v8, v7, s[12:15], 0 offen sc1
s_add_u32 s62, s62, 1
s_cmp_gt_u32 s62, 200000
s_cbranch_scc1 C_s3_x
s_waitcnt vmcnt(0)
v_subrev_u32 v244, s43, v8
v_cmp_lt_u32 vcc, 7, v244
s_and_b64 vcc, vcc, s[44:45]
s_cbranch_vccnz C_s3_p
C_s3_x:
s_branch C_r3
A_e4:
s_movk_i32 s33, 1056
s_movk_i32 s36, 1152
s_mov_b64 s[72:73], s[64:65]
s_mov_b32 s74, s66
v_mov_b32 v212, v216
v_mov_b32 v213, v217
s_mov_b64 s[76:77], s[64:65]
s_mov_b32 s78, s66
v_mov_b32 v214, v216
v_mov_b32 v215, v217
s_branch A_l0
A_e3:
s_xor_b32 s62, s3, 32
s_lshl_b32 s62, s62, 2
s_add_u32 s62, s62, s24
s_mul_i32 s62, s62, 5376
s_mul_i32 s63, s56, 1327104
s_add_u32 s62, s62, s63
v_min_u32 v218, 41, v0
v_lshlrev_b32 v218, 7, v218
buffer_load_dword v219, v218, s[64:67], s62 offen offset:512
s_add_u32 s41, s95, 15360
s_add_u32 s20, s95, 15872
s_mov_b32 s44, 2146435072
s_add_u32 s42, s95, 20480
s_add_u32 s21, s95, 20992
s_mov_b32 s45, 2146435072
s_add_u32 s43, s95, 20480
s_add_u32 s22, s95, 20992
s_mov_b32 s46, 2146435072
s_branch A_loop
A_e2:
s_add_u32 s41, s95, 5120
s_add_u32 s20, s95, 5632
s_add_u32 s44, s96, 18432
s_add_u32 s42, s95, 10240
s_add_u32 s21, s95, 10752
s_add_u32 s45, s96, 36864
s_add_u32 s43, s95, 15360
s_add_u32 s22, s95, 15872
s_add_u32 s46, s96, 55296
s_cmp_ge_u32 s26, 4
s_cbranch_scc1 A_loop
s_lshl_b32 s60, s27, 3
s_and_b32 s40, s24, 2
s_lshl_b32 s40, s40, 1
s_add_u32 s60, s60, s40
s_load_dword s30, s[84:85], s60
s_load_dwordx2 s[80:81], s[0:1], 32
s_xor_b32 s62, s3, 32
s_lshl_b32 s62, s62, 2
s_add_u32 s62, s62, s24
s_mul_i32 s62, s62, 5376
s_mul_i32 s63, s56, 1327104
s_add_u32 s62, s62, s63
v_min_u32 v218, 41, v0
v_lshlrev_b32 v218, 7, v218
buffer_load_dword v219, v218, s[64:67], s62 offen offset:512
v_and_b32 v60, 3, v0
v_bfe_u32 v61, v0, 2, 2
v_and_b32 v62, 48, v0
v_lshlrev_b32 v62, 1, v62
v_lshl_add_u32 v62, v60, 3, v62
v_lshlrev_b32 v63, 7, v61
v_sub_u32 v62, v62, v63
s_add_u32 s40, s95, 15744
v_add_u32 v62, s40, v62
ds_read_b64_tr_b16 v[168:169], v62 offset:4608
ds_read_b64_tr_b16 v[170:171], v62 offset:4096
ds_read_b64_tr_b16 v[172:173], v62 offset:3584
ds_read_b64_tr_b16 v[174:175], v62 offset:3072
ds_read_b64_tr_b16 v[176:177], v62 offset:2560
ds_read_b64_tr_b16 v[178:179], v62 offset:2048
ds_read_b64_tr_b16 v[180:181], v62 offset:1536
ds_read_b64_tr_b16 v[182:183], v62 offset:1024
ds_read_b64_tr_b16 v[184:185], v62 offset:512
ds_read_b64_tr_b16 v[186:187], v62 offset:9728
ds_read_b64_tr_b16 v[188:189], v62 offset:9216
ds_read_b64_tr_b16 v[190:191], v62 offset:8704
ds_read_b64_tr_b16 v[192:193], v62 offset:8192
ds_read_b64_tr_b16 v[194:195], v62 offset:7680
ds_read_b64_tr_b16 v[196:197], v62 offset:7168
ds_read_b64_tr_b16 v[198:199], v62 offset:6656
ds_read_b64_tr_b16 v[200:201], v62 offset:6144
s_add_u32 s60, s95, 5120
v_bfe_u32 v63, v0, 1, 2
v_lshlrev_b32 v63, 4, v63
v_lshl_add_u32 v63, v0, 6, v63
v_add_u32 v64, s60, v63
v_xor_b32 v65, 16, v64
v_xor_b32 v66, 32, v64
v_xor_b32 v67, 48, v64
v_lshl_add_u32 v72, v0, 4, s60
v_bfe_u32 v63, v0, 3, 2
v_xor_b32 v63, v63, v0
v_lshlrev_b32 v73, 4, v63
s_lshl_b32 s40, s51, 6
s_sub_u32 s40, s40, s50
s_add_u32 s40, s40, 63
s_mul_i32 s40, s40, 4224
s_add_u32 s40, s40, 18874368
s_waitcnt lgkmcnt(14)
v_alignbit_b32 v102, v169, v168, 16
v_alignbit_b32 v103, v170, v169, 16
v_alignbit_b32 v104, v171, v170, 16
v_alignbit_b32 v105, v172, v171, 16
v_alignbit_b32 v106, v173, v172, 16
v_dot2_f32_bf16 v28, v169, v101, 0
v_dot2_f32_bf16 v29, v103, v101, 0
v_dot2_f32_bf16 v30, v170, v101, 0
v_dot2_f32_bf16 v31, v104, v101, 0
v_dot2_f32_bf16 v32, v171, v101, 0
v_dot2_f32_bf16 v33, v105, v101, 0
v_dot2_f32_bf16 v34, v172, v101, 0
v_dot2_f32_bf16 v35, v106, v101, 0
v_dot2_f32_bf16 v28, v168, v100, v28
v_dot2_f32_bf16 v29, v102, v100, v29
v_dot2_f32_bf16 v30, v169, v100, v30
v_dot2_f32_bf16 v31, v103, v100, v31
v_dot2_f32_bf16 v32, v170, v100, v32
v_dot2_f32_bf16 v33, v104, v100, v33
v_dot2_f32_bf16 v34, v171, v100, v34
v_dot2_f32_bf16 v35, v105, v100, v35
s_waitcnt lgkmcnt(0)
v_lshlrev_b32 v74, 16, v186
v_and_b32 v75, 0xffff0000, v186
v_lshlrev_b32 v76, 16, v187
v_and_b32 v77, 0xffff0000, v187
v_lshlrev_b32 v78, 16, v188
v_and_b32 v79, 0xffff0000, v188
v_lshlrev_b32 v80, 16, v189
v_and_b32 v81, 0xffff0000, v189
v_pk_mul_f32 v[28:29], v[28:29], v[74:75]
v_pk_mul_f32 v[30:31], v[30:31], v[76:77]
v_pk_mul_f32 v[32:33], v[32:33], v[78:79]
v_pk_mul_f32 v[34:35], v[34:35], v[80:81]
v_cvt_pk_bf16_f32 v186, v28, v29
v_cvt_pk_bf16_f32 v187, v30, v31
v_cvt_pk_bf16_f32 v188, v32, v33
v_cvt_pk_bf16_f32 v189, v34, v35
ds_write_b128 v64, v[186:189]
v_alignbit_b32 v107, v174, v173, 16
v_alignbit_b32 v108, v175, v174, 16
v_alignbit_b32 v109, v176, v175, 16
v_alignbit_b32 v110, v177, v176, 16
v_dot2_f32_bf16 v36, v173, v101, 0
v_dot2_f32_bf16 v37, v107, v101, 0
v_dot2_f32_bf16 v38, v174, v101, 0
v_dot2_f32_bf16 v39, v108, v101, 0
v_dot2_f32_bf16 v40, v175, v101, 0
v_dot2_f32_bf16 v41, v109, v101, 0
v_dot2_f32_bf16 v42, v176, v101, 0
v_dot2_f32_bf16 v43, v110, v101, 0
v_dot2_f32_bf16 v36, v172, v100, v36
v_dot2_f32_bf16 v37, v106, v100, v37
v_dot2_f32_bf16 v38, v173, v100, v38
v_dot2_f32_bf16 v39, v107, v100, v39
v_dot2_f32_bf16 v40, v174, v100, v40
v_dot2_f32_bf16 v41, v108, v100, v41
v_dot2_f32_bf16 v42, v175, v100, v42
v_dot2_f32_bf16 v43, v109, v100, v43
v_lshlrev_b32 v74, 16, v190
v_and_b32 v75, 0xffff0000, v190
v_lshlrev_b32 v76, 16, v191
v_and_b32 v77, 0xffff0000, v191
v_lshlrev_b32 v78, 16, v192
v_and_b32 v79, 0xffff0000, v192
v_lshlrev_b32 v80, 16, v193
v_and_b32 v81, 0xffff0000, v193
v_pk_mul_f32 v[36:37], v[36:37], v[74:75]
v_pk_mul_f32 v[38:39], v[38:39], v[76:77]
v_pk_mul_f32 v[40:41], v[40:41], v[78:79]
v_pk_mul_f32 v[42:43], v[42:43], v[80:81]
v_cvt_pk_bf16_f32 v190, v36, v37
v_cvt_pk_bf16_f32 v191, v38, v39
v_cvt_pk_bf16_f32 v192, v40, v41
v_cvt_pk_bf16_f32 v193, v42, v43
ds_write_b128 v65, v[190:193]
v_alignbit_b32 v111, v178, v177, 16
v_alignbit_b32 v112, v179, v178, 16
v_alignbit_b32 v113, v180, v179, 16
v_alignbit_b32 v114, v181, v180, 16
v_dot2_f32_bf16 v44, v177, v101, 0
v_dot2_f32_bf16 v45, v111, v101, 0
v_dot2_f32_bf16 v46, v178, v101, 0
v_dot2_f32_bf16 v47, v112, v101, 0
v_dot2_f32_bf16 v48, v179, v101, 0
v_dot2_f32_bf16 v49, v113, v101, 0
v_dot2_f32_bf16 v50, v180, v101, 0
v_dot2_f32_bf16 v51, v114, v101, 0
v_dot2_f32_bf16 v44, v176, v100, v44
v_dot2_f32_bf16 v45, v110, v100, v45
v_dot2_f32_bf16 v46, v177, v100, v46
v_dot2_f32_bf16 v47, v111, v100, v47
v_dot2_f32_bf16 v48, v178, v100, v48
v_dot2_f32_bf16 v49, v112, v100, v49
v_dot2_f32_bf16 v50, v179, v100, v50
v_dot2_f32_bf16 v51, v113, v100, v51
v_lshlrev_b32 v74, 16, v194
v_and_b32 v75, 0xffff0000, v194
v_lshlrev_b32 v76, 16, v195
v_and_b32 v77, 0xffff0000, v195
v_lshlrev_b32 v78, 16, v196
v_and_b32 v79, 0xffff0000, v196
v_lshlrev_b32 v80, 16, v197
v_and_b32 v81, 0xffff0000, v197
v_pk_mul_f32 v[44:45], v[44:45], v[74:75]
v_pk_mul_f32 v[46:47], v[46:47], v[76:77]
v_pk_mul_f32 v[48:49], v[48:49], v[78:79]
v_pk_mul_f32 v[50:51], v[50:51], v[80:81]
v_cvt_pk_bf16_f32 v194, v44, v45
v_cvt_pk_bf16_f32 v195, v46, v47
v_cvt_pk_bf16_f32 v196, v48, v49
v_cvt_pk_bf16_f32 v197, v50, v51
ds_write_b128 v66, v[194:197]
v_alignbit_b32 v115, v182, v181, 16
v_alignbit_b32 v116, v183, v182, 16
v_alignbit_b32 v117, v184, v183, 16
v_alignbit_b32 v118, v185, v184, 16
v_dot2_f32_bf16 v52, v181, v101, 0
v_dot2_f32_bf16 v53, v115, v101, 0
v_dot2_f32_bf16 v54, v182, v101, 0
v_dot2_f32_bf16 v55, v116, v101, 0
v_dot2_f32_bf16 v56, v183, v101, 0
v_dot2_f32_bf16 v57, v117, v101, 0
v_dot2_f32_bf16 v58, v184, v101, 0
v_dot2_f32_bf16 v59, v118, v101, 0
v_dot2_f32_bf16 v52, v180, v100, v52
v_dot2_f32_bf16 v53, v114, v100, v53
v_dot2_f32_bf16 v54, v181, v100, v54
v_dot2_f32_bf16 v55, v115, v100, v55
v_dot2_f32_bf16 v56, v182, v100, v56
v_dot2_f32_bf16 v57, v116, v100, v57
v_dot2_f32_bf16 v58, v183, v100, v58
v_dot2_f32_bf16 v59, v117, v100, v59
v_lshlrev_b32 v74, 16, v198
v_and_b32 v75, 0xffff0000, v198
v_lshlrev_b32 v76, 16, v199
v_and_b32 v77, 0xffff0000, v199
v_lshlrev_b32 v78, 16, v200
v_and_b32 v79, 0xffff0000, v200
v_lshlrev_b32 v80, 16, v201
v_and_b32 v81, 0xffff0000, v201
v_pk_mul_f32 v[52:53], v[52:53], v[74:75]
v_pk_mul_f32 v[54:55], v[54:55], v[76:77]
v_pk_mul_f32 v[56:57], v[56:57], v[78:79]
v_pk_mul_f32 v[58:59], v[58:59], v[80:81]
v_cvt_pk_bf16_f32 v198, v52, v53
v_cvt_pk_bf16_f32 v199, v54, v55
v_cvt_pk_bf16_f32 v200, v56, v57
v_cvt_pk_bf16_f32 v201, v58, v59
ds_write_b128 v67, v[198:201]
ds_read_b128 v[168:171], v72 offset:0
ds_read_b128 v[172:175], v72 offset:1024
ds_read_b128 v[176:179], v72 offset:2048
ds_read_b128 v[180:183], v72 offset:3072
v_mov_b32 v48, s92
s_lshl_b32 s60, s51, 6
s_add_u32 s60, s60, s50
s_lshl_b32 s60, s60, 5
s_add_u32 s37, s60, 23726208
s_movk_i32 s33, 1056
s_movk_i32 s36, 1152
s_mov_b64 s[72:73], s[64:65]
s_mov_b32 s74, s66
v_mov_b32 v212, v216
v_mov_b32 v213, v217
s_mov_b64 s[76:77], s[64:65]
s_mov_b32 s78, s66
v_mov_b32 v214, v216
v_mov_b32 v215, v217
s_waitcnt lgkmcnt(3)
buffer_store_dwordx4 v[168:171], v73, s[12:15], s40 offen offset:0 sc1
s_waitcnt lgkmcnt(2)
buffer_store_dwordx4 v[172:175], v73, s[12:15], s40 offen offset:1024 sc1
s_waitcnt lgkmcnt(1)
buffer_store_dwordx4 v[176:179], v73, s[12:15], s40 offen offset:2048 sc1
s_waitcnt lgkmcnt(0)
buffer_store_dwordx4 v[180:183], v73, s[12:15], s40 offen offset:3072 sc1
s_waitcnt lgkmcnt(0)
s_branch A_loop
A_e1:
ds_read_b64_tr_b16 v[100:101], v14 offset:0
ds_read_b64_tr_b16 v[104:105], v14 offset:32
ds_read_b64_tr_b16 v[108:109], v14 offset:64
ds_read_b64_tr_b16 v[112:113], v14 offset:96
ds_read_b64_tr_b16 v[116:117], v15 offset:128
ds_read_b64_tr_b16 v[120:121], v15 offset:160
ds_read_b64_tr_b16 v[124:125], v15 offset:192
ds_read_b64_tr_b16 v[128:129], v15 offset:224
ds_read_b64_tr_b16 v[168:169], v16 offset:0
ds_read_b64_tr_b16 v[102:103], v14 offset:5120
ds_read_b64_tr_b16 v[106:107], v14 offset:5152
ds_read_b64_tr_b16 v[110:111], v14 offset:5184
ds_read_b64_tr_b16 v[114:115], v14 offset:5216
ds_read_b64_tr_b16 v[118:119], v15 offset:5248
ds_read_b64_tr_b16 v[122:123], v15 offset:5280
ds_read_b64_tr_b16 v[126:127], v15 offset:5312
ds_read_b64_tr_b16 v[130:131], v15 offset:5344
ds_read_b64_tr_b16 v[170:171], v16 offset:5120
ds_read_b64_tr_b16 v[172:173], v14 offset:10240
ds_read_b64_tr_b16 v[176:177], v14 offset:10272
ds_read_b64_tr_b16 v[180:181], v14 offset:10304
ds_read_b64_tr_b16 v[184:185], v14 offset:10336
ds_read_b64_tr_b16 v[188:189], v15 offset:10368
ds_read_b64_tr_b16 v[192:193], v15 offset:10400
ds_read_b64_tr_b16 v[196:197], v15 offset:10432
ds_read_b64_tr_b16 v[200:201], v15 offset:10464
ds_read_b64_tr_b16 v[204:205], v16 offset:10240
s_add_u32 s41, s95, 0
s_add_u32 s20, s95, 512
s_add_u32 s44, s96, 73728
s_add_u32 s42, s95, 5120
s_add_u32 s21, s95, 5632
s_add_u32 s45, s96, 92160
s_add_u32 s43, s95, 10240
s_add_u32 s22, s95, 10752
s_add_u32 s46, s96, 110592
s_add_u32 s47, s96, 165888
v_mov_b32 v20, 163840
s_cmp_ge_u32 s26, 4
s_cbranch_scc1 A_e1x
s_lshr_b32 s40, s27, 4
s_lshl_b32 s40, s40, 11
s_add_u32 s48, s40, 23726208
s_mov_b64 s[72:73], s[80:81]
s_mov_b32 s74, 2359296
s_mov_b64 s[16:17], s[12:13]
s_mov_b32 s18, s14
s_mov_b64 s[52:53], -1
v_mov_b32 v28, 0
v_mov_b32 v29, 0
v_lshl_add_u32 v30, v0, 3, s95
ds_write_b64 v30, v[28:29]
s_lshl_b32 s40, s27, 2
s_add_u32 s40, s40, s24
s_add_u32 s47, s96, 73728
v_mov_b32 v212, 2146435072
v_lshlrev_b32 v213, 4, v0
v_lshrrev_b32 v30, 2, v0
v_mul_u32_u24 v30, 4160, v30
v_add_u32 v217, v30, v213
v_mov_b32 v216, v212
v_add_u32 v20, s95, v213
s_movk_i32 s33, 1024
s_movk_i32 s23, 1024
s_movk_i32 s36, 1024
s_mov_b32 s34, 67584
s_add_u32 s41, s95, 4608
s_add_u32 s22, s95, 4608
s_add_u32 s43, s95, 8704
s_add_u32 s21, s95, 8768
s_add_u32 s42, s95, 12864
s_lshl_b32 s44, s40, 12
s_lshr_b32 s55, s40, 6
s_mul_i32 s55, s55, 266240
s_lshl_b32 s40, s40, 6
s_add_u32 s40, s40, s55
s_add_u32 s46, s40, 18874368
s_mov_b32 s45, 2146435072
A_e1x:
s_waitcnt vmcnt(7)
s_lshl_b32 s60, s56, 2
s_add_u32 s60, s60, s24
s_lshl_b32 s60, s60, 5
s_add_u32 s60, s60, 23744640
ds_read_b64_tr_b16 v[174:175], v14 offset:15360
ds_read_b64_tr_b16 v[178:179], v14 offset:15392
ds_read_b64_tr_b16 v[182:183], v14 offset:15424
ds_read_b64_tr_b16 v[186:187], v14 offset:15456
ds_read_b64_tr_b16 v[190:191], v15 offset:15488
ds_read_b64_tr_b16 v[194:195], v15 offset:15520
ds_read_b64_tr_b16 v[198:199], v15 offset:15552
ds_read_b64_tr_b16 v[202:203], v15 offset:15584
ds_read_b64_tr_b16 v[206:207], v16 offset:15360
buffer_load_dword v223, v27, s[12:15], s60 offen sc1
s_waitcnt lgkmcnt(0)
s_branch A_loop
A_s0:
s_mov_b32 s62, 0
A_s0_p:
buffer_load_dword v221, v220, s[12:15], s48 offen sc1
s_add_u32 s62, s62, 1
s_cmp_gt_u32 s62, 200000
s_cbranch_scc1 A_s0_x
s_waitcnt vmcnt(0)
s_add_u32 s63, s92, 8
v_subrev_u32 v51, s63, v221
v_cmp_lt_u32 vcc, 7, v51
s_and_b64 vcc, vcc, -1
s_cbranch_vccnz A_s0_p
A_s0_x:
s_branch A_r0
A_s5:
s_lshl_b32 s60, s56, 2
s_add_u32 s60, s60, s24
s_lshl_b32 s60, s60, 5
s_add_u32 s60, s60, 23744640
s_mov_b32 s62, 0
A_s5_p:
buffer_load_dword v223, v27, s[12:15], s60 offen sc1
s_add_u32 s62, s62, 1
s_cmp_gt_u32 s62, 200000
s_cbranch_scc1 A_s5_x
s_waitcnt vmcnt(0)
s_add_u32 s63, s92, 8
v_subrev_u32 v51, s63, v223
v_cmp_lt_u32 vcc, 7, v51
s_and_b64 vcc, vcc, 1
s_cbranch_vccnz A_s5_p
A_s5_x:
s_branch A_r5
A_conv:
v_and_b32 v132, 15, v0
v_lshrrev_b32 v133, 4, v0
v_sub_u32 v134, 3, v132
v_and_b32 v134, 3, v134
v_mul_u32_u24 v20, 4158, v134
v_sub_u32 v135, 15, v132
v_lshl_add_u32 v135, v133, 3, v135
v_lshl_add_u32 v20, v135, 1, v20
s_add_u32 s60, s95, 4608
v_add_u32 v20, s60, v20
v_lshlrev_b32 v135, 5, v132
v_lshl_add_u32 v21, v133, 4, v135
s_add_u32 s60, s95, 32
v_add_u32 v21, s60, v21
v_and_b32 v134, 16, v0
v_sub_u32 v134, v134, v135
s_add_u32 s60, s95, 5088
v_add_u32 v22, s60, v134
ds_read_b128 a[244:247], v22 offset:3584
ds_read_b128 a[248:251], v22 offset:3072
ds_read_b128 a[252:255], v22 offset:2560
ds_read_b128 v[60:63], v22 offset:2048
ds_read_b128 v[64:67], v22 offset:1536
ds_read_b128 v[68:71], v22 offset:1024
ds_read_b128 v[72:75], v22 offset:512
ds_read_b128 v[76:79], v22 offset:0
ds_read_b128 a[212:215], v21 offset:448
ds_read_b64 a[180:181], v20 offset:4032
ds_read_b128 a[216:219], v21 offset:960
ds_read_b64 a[182:183], v20 offset:4040
ds_read_b64 a[184:185], v20 offset:3520
ds_read_b64 a[186:187], v20 offset:3528
ds_read_b128 a[220:223], v21 offset:1472
ds_read_b64 a[188:189], v20 offset:3008
ds_read_b128 a[224:227], v21 offset:1984
ds_read_b64 a[190:191], v20 offset:3016
ds_read_b64 a[192:193], v20 offset:2496
ds_read_b64 a[194:195], v20 offset:2504
s_lshl_b32 s60, s24, 4
s_lshr_b32 s60, s30, s60
s_and_b32 s60, s60, 0xffff
v_lshl_add_u32 v134, v133, 3, v132
v_sub_u32 v134, 15, v134
v_lshlrev_b32 v24, 4, v134
v_lshlrev_b32 v24, v24, s60
v_ashrrev_i32 v134, 1, v134
v_cmp_eq_u32 vcc, 0, v134
v_cmp_eq_u32 s[40:41], 1, v134
v_cmp_eq_u32 s[42:43], 2, v134
v_cmp_eq_u32 s[44:45], 3, v134
v_cndmask_b32 v152, 0, v24, vcc
v_cndmask_b32 v153, 0, v24, s[40:41]
v_cndmask_b32 v154, 0, v24, s[42:43]
v_cndmask_b32 v155, 0, v24, s[44:45]
ds_read_b128 a[228:231], v21 offset:2496
ds_read_b64 a[196:197], v20 offset:1984
ds_read_b128 a[232:235], v21 offset:3008
ds_read_b64 a[198:199], v20 offset:1992
ds_read_b64 a[200:201], v20 offset:1472
ds_read_b64 a[202:203], v20 offset:1480
ds_read_b128 a[236:239], v21 offset:3520
ds_read_b64 a[204:205], v20 offset:960
ds_read_b128 a[240:243], v21 offset:4032
ds_read_b64 a[206:207], v20 offset:968
ds_read_b64 a[208:209], v20 offset:448
ds_read_b64 a[210:211], v20 offset:456
s_waitcnt lgkmcnt(15)
v_mfma_f32_16x16x32_bf16 v[28:31], v[152:155], a[244:247], 0
v_lshl_add_u32 v135, v133, 3, v135
s_mul_i32 s60, s24, 25664
v_mfma_f32_16x16x32_bf16 v[32:35], v[152:155], a[248:251], 0
s_add_u32 s60, s60, 82688
v_add_u32 v12, s60, v135
v_bfe_u32 v13, v0, 2, 2
v_mfma_f32_16x16x32_bf16 v[36:39], v[152:155], a[252:255], 0
v_mul_u32_u24 v13, 25664, v13
v_lshl_add_u32 v13, v133, 5, v13
v_mfma_f32_16x16x32_bf16 v[40:43], v[152:155], v[60:63], 0
v_and_b32 v135, 3, v0
v_lshl_add_u32 v13, v135, 3, v13
v_mfma_f32_16x16x32_bf16 v[44:47], v[152:155], v[64:67], 0
s_lshl_b32 s60, s24, 10
s_add_u32 s60, s60, 82688
v_add_u32 v13, s60, v13
v_mfma_f32_16x16x32_bf16 v[48:51], v[152:155], v[68:71], 0
ds_read_b64_tr_b16 a[0:1], v17 offset:0
ds_read_b64_tr_b16 a[4:5], v17 offset:32
v_mfma_f32_16x16x32_bf16 v[52:55], v[152:155], v[72:75], 0
s_lshl_b32 s60, s24, 12
ds_read_b64_tr_b16 a[8:9], v17 offset:64
ds_read_b64_tr_b16 a[12:13], v17 offset:96
v_mfma_f32_16x16x32_bf16 v[56:59], v[152:155], v[76:79], 0
ds_read_b64_tr_b16 a[16:17], v18 offset:128
ds_read_b64_tr_b16 a[20:21], v18 offset:160
v_mfma_f32_16x16x32_bf16 v[28:31], a[180:183], a[212:215], v[28:31]
v_lshl_add_u32 v23, v0, 3, s60
s_lshl_b32 s39, s27, 14
v_mfma_f32_16x16x32_bf16 v[32:35], a[180:183], a[216:219], v[32:35]
s_add_u32 s39, s39, 21307392
ds_read_b64_tr_b16 a[24:25], v18 offset:192
ds_read_b64_tr_b16 a[28:29], v18 offset:224
v_mfma_f32_16x16x32_bf16 v[32:35], a[184:187], a[212:215], v[32:35]
s_waitcnt lgkmcnt(15)
ds_read_b64_tr_b16 a[32:33], v19 offset:0
s_mul_i32 s40, s56, 36
v_mfma_f32_16x16x32_bf16 v[36:39], a[180:183], a[220:223], v[36:39]
s_mul_i32 s41, s24, 9
s_add_u32 s40, s40, s41
s_lshl_b32 s28, s40, 10
v_mfma_f32_16x16x32_bf16 v[36:39], a[184:187], a[216:219], v[36:39]
s_mul_i32 s40, s57, 1179648
ds_read_b128 v[80:83], v21 offset:384
ds_read_b64 a[244:245], v20 offset:3968
v_mfma_f32_16x16x32_bf16 v[36:39], a[188:191], a[212:215], v[36:39]
s_add_u32 s28, s28, s40
s_add_u32 s30, s56, 1
v_mfma_f32_16x16x32_bf16 v[40:43], a[180:183], a[224:227], v[40:43]
s_add_u32 m0, s54, 0
ds_read_b128 v[244:247], v21 offset:896
ds_read_b64 a[246:247], v20 offset:3976
v_mfma_f32_16x16x32_bf16 v[40:43], a[184:187], a[220:223], v[40:43]
s_add_u32 s97, s96, 129024
s_waitcnt lgkmcnt(4)
buffer_load_dwordx4 v2, s[12:15], s97 offen sc1 lds
v_mfma_f32_16x16x32_bf16 v[40:43], a[188:191], a[216:219], v[40:43]
s_and_b32 s30, s30, 3
ds_read_b64 a[248:249], v20 offset:3456
ds_read_b64 a[250:251], v20 offset:3464
v_mfma_f32_16x16x32_bf16 v[40:43], a[192:195], a[212:215], v[40:43]
buffer_load_dwordx4 v3, s[64:67], s97 offen offset:512 lds
s_mul_i32 s29, s30, 294912
v_mfma_f32_16x16x32_bf16 v[44:47], a[180:183], a[228:231], v[44:47]
s_add_u32 s29, s29, s28
v_lshlrev_b32 v9, 4, v0
v_add_u32 v10, 4096, v9
v_mfma_f32_16x16x32_bf16 v[44:47], a[184:187], a[224:227], v[44:47]
ds_read_b128 v[248:251], v21 offset:1408
ds_read_b64 a[252:253], v20 offset:2944
v_mfma_f32_16x16x32_bf16 v[44:47], a[188:191], a[220:223], v[44:47]
v_add_u32 v11, 8192, v9
s_add_u32 s63, s92, 6
v_mfma_f32_16x16x32_bf16 v[44:47], a[192:195], a[216:219], v[44:47]
ds_read_b128 v[252:255], v21 offset:1920
ds_read_b64 a[254:255], v20 offset:2952
v_mfma_f32_16x16x32_bf16 v[44:47], a[196:199], a[212:215], v[44:47]
buffer_load_dwordx4 v4, s[64:67], s97 offen offset:1568 lds
v_mfma_f32_16x16x32_bf16 v[48:51], a[180:183], a[232:235], v[48:51]
ds_read_b64 v[60:61], v20 offset:2432
ds_read_b64 v[62:63], v20 offset:2440
v_mfma_f32_16x16x32_bf16 v[48:51], a[184:187], a[228:231], v[48:51]
s_waitcnt vmcnt(10)
v_subrev_u32 v132, s63, v8
v_cmp_lt_u32 vcc, 7, v132
v_mfma_f32_16x16x32_bf16 v[48:51], a[188:191], a[224:227], v[48:51]
buffer_load_dwordx4 v5, s[64:67], s97 offen offset:2624 lds
s_and_b64 vcc, vcc, 262143
v_mfma_f32_16x16x32_bf16 v[48:51], a[192:195], a[220:223], v[48:51]
ds_read_b128 v[208:211], v21 offset:2432
ds_read_b64 v[64:65], v20 offset:1920
v_mfma_f32_16x16x32_bf16 v[48:51], a[196:199], a[216:219], v[48:51]
s_cbranch_vccnz A_c0
A_c0_r:
v_mfma_f32_16x16x32_bf16 v[48:51], a[200:203], a[212:215], v[48:51]
ds_read_b128 v[212:215], v21 offset:2944
ds_read_b64 v[66:67], v20 offset:1928
v_mfma_f32_16x16x32_bf16 v[52:55], a[180:183], a[236:239], v[52:55]
buffer_load_dwordx4 v[132:135], v9, s[12:15], s29 offen offset:0 sc1
v_mul_f32 v224, v84, v84
v_mfma_f32_16x16x32_bf16 v[52:55], a[184:187], a[232:235], v[52:55]
ds_read_b64 v[68:69], v20 offset:1408
ds_read_b64 v[70:71], v20 offset:1416
v_mfma_f32_16x16x32_bf16 v[52:55], a[188:191], a[228:231], v[52:55]
v_mul_f32 v225, v85, v85
v_fma_f32 v224, v224, s35, v26
v_mfma_f32_16x16x32_bf16 v[52:55], a[192:195], a[224:227], v[52:55]
buffer_load_dwordx4 v6, s[64:67], s97 offen offset:3680 lds
v_fma_f32 v225, v225, s35, v26
v_mfma_f32_16x16x32_bf16 v[52:55], a[196:199], a[220:223], v[52:55]
ds_read_b128 v[216:219], v21 offset:3456
ds_read_b64 v[72:73], v20 offset:896
v_mfma_f32_16x16x32_bf16 v[52:55], a[200:203], a[216:219], v[52:55]
v_mul_f32 v224, v84, v224
v_mul_f32 v225, v85, v225
v_mfma_f32_16x16x32_bf16 v[52:55], a[204:207], a[212:215], v[52:55]
ds_read_b128 v[220:223], v21 offset:3968
ds_read_b64 v[74:75], v20 offset:904
v_mfma_f32_16x16x32_bf16 v[56:59], a[180:183], a[240:243], v[56:59]
buffer_load_dwordx4 v[136:139], v9, s[12:15], s29 offen offset:1024 sc1
v_mul_f32 v232, v84, v92
v_mfma_f32_16x16x32_bf16 v[56:59], a[184:187], a[236:239], v[56:59]
ds_read_b64 v[76:77], v20 offset:384
ds_read_b64 v[78:79], v20 offset:392
v_mfma_f32_16x16x32_bf16 v[56:59], a[188:191], a[232:235], v[56:59]
ds_read_b64_tr_b16 a[2:3], v17 offset:20480
ds_read_b64_tr_b16 a[6:7], v17 offset:20512
v_mfma_f32_16x16x32_bf16 v[56:59], a[192:195], a[228:231], v[56:59]
ds_read_b64_tr_b16 a[10:11], v17 offset:20544
ds_read_b64_tr_b16 a[14:15], v17 offset:20576
v_mfma_f32_16x16x32_bf16 v[56:59], a[196:199], a[224:227], v[56:59]
ds_read_b64_tr_b16 a[18:19], v18 offset:20608
ds_read_b64_tr_b16 a[22:23], v18 offset:20640
v_mfma_f32_16x16x32_bf16 v[56:59], a[200:203], a[220:223], v[56:59]
ds_read_b64_tr_b16 a[26:27], v18 offset:20672
ds_read_b64_tr_b16 a[30:31], v18 offset:20704
v_mfma_f32_16x16x32_bf16 v[56:59], a[204:207], a[216:219], v[56:59]
ds_read_b64_tr_b16 a[34:35], v19 offset:20480
v_mul_f32 v233, v85, v93
v_mfma_f32_16x16x32_bf16 v[56:59], a[208:211], a[212:215], v[56:59]
s_waitcnt lgkmcnt(9)
v_exp_f32 v224, v224
v_mfma_f32_16x16x32_bf16 v[28:31], a[244:247], v[80:83], v[28:31]
v_exp_f32 v225, v225
v_mfma_f32_16x16x32_bf16 v[32:35], a[244:247], v[244:247], v[32:35]
ds_read_b128 a[212:215], v21 offset:320
ds_read_b64 a[180:181], v20 offset:3904
v_mfma_f32_16x16x32_bf16 v[32:35], a[248:251], v[80:83], v[32:35]
s_add_u32 m0, s54, 20480
s_add_u32 s97, s96, 147456
v_add_f32 v224, 1.0, v224
v_mfma_f32_16x16x32_bf16 v[36:39], a[244:247], v[248:251], v[36:39]
ds_read_b128 a[216:219], v21 offset:832
ds_read_b64 a[182:183], v20 offset:3912
v_mfma_f32_16x16x32_bf16 v[36:39], a[248:251], v[244:247], v[36:39]
s_waitcnt lgkmcnt(4)
buffer_load_dwordx4 v2, s[12:15], s97 offen sc1 lds
v_add_f32 v225, 1.0, v225
v_mfma_f32_16x16x32_bf16 v[36:39], a[252:255], v[80:83], v[36:39]
buffer_load_dwordx4 v3, s[64:67], s97 offen offset:512 lds
v_mul_f32 v226, v86, v86
v_mfma_f32_16x16x32_bf16 v[40:43], a[244:247], v[252:255], v[40:43]
ds_read_b64 a[184:185], v20 offset:3392
ds_read_b64 a[186:187], v20 offset:3400
v_mfma_f32_16x16x32_bf16 v[40:43], a[248:251], v[248:251], v[40:43]
v_rcp_f32 v224, v224
v_mfma_f32_16x16x32_bf16 v[40:43], a[252:255], v[244:247], v[40:43]
ds_read_b128 a[220:223], v21 offset:1344
ds_read_b64 a[188:189], v20 offset:2880
v_mfma_f32_16x16x32_bf16 v[40:43], v[60:63], v[80:83], v[40:43]
buffer_load_dwordx4 v4, s[64:67], s97 offen offset:1568 lds
v_mul_f32 v232, v232, v224
v_mfma_f32_16x16x32_bf16 v[44:47], a[244:247], v[208:211], v[44:47]
v_rcp_f32 v225, v225
v_mfma_f32_16x16x32_bf16 v[44:47], a[248:251], v[252:255], v[44:47]
ds_read_b128 a[224:227], v21 offset:1856
ds_read_b64 a[190:191], v20 offset:2888
v_mfma_f32_16x16x32_bf16 v[44:47], a[252:255], v[248:251], v[44:47]
v_mul_f32 v233, v233, v225
v_mul_f32 v227, v87, v87
v_mfma_f32_16x16x32_bf16 v[44:47], v[60:63], v[244:247], v[44:47]
ds_read_b64 a[192:193], v20 offset:2368
ds_read_b64 a[194:195], v20 offset:2376
v_mfma_f32_16x16x32_bf16 v[44:47], v[64:67], v[80:83], v[44:47]
buffer_load_dwordx4 v5, s[64:67], s97 offen offset:2624 lds
v_fma_f32 v226, v226, s35, v26
v_mfma_f32_16x16x32_bf16 v[48:51], a[244:247], v[212:215], v[48:51]
v_fma_f32 v227, v227, s35, v26
v_mul_f32 v226, v86, v226
v_mfma_f32_16x16x32_bf16 v[48:51], a[248:251], v[208:211], v[48:51]
ds_read_b128 a[228:231], v21 offset:2368
ds_read_b64 a[196:197], v20 offset:1856
v_mfma_f32_16x16x32_bf16 v[48:51], a[252:255], v[252:255], v[48:51]
buffer_load_dwordx4 v[140:143], v9, s[12:15], s29 offen offset:2048 sc1
v_mul_f32 v227, v87, v227
v_mfma_f32_16x16x32_bf16 v[48:51], v[60:63], v[248:251], v[48:51]
v_exp_f32 v226, v226
v_mfma_f32_16x16x32_bf16 v[48:51], v[64:67], v[244:247], v[48:51]
ds_read_b128 a[232:235], v21 offset:2880
ds_read_b64 a[198:199], v20 offset:1864
v_mfma_f32_16x16x32_bf16 v[48:51], v[68:71], v[80:83], v[48:51]
buffer_load_dwordx4 v6, s[64:67], s97 offen offset:3680 lds
v_mul_f32 v234, v86, v94
v_mfma_f32_16x16x32_bf16 v[52:55], a[244:247], v[216:219], v[52:55]
ds_read_b64 a[200:201], v20 offset:1344
ds_read_b64 a[202:203], v20 offset:1352
v_mfma_f32_16x16x32_bf16 v[52:55], a[248:251], v[212:215], v[52:55]
v_exp_f32 v227, v227
v_mfma_f32_16x16x32_bf16 v[52:55], a[252:255], v[208:211], v[52:55]
v_mul_f32 v235, v87, v95
v_add_f32 v226, 1.0, v226
v_mfma_f32_16x16x32_bf16 v[52:55], v[60:63], v[252:255], v[52:55]
ds_read_b128 a[236:239], v21 offset:3392
ds_read_b64 a[204:205], v20 offset:832
v_mfma_f32_16x16x32_bf16 v[52:55], v[64:67], v[248:251], v[52:55]
buffer_load_dwordx4 v[144:147], v9, s[12:15], s29 offen offset:3072 sc1
v_add_f32 v227, 1.0, v227
v_mfma_f32_16x16x32_bf16 v[52:55], v[68:71], v[244:247], v[52:55]
ds_read_b128 a[240:243], v21 offset:3904
ds_read_b64 a[206:207], v20 offset:840
v_mfma_f32_16x16x32_bf16 v[52:55], v[72:75], v[80:83], v[52:55]
s_waitcnt vmcnt(16)
ds_read_b64_tr_b16 a[36:37], v17 offset:40960
ds_read_b64_tr_b16 a[40:41], v17 offset:40992
v_mfma_f32_16x16x32_bf16 v[56:59], a[244:247], v[220:223], v[56:59]
ds_read_b64_tr_b16 a[44:45], v17 offset:41024
ds_read_b64_tr_b16 a[48:49], v17 offset:41056
v_mfma_f32_16x16x32_bf16 v[56:59], a[248:251], v[216:219], v[56:59]
ds_read_b64 a[208:209], v20 offset:320
ds_read_b64 a[210:211], v20 offset:328
v_mfma_f32_16x16x32_bf16 v[56:59], a[252:255], v[212:215], v[56:59]
ds_read_b64_tr_b16 a[52:53], v18 offset:41088
ds_read_b64_tr_b16 a[56:57], v18 offset:41120
v_mfma_f32_16x16x32_bf16 v[56:59], v[60:63], v[208:211], v[56:59]
ds_read_b64_tr_b16 a[60:61], v18 offset:41152
ds_read_b64_tr_b16 a[64:65], v18 offset:41184
v_mfma_f32_16x16x32_bf16 v[56:59], v[64:67], v[252:255], v[56:59]
ds_read_b64_tr_b16 a[68:69], v19 offset:40960
v_cvt_pk_bf16_f32 v240, v232, v233
v_mfma_f32_16x16x32_bf16 v[56:59], v[68:71], v[248:251], v[56:59]
v_rcp_f32 v226, v226
v_mfma_f32_16x16x32_bf16 v[56:59], v[72:75], v[244:247], v[56:59]
s_add_u32 m0, s54, 40960
s_add_u32 s97, s96, 165888
v_mul_f32 v234, v234, v226
v_mfma_f32_16x16x32_bf16 v[56:59], v[76:79], v[80:83], v[56:59]
s_waitcnt lgkmcnt(5)
s_waitcnt lgkmcnt(0)
buffer_load_dwordx4 v2, s[12:15], s97 offen sc1 lds
v_mfma_f32_16x16x32_bf16 v[28:31], a[180:183], a[212:215], v[28:31]
v_rcp_f32 v227, v227
v_mfma_f32_16x16x32_bf16 v[32:35], a[180:183], a[216:219], v[32:35]
ds_read_b128 v[80:83], v21 offset:256
ds_read_b64 a[244:245], v20 offset:3840
v_mfma_f32_16x16x32_bf16 v[32:35], a[184:187], a[212:215], v[32:35]
buffer_load_dwordx4 v3, s[64:67], s97 offen offset:512 lds
v_mul_f32 v235, v235, v227
v_mfma_f32_16x16x32_bf16 v[36:39], a[180:183], a[220:223], v[36:39]
ds_read_b128 v[244:247], v21 offset:768
ds_read_b64 a[246:247], v20 offset:3848
v_mfma_f32_16x16x32_bf16 v[36:39], a[184:187], a[216:219], v[36:39]
v_mul_f32 v228, v88, v88
v_mul_f32 v229, v89, v89
v_mfma_f32_16x16x32_bf16 v[36:39], a[188:191], a[212:215], v[36:39]
buffer_load_dwordx4 v4, s[64:67], s97 offen offset:1568 lds
v_fma_f32 v228, v228, s35, v26
v_mfma_f32_16x16x32_bf16 v[40:43], a[180:183], a[224:227], v[40:43]
ds_read_b64 a[248:249], v20 offset:3328
ds_read_b64 a[250:251], v20 offset:3336
v_mfma_f32_16x16x32_bf16 v[40:43], a[184:187], a[220:223], v[40:43]
v_fma_f32 v229, v229, s35, v26
v_mul_f32 v228, v88, v228
v_mfma_f32_16x16x32_bf16 v[40:43], a[188:191], a[216:219], v[40:43]
ds_read_b128 v[248:251], v21 offset:1280
ds_read_b64 a[252:253], v20 offset:2816
v_mfma_f32_16x16x32_bf16 v[40:43], a[192:195], a[212:215], v[40:43]
buffer_load_dwordx4 v5, s[64:67], s97 offen offset:2624 lds
v_mul_f32 v229, v89, v229
v_mfma_f32_16x16x32_bf16 v[44:47], a[180:183], a[228:231], v[44:47]
v_exp_f32 v228, v228
v_mfma_f32_16x16x32_bf16 v[44:47], a[184:187], a[224:227], v[44:47]
ds_read_b128 v[252:255], v21 offset:1792
ds_read_b64 a[254:255], v20 offset:2824
v_mfma_f32_16x16x32_bf16 v[44:47], a[188:191], a[220:223], v[44:47]
buffer_load_dwordx4 v[148:151], v10, s[12:15], s29 offen offset:0 sc1
v_mul_f32 v236, v88, v96
v_mfma_f32_16x16x32_bf16 v[44:47], a[192:195], a[216:219], v[44:47]
ds_read_b64 v[60:61], v20 offset:2304
ds_read_b64 v[62:63], v20 offset:2312
v_mfma_f32_16x16x32_bf16 v[44:47], a[196:199], a[212:215], v[44:47]
v_exp_f32 v229, v229
v_mfma_f32_16x16x32_bf16 v[48:51], a[180:183], a[232:235], v[48:51]
v_mul_f32 v237, v89, v97
v_add_f32 v228, 1.0, v228
v_mfma_f32_16x16x32_bf16 v[48:51], a[184:187], a[228:231], v[48:51]
ds_read_b128 v[208:211], v21 offset:2304
ds_read_b64 v[64:65], v20 offset:1792
v_mfma_f32_16x16x32_bf16 v[48:51], a[188:191], a[224:227], v[48:51]
buffer_load_dwordx4 v6, s[64:67], s97 offen offset:3680 lds
v_add_f32 v229, 1.0, v229
v_mfma_f32_16x16x32_bf16 v[48:51], a[192:195], a[220:223], v[48:51]
v_rcp_f32 v228, v228
v_mfma_f32_16x16x32_bf16 v[48:51], a[196:199], a[216:219], v[48:51]
ds_read_b128 v[212:215], v21 offset:2816
ds_read_b64 v[66:67], v20 offset:1800
v_mfma_f32_16x16x32_bf16 v[48:51], a[200:203], a[212:215], v[48:51]
buffer_load_dwordx4 v[152:155], v10, s[12:15], s29 offen offset:1024 sc1
v_cvt_pk_bf16_f32 v241, v234, v235
v_mfma_f32_16x16x32_bf16 v[52:55], a[180:183], a[236:239], v[52:55]
ds_read_b64 v[68:69], v20 offset:1280
ds_read_b64 v[70:71], v20 offset:1288
v_mfma_f32_16x16x32_bf16 v[52:55], a[184:187], a[232:235], v[52:55]
s_waitcnt vmcnt(15)
ds_read_b64_tr_b16 a[38:39], v17 offset:0
ds_read_b64_tr_b16 a[42:43], v17 offset:32
v_mfma_f32_16x16x32_bf16 v[52:55], a[188:191], a[228:231], v[52:55]
ds_read_b64_tr_b16 a[46:47], v17 offset:64
ds_read_b64_tr_b16 a[50:51], v17 offset:96
v_mfma_f32_16x16x32_bf16 v[52:55], a[192:195], a[224:227], v[52:55]
ds_read_b128 v[216:219], v21 offset:3328
ds_read_b64 v[72:73], v20 offset:768
v_mfma_f32_16x16x32_bf16 v[52:55], a[196:199], a[220:223], v[52:55]
ds_read_b64_tr_b16 a[54:55], v18 offset:128
ds_read_b64_tr_b16 a[58:59], v18 offset:160
v_mfma_f32_16x16x32_bf16 v[52:55], a[200:203], a[216:219], v[52:55]
ds_read_b128 v[220:223], v21 offset:3840
ds_read_b64 v[74:75], v20 offset:776
v_mfma_f32_16x16x32_bf16 v[52:55], a[204:207], a[212:215], v[52:55]
ds_read_b64_tr_b16 a[62:63], v18 offset:192
ds_read_b64_tr_b16 a[66:67], v18 offset:224
v_mfma_f32_16x16x32_bf16 v[56:59], a[180:183], a[240:243], v[56:59]
ds_read_b64_tr_b16 a[70:71], v19 offset:0
v_mul_f32 v236, v236, v228
v_mfma_f32_16x16x32_bf16 v[56:59], a[184:187], a[236:239], v[56:59]
ds_read_b64 v[76:77], v20 offset:256
ds_read_b64 v[78:79], v20 offset:264
v_mfma_f32_16x16x32_bf16 v[56:59], a[188:191], a[232:235], v[56:59]
s_add_u32 m0, s54, 0
s_add_u32 s97, s96, 184320
v_mul_f32 v230, v90, v90
v_mfma_f32_16x16x32_bf16 v[56:59], a[192:195], a[228:231], v[56:59]
s_waitcnt lgkmcnt(2)
buffer_load_dwordx4 v2, s[12:15], s97 offen sc1 lds
v_mul_f32 v231, v91, v91
v_mfma_f32_16x16x32_bf16 v[56:59], a[196:199], a[224:227], v[56:59]
v_rcp_f32 v229, v229
v_mfma_f32_16x16x32_bf16 v[56:59], a[200:203], a[220:223], v[56:59]
buffer_load_dwordx4 v3, s[64:67], s97 offen offset:512 lds
v_mul_f32 v237, v237, v229
v_mfma_f32_16x16x32_bf16 v[56:59], a[204:207], a[216:219], v[56:59]
v_fma_f32 v230, v230, s35, v26
v_fma_f32 v231, v231, s35, v26
v_mfma_f32_16x16x32_bf16 v[56:59], a[208:211], a[212:215], v[56:59]
s_waitcnt lgkmcnt(0)
v_mul_f32 v230, v90, v230
v_mul_f32 v231, v91, v231
v_mfma_f32_16x16x32_bf16 v[28:31], a[244:247], v[80:83], v[28:31]
v_exp_f32 v230, v230
v_mfma_f32_16x16x32_bf16 v[32:35], a[244:247], v[244:247], v[32:35]
ds_read_b128 a[212:215], v21 offset:192
ds_read_b64 a[180:181], v20 offset:3776
v_mfma_f32_16x16x32_bf16 v[32:35], a[248:251], v[80:83], v[32:35]
buffer_load_dwordx4 v4, s[64:67], s97 offen offset:1568 lds
v_mul_f32 v238, v90, v98
v_mfma_f32_16x16x32_bf16 v[36:39], a[244:247], v[248:251], v[36:39]
ds_read_b128 a[216:219], v21 offset:704
ds_read_b64 a[182:183], v20 offset:3784
v_mfma_f32_16x16x32_bf16 v[36:39], a[248:251], v[244:247], v[36:39]
v_exp_f32 v231, v231
v_mfma_f32_16x16x32_bf16 v[36:39], a[252:255], v[80:83], v[36:39]
buffer_load_dwordx4 v5, s[64:67], s97 offen offset:2624 lds
v_mul_f32 v239, v91, v99
v_mfma_f32_16x16x32_bf16 v[40:43], a[244:247], v[252:255], v[40:43]
ds_read_b64 a[184:185], v20 offset:3264
ds_read_b64 a[186:187], v20 offset:3272
v_mfma_f32_16x16x32_bf16 v[40:43], a[248:251], v[248:251], v[40:43]
v_add_f32 v230, 1.0, v230
v_add_f32 v231, 1.0, v231
v_mfma_f32_16x16x32_bf16 v[40:43], a[252:255], v[244:247], v[40:43]
ds_read_b128 a[220:223], v21 offset:1216
ds_read_b64 a[188:189], v20 offset:2752
v_mfma_f32_16x16x32_bf16 v[40:43], v[60:63], v[80:83], v[40:43]
buffer_load_dwordx4 v[156:159], v10, s[12:15], s29 offen offset:2048 sc1
v_cvt_pk_bf16_f32 v242, v236, v237
v_mfma_f32_16x16x32_bf16 v[44:47], a[244:247], v[208:211], v[44:47]
v_rcp_f32 v230, v230
v_mfma_f32_16x16x32_bf16 v[44:47], a[248:251], v[252:255], v[44:47]
ds_read_b128 a[224:227], v21 offset:1728
ds_read_b64 a[190:191], v20 offset:2760
v_mfma_f32_16x16x32_bf16 v[44:47], a[252:255], v[248:251], v[44:47]
buffer_load_dwordx4 v6, s[64:67], s97 offen offset:3680 lds
v_mul_f32 v238, v238, v230
v_mfma_f32_16x16x32_bf16 v[44:47], v[60:63], v[244:247], v[44:47]
ds_read_b64 a[192:193], v20 offset:2240
ds_read_b64 a[194:195], v20 offset:2248
v_mfma_f32_16x16x32_bf16 v[44:47], v[64:67], v[80:83], v[44:47]
v_rcp_f32 v231, v231
v_mfma_f32_16x16x32_bf16 v[48:51], a[244:247], v[212:215], v[48:51]
v_mul_f32 v239, v239, v231
v_cvt_pk_bf16_f32 v243, v238, v239
v_mfma_f32_16x16x32_bf16 v[48:51], a[248:251], v[208:211], v[48:51]
buffer_store_dwordx4 v[240:243], v25, s[12:15], s32 offen sc1
ds_read_b128 a[228:231], v21 offset:2240
ds_read_b64 a[196:197], v20 offset:1728
v_mfma_f32_16x16x32_bf16 v[48:51], a[252:255], v[252:255], v[48:51]
buffer_load_dwordx4 v[160:163], v10, s[12:15], s29 offen offset:3072 sc1
v_mov_b32 v25, s92
v_mfma_f32_16x16x32_bf16 v[48:51], v[60:63], v[248:251], v[48:51]
s_waitcnt vmcnt(16)
ds_read_b64_tr_b16 a[72:73], v17 offset:20480
ds_read_b64_tr_b16 a[76:77], v17 offset:20512
v_mfma_f32_16x16x32_bf16 v[48:51], v[64:67], v[244:247], v[48:51]
ds_read_b128 a[232:235], v21 offset:2752
ds_read_b64 a[198:199], v20 offset:1736
v_mfma_f32_16x16x32_bf16 v[48:51], v[68:71], v[80:83], v[48:51]
ds_read_b64_tr_b16 a[80:81], v17 offset:20544
ds_read_b64_tr_b16 a[84:85], v17 offset:20576
v_mfma_f32_16x16x32_bf16 v[52:55], a[244:247], v[216:219], v[52:55]
ds_read_b64 a[200:201], v20 offset:1216
ds_read_b64 a[202:203], v20 offset:1224
v_mfma_f32_16x16x32_bf16 v[52:55], a[248:251], v[212:215], v[52:55]
ds_read_b64_tr_b16 a[88:89], v18 offset:20608
ds_read_b64_tr_b16 a[92:93], v18 offset:20640
v_mfma_f32_16x16x32_bf16 v[52:55], a[252:255], v[208:211], v[52:55]
ds_read_b64_tr_b16 a[96:97], v18 offset:20672
ds_read_b64_tr_b16 a[100:101], v18 offset:20704
v_mfma_f32_16x16x32_bf16 v[52:55], v[60:63], v[252:255], v[52:55]
ds_read_b128 a[236:239], v21 offset:3264
ds_read_b64 a[204:205], v20 offset:704
v_mfma_f32_16x16x32_bf16 v[52:55], v[64:67], v[248:251], v[52:55]
ds_read_b64_tr_b16 a[104:105], v19 offset:20480
v_mfma_f32_16x16x32_bf16 v[52:55], v[68:71], v[244:247], v[52:55]
s_add_u32 m0, s54, 20480
ds_read_b128 a[240:243], v21 offset:3776
ds_read_b64 a[206:207], v20 offset:712
v_mfma_f32_16x16x32_bf16 v[52:55], v[72:75], v[80:83], v[52:55]
s_add_u32 s97, s96, 202752
s_waitcnt lgkmcnt(2)
buffer_load_dwordx4 v2, s[12:15], s97 offen sc1 lds
v_mfma_f32_16x16x32_bf16 v[56:59], a[244:247], v[220:223], v[56:59]
v_mfma_f32_16x16x32_bf16 v[56:59], a[248:251], v[216:219], v[56:59]
ds_read_b64 a[208:209], v20 offset:192
ds_read_b64 a[210:211], v20 offset:200
v_mfma_f32_16x16x32_bf16 v[56:59], a[252:255], v[212:215], v[56:59]
buffer_load_dwordx4 v3, s[64:67], s97 offen offset:512 lds
v_mfma_f32_16x16x32_bf16 v[56:59], v[60:63], v[208:211], v[56:59]
v_mfma_f32_16x16x32_bf16 v[56:59], v[64:67], v[252:255], v[56:59]
v_mfma_f32_16x16x32_bf16 v[56:59], v[68:71], v[248:251], v[56:59]
buffer_load_dwordx4 v4, s[64:67], s97 offen offset:1568 lds
v_mfma_f32_16x16x32_bf16 v[56:59], v[72:75], v[244:247], v[56:59]
v_mfma_f32_16x16x32_bf16 v[56:59], v[76:79], v[80:83], v[56:59]
s_waitcnt lgkmcnt(0)
v_mfma_f32_16x16x32_bf16 v[28:31], a[180:183], a[212:215], v[28:31]
v_mfma_f32_16x16x32_bf16 v[32:35], a[180:183], a[216:219], v[32:35]
ds_read_b128 v[80:83], v21 offset:128
ds_read_b64 a[244:245], v20 offset:3712
v_mfma_f32_16x16x32_bf16 v[32:35], a[184:187], a[212:215], v[32:35]
buffer_load_dwordx4 v5, s[64:67], s97 offen offset:2624 lds
v_mfma_f32_16x16x32_bf16 v[36:39], a[180:183], a[220:223], v[36:39]
ds_read_b128 v[244:247], v21 offset:640
ds_read_b64 a[246:247], v20 offset:3720
v_mfma_f32_16x16x32_bf16 v[36:39], a[184:187], a[216:219], v[36:39]
buffer_load_dwordx4 v[164:167], v11, s[12:15], s29 offen offset:0 sc1
s_add_u32 s29, s29, 147456
v_mfma_f32_16x16x32_bf16 v[36:39], a[188:191], a[212:215], v[36:39]
v_mfma_f32_16x16x32_bf16 v[40:43], a[180:183], a[224:227], v[40:43]
ds_read_b64 a[248:249], v20 offset:3200
ds_read_b64 a[250:251], v20 offset:3208
v_mfma_f32_16x16x32_bf16 v[40:43], a[184:187], a[220:223], v[40:43]
v_mfma_f32_16x16x32_bf16 v[40:43], a[188:191], a[216:219], v[40:43]
ds_read_b128 v[248:251], v21 offset:1152
ds_read_b64 a[252:253], v20 offset:2688
v_mfma_f32_16x16x32_bf16 v[40:43], a[192:195], a[212:215], v[40:43]
buffer_load_dwordx4 v6, s[64:67], s97 offen offset:3680 lds
v_mfma_f32_16x16x32_bf16 v[44:47], a[180:183], a[228:231], v[44:47]
v_mfma_f32_16x16x32_bf16 v[44:47], a[184:187], a[224:227], v[44:47]
ds_read_b128 v[252:255], v21 offset:1664
ds_read_b64 a[254:255], v20 offset:2696
v_mfma_f32_16x16x32_bf16 v[44:47], a[188:191], a[220:223], v[44:47]
buffer_load_dwordx4 v[208:211], v9, s[12:15], s29 offen offset:0 sc1
v_mfma_f32_16x16x32_bf16 v[44:47], a[192:195], a[216:219], v[44:47]
ds_read_b64 v[60:61], v20 offset:2176
ds_read_b64 v[62:63], v20 offset:2184
v_mfma_f32_16x16x32_bf16 v[44:47], a[196:199], a[212:215], v[44:47]
s_waitcnt vmcnt(16)
ds_read_b64_tr_b16 a[74:75], v17 offset:40960
ds_read_b64_tr_b16 a[78:79], v17 offset:40992
v_mfma_f32_16x16x32_bf16 v[48:51], a[180:183], a[232:235], v[48:51]
ds_read_b64_tr_b16 a[82:83], v17 offset:41024
ds_read_b64_tr_b16 a[86:87], v17 offset:41056
v_mfma_f32_16x16x32_bf16 v[48:51], a[184:187], a[228:231], v[48:51]
ds_read_b128 v[84:87], v21 offset:2176
ds_read_b64 v[64:65], v20 offset:1664
v_mfma_f32_16x16x32_bf16 v[48:51], a[188:191], a[224:227], v[48:51]
ds_read_b64_tr_b16 a[90:91], v18 offset:41088
ds_read_b64_tr_b16 a[94:95], v18 offset:41120
v_mfma_f32_16x16x32_bf16 v[48:51], a[192:195], a[220:223], v[48:51]
ds_read_b64_tr_b16 a[98:99], v18 offset:41152
ds_read_b64_tr_b16 a[102:103], v18 offset:41184
v_mfma_f32_16x16x32_bf16 v[48:51], a[196:199], a[216:219], v[48:51]
ds_read_b128 v[88:91], v21 offset:2688
ds_read_b64 v[66:67], v20 offset:1672
v_mfma_f32_16x16x32_bf16 v[48:51], a[200:203], a[212:215], v[48:51]
ds_read_b64_tr_b16 a[106:107], v19 offset:40960
v_mfma_f32_16x16x32_bf16 v[52:55], a[180:183], a[236:239], v[52:55]
ds_read_b64 v[68:69], v20 offset:1152
ds_read_b64 v[70:71], v20 offset:1160
v_mfma_f32_16x16x32_bf16 v[52:55], a[184:187], a[232:235], v[52:55]
s_add_u32 m0, s54, 40960
s_add_u32 s97, s96, 221184
v_mfma_f32_16x16x32_bf16 v[52:55], a[188:191], a[228:231], v[52:55]
s_waitcnt lgkmcnt(2)
buffer_load_dwordx4 v2, s[12:15], s97 offen sc1 lds
v_mfma_f32_16x16x32_bf16 v[52:55], a[192:195], a[224:227], v[52:55]
ds_read_b128 v[92:95], v21 offset:3200
ds_read_b64 v[72:73], v20 offset:640
v_mfma_f32_16x16x32_bf16 v[52:55], a[196:199], a[220:223], v[52:55]
buffer_load_dwordx4 v3, s[64:67], s97 offen offset:512 lds
v_mfma_f32_16x16x32_bf16 v[52:55], a[200:203], a[216:219], v[52:55]
ds_read_b128 v[96:99], v21 offset:3712
ds_read_b64 v[74:75], v20 offset:648
v_mfma_f32_16x16x32_bf16 v[52:55], a[204:207], a[212:215], v[52:55]
v_mfma_f32_16x16x32_bf16 v[56:59], a[180:183], a[240:243], v[56:59]
v_mfma_f32_16x16x32_bf16 v[56:59], a[184:187], a[236:239], v[56:59]
ds_read_b64 v[76:77], v20 offset:128
ds_read_b64 v[78:79], v20 offset:136
v_mfma_f32_16x16x32_bf16 v[56:59], a[188:191], a[232:235], v[56:59]
buffer_load_dwordx4 v4, s[64:67], s97 offen offset:1568 lds
v_mfma_f32_16x16x32_bf16 v[56:59], a[192:195], a[228:231], v[56:59]
v_mfma_f32_16x16x32_bf16 v[56:59], a[196:199], a[224:227], v[56:59]
v_mfma_f32_16x16x32_bf16 v[56:59], a[200:203], a[220:223], v[56:59]
buffer_load_dwordx4 v5, s[64:67], s97 offen offset:2624 lds
v_mfma_f32_16x16x32_bf16 v[56:59], a[204:207], a[216:219], v[56:59]
v_mfma_f32_16x16x32_bf16 v[56:59], a[208:211], a[212:215], v[56:59]
s_waitcnt lgkmcnt(0)
v_mfma_f32_16x16x32_bf16 v[28:31], a[244:247], v[80:83], v[28:31]
buffer_load_dwordx4 v[212:215], v9, s[12:15], s29 offen offset:1024 sc1
v_mfma_f32_16x16x32_bf16 v[32:35], a[244:247], v[244:247], v[32:35]
ds_read_b128 a[212:215], v21 offset:64
ds_read_b64 a[180:181], v20 offset:3648
v_mfma_f32_16x16x32_bf16 v[32:35], a[248:251], v[80:83], v[32:35]
v_mfma_f32_16x16x32_bf16 v[36:39], a[244:247], v[248:251], v[36:39]
ds_read_b128 a[216:219], v21 offset:576
ds_read_b64 a[182:183], v20 offset:3656
v_mfma_f32_16x16x32_bf16 v[36:39], a[248:251], v[244:247], v[36:39]
buffer_load_dwordx4 v6, s[64:67], s97 offen offset:3680 lds
v_mfma_f32_16x16x32_bf16 v[36:39], a[252:255], v[80:83], v[36:39]
v_mfma_f32_16x16x32_bf16 v[40:43], a[244:247], v[252:255], v[40:43]
ds_read_b64 a[184:185], v20 offset:3136
ds_read_b64 a[186:187], v20 offset:3144
v_mfma_f32_16x16x32_bf16 v[40:43], a[248:251], v[248:251], v[40:43]
v_mfma_f32_16x16x32_bf16 v[40:43], a[252:255], v[244:247], v[40:43]
ds_read_b128 a[220:223], v21 offset:1088
ds_read_b64 a[188:189], v20 offset:2624
v_mfma_f32_16x16x32_bf16 v[40:43], v[60:63], v[80:83], v[40:43]
buffer_load_dwordx4 v[216:219], v9, s[12:15], s29 offen offset:2048 sc1
v_mfma_f32_16x16x32_bf16 v[44:47], a[244:247], v[84:87], v[44:47]
s_waitcnt vmcnt(16)
ds_read_b64_tr_b16 a[108:109], v17 offset:0
ds_read_b64_tr_b16 a[112:113], v17 offset:32
v_mfma_f32_16x16x32_bf16 v[44:47], a[248:251], v[252:255], v[44:47]
ds_read_b128 a[224:227], v21 offset:1600
ds_read_b64 a[190:191], v20 offset:2632
v_mfma_f32_16x16x32_bf16 v[44:47], a[252:255], v[248:251], v[44:47]
ds_read_b64_tr_b16 a[116:117], v17 offset:64
ds_read_b64_tr_b16 a[120:121], v17 offset:96
v_mfma_f32_16x16x32_bf16 v[44:47], v[60:63], v[244:247], v[44:47]
ds_read_b64 a[192:193], v20 offset:2112
ds_read_b64 a[194:195], v20 offset:2120
v_mfma_f32_16x16x32_bf16 v[44:47], v[64:67], v[80:83], v[44:47]
ds_read_b64_tr_b16 a[124:125], v18 offset:128
ds_read_b64_tr_b16 a[128:129], v18 offset:160
v_mfma_f32_16x16x32_bf16 v[48:51], a[244:247], v[88:91], v[48:51]
ds_read_b64_tr_b16 a[132:133], v18 offset:192
ds_read_b64_tr_b16 a[136:137], v18 offset:224
v_mfma_f32_16x16x32_bf16 v[48:51], a[248:251], v[84:87], v[48:51]
ds_read_b128 a[228:231], v21 offset:2112
ds_read_b64 a[196:197], v20 offset:1600
v_mfma_f32_16x16x32_bf16 v[48:51], a[252:255], v[252:255], v[48:51]
ds_read_b64_tr_b16 a[140:141], v19 offset:0
v_mfma_f32_16x16x32_bf16 v[48:51], v[60:63], v[248:251], v[48:51]
s_add_u32 m0, s54, 0
s_add_u32 s97, s96, 239616
v_mfma_f32_16x16x32_bf16 v[48:51], v[64:67], v[244:247], v[48:51]
ds_read_b128 a[232:235], v21 offset:2624
ds_read_b64 a[198:199], v20 offset:1608
v_mfma_f32_16x16x32_bf16 v[48:51], v[68:71], v[80:83], v[48:51]
s_waitcnt lgkmcnt(2)
buffer_load_dwordx4 v2, s[12:15], s97 offen sc1 lds
v_mfma_f32_16x16x32_bf16 v[52:55], a[244:247], v[92:95], v[52:55]
ds_read_b64 a[200:201], v20 offset:1088
ds_read_b64 a[202:203], v20 offset:1096
v_mfma_f32_16x16x32_bf16 v[52:55], a[248:251], v[88:91], v[52:55]
buffer_load_dwordx4 v3, s[64:67], s97 offen offset:512 lds
v_add_u32 v26, 8, v25
v_mfma_f32_16x16x32_bf16 v[52:55], a[252:255], v[84:87], v[52:55]
s_waitcnt vmcnt(17)
buffer_store_dword v26, v27, s[12:15], s93 offen sc1
v_mfma_f32_16x16x32_bf16 v[52:55], v[60:63], v[252:255], v[52:55]
ds_read_b128 a[236:239], v21 offset:3136
ds_read_b64 a[204:205], v20 offset:576
v_mfma_f32_16x16x32_bf16 v[52:55], v[64:67], v[248:251], v[52:55]
buffer_load_dwordx4 v4, s[64:67], s97 offen offset:1568 lds
v_mfma_f32_16x16x32_bf16 v[52:55], v[68:71], v[244:247], v[52:55]
ds_read_b128 a[240:243], v21 offset:3648
ds_read_b64 a[206:207], v20 offset:584
v_mfma_f32_16x16x32_bf16 v[52:55], v[72:75], v[80:83], v[52:55]
v_mfma_f32_16x16x32_bf16 v[56:59], a[244:247], v[96:99], v[56:59]
v_mfma_f32_16x16x32_bf16 v[56:59], a[248:251], v[92:95], v[56:59]
ds_read_b64 a[208:209], v20 offset:64
ds_read_b64 a[210:211], v20 offset:72
v_mfma_f32_16x16x32_bf16 v[56:59], a[252:255], v[88:91], v[56:59]
buffer_load_dwordx4 v5, s[64:67], s97 offen offset:2624 lds
v_mfma_f32_16x16x32_bf16 v[56:59], v[60:63], v[84:87], v[56:59]
v_mfma_f32_16x16x32_bf16 v[56:59], v[64:67], v[252:255], v[56:59]
buffer_load_dwordx4 v[220:223], v9, s[12:15], s29 offen offset:3072 sc1
v_mfma_f32_16x16x32_bf16 v[56:59], v[68:71], v[248:251], v[56:59]
v_mfma_f32_16x16x32_bf16 v[56:59], v[72:75], v[244:247], v[56:59]
v_mfma_f32_16x16x32_bf16 v[56:59], v[76:79], v[80:83], v[56:59]
s_waitcnt lgkmcnt(0)
v_mfma_f32_16x16x32_bf16 v[28:31], a[180:183], a[212:215], v[28:31]
buffer_load_dwordx4 v6, s[64:67], s97 offen offset:3680 lds
v_mfma_f32_16x16x32_bf16 v[32:35], a[180:183], a[216:219], v[32:35]
ds_read_b128 v[80:83], v21 offset:0
ds_read_b64 a[244:245], v20 offset:3584
v_mfma_f32_16x16x32_bf16 v[32:35], a[184:187], a[212:215], v[32:35]
v_mfma_f32_16x16x32_bf16 v[36:39], a[180:183], a[220:223], v[36:39]
ds_read_b128 v[244:247], v21 offset:512
ds_read_b64 a[246:247], v20 offset:3592
v_mfma_f32_16x16x32_bf16 v[36:39], a[184:187], a[216:219], v[36:39]
buffer_load_dwordx4 v[224:227], v10, s[12:15], s29 offen offset:0 sc1
v_mfma_f32_16x16x32_bf16 v[36:39], a[188:191], a[212:215], v[36:39]
s_waitcnt vmcnt(16)
ds_read_b64_tr_b16 a[110:111], v17 offset:20480
ds_read_b64_tr_b16 a[114:115], v17 offset:20512
v_mfma_f32_16x16x32_bf16 v[40:43], a[180:183], a[224:227], v[40:43]
ds_read_b64 a[248:249], v20 offset:3072
ds_read_b64 a[250:251], v20 offset:3080
v_mfma_f32_16x16x32_bf16 v[40:43], a[184:187], a[220:223], v[40:43]
ds_read_b64_tr_b16 a[118:119], v17 offset:20544
ds_read_b64_tr_b16 a[122:123], v17 offset:20576
v_mfma_f32_16x16x32_bf16 v[40:43], a[188:191], a[216:219], v[40:43]
ds_read_b128 v[248:251], v21 offset:1024
ds_read_b64 a[252:253], v20 offset:2560
v_mfma_f32_16x16x32_bf16 v[40:43], a[192:195], a[212:215], v[40:43]
ds_read_b64_tr_b16 a[126:127], v18 offset:20608
ds_read_b64_tr_b16 a[130:131], v18 offset:20640
v_mfma_f32_16x16x32_bf16 v[44:47], a[180:183], a[228:231], v[44:47]
ds_read_b64_tr_b16 a[134:135], v18 offset:20672
ds_read_b64_tr_b16 a[138:139], v18 offset:20704
v_mfma_f32_16x16x32_bf16 v[44:47], a[184:187], a[224:227], v[44:47]
ds_read_b128 v[252:255], v21 offset:1536
ds_read_b64 a[254:255], v20 offset:2568
v_mfma_f32_16x16x32_bf16 v[44:47], a[188:191], a[220:223], v[44:47]
ds_read_b64_tr_b16 a[142:143], v19 offset:20480
v_mfma_f32_16x16x32_bf16 v[44:47], a[192:195], a[216:219], v[44:47]
ds_read_b64 v[60:61], v20 offset:2048
ds_read_b64 v[62:63], v20 offset:2056
v_mfma_f32_16x16x32_bf16 v[44:47], a[196:199], a[212:215], v[44:47]
s_add_u32 m0, s54, 20480
s_add_u32 s97, s96, 258048
v_mfma_f32_16x16x32_bf16 v[48:51], a[180:183], a[232:235], v[48:51]
s_waitcnt lgkmcnt(2)
buffer_load_dwordx4 v2, s[12:15], s97 offen sc1 lds
v_mfma_f32_16x16x32_bf16 v[48:51], a[184:187], a[228:231], v[48:51]
ds_read_b128 v[84:87], v21 offset:2048
ds_read_b64 v[64:65], v20 offset:1536
v_mfma_f32_16x16x32_bf16 v[48:51], a[188:191], a[224:227], v[48:51]
buffer_load_dwordx4 v3, s[64:67], s97 offen offset:512 lds
v_mfma_f32_16x16x32_bf16 v[48:51], a[192:195], a[220:223], v[48:51]
v_mfma_f32_16x16x32_bf16 v[48:51], a[196:199], a[216:219], v[48:51]
ds_read_b128 v[88:91], v21 offset:2560
ds_read_b64 v[66:67], v20 offset:1544
v_mfma_f32_16x16x32_bf16 v[48:51], a[200:203], a[212:215], v[48:51]
v_mfma_f32_16x16x32_bf16 v[52:55], a[180:183], a[236:239], v[52:55]
ds_read_b64 v[68:69], v20 offset:1024
ds_read_b64 v[70:71], v20 offset:1032
v_mfma_f32_16x16x32_bf16 v[52:55], a[184:187], a[232:235], v[52:55]
buffer_load_dwordx4 v4, s[64:67], s97 offen offset:1568 lds
v_mfma_f32_16x16x32_bf16 v[52:55], a[188:191], a[228:231], v[52:55]
v_mfma_f32_16x16x32_bf16 v[52:55], a[192:195], a[224:227], v[52:55]
ds_read_b128 v[92:95], v21 offset:3072
ds_read_b64 v[72:73], v20 offset:512
v_mfma_f32_16x16x32_bf16 v[52:55], a[196:199], a[220:223], v[52:55]
buffer_load_dwordx4 v5, s[64:67], s97 offen offset:2624 lds
v_mfma_f32_16x16x32_bf16 v[52:55], a[200:203], a[216:219], v[52:55]
ds_read_b128 v[96:99], v21 offset:3584
ds_read_b64 v[74:75], v20 offset:520
v_mfma_f32_16x16x32_bf16 v[52:55], a[204:207], a[212:215], v[52:55]
v_mfma_f32_16x16x32_bf16 v[56:59], a[180:183], a[240:243], v[56:59]
buffer_load_dwordx4 v[228:231], v10, s[12:15], s29 offen offset:1024 sc1
v_mfma_f32_16x16x32_bf16 v[56:59], a[184:187], a[236:239], v[56:59]
ds_read_b64 v[76:77], v20 offset:0
ds_read_b64 v[78:79], v20 offset:8
v_mfma_f32_16x16x32_bf16 v[56:59], a[188:191], a[232:235], v[56:59]
v_mfma_f32_16x16x32_bf16 v[56:59], a[192:195], a[228:231], v[56:59]
v_mfma_f32_16x16x32_bf16 v[56:59], a[196:199], a[224:227], v[56:59]
buffer_load_dwordx4 v6, s[64:67], s97 offen offset:3680 lds
v_mfma_f32_16x16x32_bf16 v[56:59], a[200:203], a[220:223], v[56:59]
v_mfma_f32_16x16x32_bf16 v[56:59], a[204:207], a[216:219], v[56:59]
v_mfma_f32_16x16x32_bf16 v[56:59], a[208:211], a[212:215], v[56:59]
s_waitcnt lgkmcnt(0)
v_mfma_f32_16x16x32_bf16 v[28:31], a[244:247], v[80:83], v[28:31]
buffer_load_dwordx4 v[232:235], v10, s[12:15], s29 offen offset:2048 sc1
v_mfma_f32_16x16x32_bf16 v[32:35], a[244:247], v[244:247], v[32:35]
s_waitcnt vmcnt(16)
ds_read_b64_tr_b16 a[144:145], v17 offset:40960
ds_read_b64_tr_b16 a[148:149], v17 offset:40992
v_mfma_f32_16x16x32_bf16 v[32:35], a[248:251], v[80:83], v[32:35]
ds_read_b64_tr_b16 a[152:153], v17 offset:41024
ds_read_b64_tr_b16 a[156:157], v17 offset:41056
v_mfma_f32_16x16x32_bf16 v[36:39], a[244:247], v[248:251], v[36:39]
v_cvt_pk_bf16_f32 v28, v28, v29
v_cvt_pk_bf16_f32 v29, v30, v31
v_mfma_f32_16x16x32_bf16 v[36:39], a[248:251], v[244:247], v[36:39]
ds_write_b64 v12, v[28:29] offset:0
v_mfma_f32_16x16x32_bf16 v[36:39], a[252:255], v[80:83], v[36:39]
v_cvt_pk_bf16_f32 v32, v32, v33
v_cvt_pk_bf16_f32 v33, v34, v35
v_mfma_f32_16x16x32_bf16 v[40:43], a[244:247], v[252:255], v[40:43]
ds_write_b64 v12, v[32:33] offset:512
v_mfma_f32_16x16x32_bf16 v[40:43], a[248:251], v[248:251], v[40:43]
ds_read_b64_tr_b16 a[160:161], v18 offset:41088
ds_read_b64_tr_b16 a[164:165], v18 offset:41120
v_mfma_f32_16x16x32_bf16 v[40:43], a[252:255], v[244:247], v[40:43]
v_cvt_pk_bf16_f32 v36, v36, v37
v_cvt_pk_bf16_f32 v37, v38, v39
v_mfma_f32_16x16x32_bf16 v[40:43], v[60:63], v[80:83], v[40:43]
ds_write_b64 v12, v[36:37] offset:1024
v_mfma_f32_16x16x32_bf16 v[44:47], a[244:247], v[84:87], v[44:47]
ds_read_b64_tr_b16 a[168:169], v18 offset:41152
ds_read_b64_tr_b16 a[172:173], v18 offset:41184
v_mfma_f32_16x16x32_bf16 v[44:47], a[248:251], v[252:255], v[44:47]
ds_read_b64_tr_b16 a[176:177], v19 offset:40960
buffer_load_dword v8, v7, s[12:15], 0 offen sc1
v_mfma_f32_16x16x32_bf16 v[44:47], a[252:255], v[248:251], v[44:47]
s_add_u32 m0, s54, 40960
v_cvt_pk_bf16_f32 v40, v40, v41
v_cvt_pk_bf16_f32 v41, v42, v43
v_mfma_f32_16x16x32_bf16 v[44:47], v[60:63], v[244:247], v[44:47]
s_add_u32 s97, s96, 276480
ds_write_b64 v12, v[40:41] offset:1536
v_mfma_f32_16x16x32_bf16 v[44:47], v[64:67], v[80:83], v[44:47]
s_waitcnt lgkmcnt(1)
buffer_load_dwordx4 v2, s[12:15], s97 offen sc1 lds
buffer_load_dwordx4 v3, s[64:67], s97 offen offset:512 lds
v_mfma_f32_16x16x32_bf16 v[48:51], a[244:247], v[88:91], v[48:51]
v_mfma_f32_16x16x32_bf16 v[48:51], a[248:251], v[84:87], v[48:51]
v_mfma_f32_16x16x32_bf16 v[48:51], a[252:255], v[252:255], v[48:51]
v_cvt_pk_bf16_f32 v44, v44, v45
v_cvt_pk_bf16_f32 v45, v46, v47
v_mfma_f32_16x16x32_bf16 v[48:51], v[60:63], v[248:251], v[48:51]
ds_write_b64 v12, v[44:45] offset:2048
v_mfma_f32_16x16x32_bf16 v[48:51], v[64:67], v[244:247], v[48:51]
buffer_load_dwordx4 v4, s[64:67], s97 offen offset:1568 lds
v_mfma_f32_16x16x32_bf16 v[48:51], v[68:71], v[80:83], v[48:51]
v_mfma_f32_16x16x32_bf16 v[52:55], a[244:247], v[92:95], v[52:55]
buffer_load_dwordx4 v5, s[64:67], s97 offen offset:2624 lds
v_mfma_f32_16x16x32_bf16 v[52:55], a[248:251], v[88:91], v[52:55]
v_mfma_f32_16x16x32_bf16 v[52:55], a[252:255], v[84:87], v[52:55]
v_cvt_pk_bf16_f32 v48, v48, v49
v_cvt_pk_bf16_f32 v49, v50, v51
v_mfma_f32_16x16x32_bf16 v[52:55], v[60:63], v[252:255], v[52:55]
ds_write_b64 v12, v[48:49] offset:2560
v_mfma_f32_16x16x32_bf16 v[52:55], v[64:67], v[248:251], v[52:55]
buffer_load_dwordx4 v[236:239], v10, s[12:15], s29 offen offset:3072 sc1
v_mfma_f32_16x16x32_bf16 v[52:55], v[68:71], v[244:247], v[52:55]
v_mfma_f32_16x16x32_bf16 v[52:55], v[72:75], v[80:83], v[52:55]
v_mfma_f32_16x16x32_bf16 v[56:59], a[244:247], v[96:99], v[56:59]
buffer_load_dwordx4 v6, s[64:67], s97 offen offset:3680 lds
v_mfma_f32_16x16x32_bf16 v[56:59], a[248:251], v[92:95], v[56:59]
v_mfma_f32_16x16x32_bf16 v[56:59], a[252:255], v[88:91], v[56:59]
v_cvt_pk_bf16_f32 v52, v52, v53
v_cvt_pk_bf16_f32 v53, v54, v55
v_mfma_f32_16x16x32_bf16 v[56:59], v[60:63], v[84:87], v[56:59]
ds_write_b64 v12, v[52:53] offset:3072
v_mfma_f32_16x16x32_bf16 v[56:59], v[64:67], v[252:255], v[56:59]
buffer_load_dwordx4 v[240:243], v11, s[12:15], s29 offen offset:0 sc1
v_mfma_f32_16x16x32_bf16 v[56:59], v[68:71], v[248:251], v[56:59]
v_mfma_f32_16x16x32_bf16 v[56:59], v[72:75], v[244:247], v[56:59]
v_mfma_f32_16x16x32_bf16 v[56:59], v[76:79], v[80:83], v[56:59]
s_nop 7
v_cvt_pk_bf16_f32 v56, v56, v57
v_cvt_pk_bf16_f32 v57, v58, v59
ds_write_b64 v12, v[56:57] offset:3584
s_waitcnt lgkmcnt(0)
s_barrier
ds_read_b64_tr_b16 v[64:65], v13 offset:0
ds_read_b64_tr_b16 v[66:67], v13 offset:128
ds_read_b64_tr_b16 v[68:69], v13 offset:256
ds_read_b64_tr_b16 v[70:71], v13 offset:384
ds_read_b64_tr_b16 v[72:73], v13 offset:512
ds_read_b64_tr_b16 v[74:75], v13 offset:640
ds_read_b64_tr_b16 v[76:77], v13 offset:768
ds_read_b64_tr_b16 v[78:79], v13 offset:896
s_waitcnt lgkmcnt(7)
buffer_store_dwordx2 v[64:65], v23, s[12:15], s39 offen offset:0 sc1
s_waitcnt lgkmcnt(6)
buffer_store_dwordx2 v[66:67], v23, s[12:15], s39 offen offset:512 sc1
s_waitcnt lgkmcnt(5)
buffer_store_dwordx2 v[68:69], v23, s[12:15], s39 offen offset:1024 sc1
s_waitcnt lgkmcnt(4)
buffer_store_dwordx2 v[70:71], v23, s[12:15], s39 offen offset:1536 sc1
s_waitcnt lgkmcnt(3)
buffer_store_dwordx2 v[72:73], v23, s[12:15], s39 offen offset:2048 sc1
s_waitcnt lgkmcnt(2)
buffer_store_dwordx2 v[74:75], v23, s[12:15], s39 offen offset:2560 sc1
s_waitcnt lgkmcnt(1)
buffer_store_dwordx2 v[76:77], v23, s[12:15], s39 offen offset:3072 sc1
s_waitcnt lgkmcnt(0)
buffer_store_dwordx2 v[78:79], v23, s[12:15], s39 offen offset:3584 sc1
s_waitcnt vmcnt(17)
s_branch C_start
A_gate:
s_load_dwordx2 s[72:73], s[0:1], 8
s_load_dwordx2 s[76:77], s[0:1], 16
s_load_dwordx2 s[80:81], s[0:1], 24
s_load_dwordx2 s[84:85], s[0:1], 80
s_load_dwordx2 s[64:65], s[0:1], 72
s_load_dwordx2 s[68:69], s[0:1], 88
s_load_dwordx2 s[88:89], s[0:1], 96
s_load_dwordx2 s[12:13], s[0:1], 104
v_cmp_eq_u32 vcc, 0, v0
v_mov_b32 v28, 2146435072
s_mul_i32 s54, s24, 5120
s_mul_i32 s95, s24, 25600
s_add_u32 s95, s95, 61440
v_cndmask_b32 v27, v28, v0, vcc
s_and_b32 s58, s3, 3
s_lshr_b32 s57, s3, 2
s_mov_b32 s14, 48447488
s_mov_b32 s15, 0x00020000
s_mov_b32 s66, 5308928
s_mov_b32 s67, 0x00020000
s_mov_b32 s70, 2359296
s_mov_b32 s71, 0x00020000
s_mov_b32 s74, 2368512
s_mov_b32 s75, 0x00020000
s_mov_b32 s78, 2359296
s_mov_b32 s79, 0x00020000
s_mov_b32 s82, 4608
s_mov_b32 s83, 0x00020000
s_mov_b32 s86, 1152
s_mov_b32 s87, 0x00020000
s_mov_b32 s90, 256
s_mov_b32 s91, 0x00020000
s_mov_b32 s18, 5308928
s_mov_b32 s19, 0x00020000
s_mov_b32 s6, 2363392
s_mov_b32 s7, 0x00020000
s_lshl_b32 s39, s56, 2
s_add_u32 s39, s39, s24
s_waitcnt lgkmcnt(0)
s_sub_u32 s4, s4, 4096
s_subb_u32 s5, s5, 0
s_sub_u32 s64, s64, 512
s_subb_u32 s65, s65, 0
s_cmp_lg_u32 s39, 0
s_cbranch_scc1 A_g1
s_mov_b32 s40, 23674880
buffer_load_dword v2, v27, s[12:15], s40 offen sc1
s_waitcnt vmcnt(0)
v_add_u32 v2, 1, v2
v_lshl_add_u32 v3, v2, 4, 1
buffer_store_dword v3, v27, s[88:91], 0 offen sc1
buffer_store_dword v2, v27, s[12:15], s40 offen sc1
A_g1:
s_mul_i32 s41, s39, 331776
s_add_u32 s42, s41, 43139072
s_lshl_b32 s43, s39, 5
s_add_u32 s43, s43, 23744640
s_mul_i32 s38, s39, 147456
s_add_u32 s38, s38, 4096
s_lshl_b32 s94, s39, 5
s_add_u32 s94, s94, 23725696
s_lshl_b32 s39, s39, 9
s_add_u32 s39, s39, 23666688
v_and_b32 v2, 7, v0
v_lshlrev_b32 v2, 4, v2
v_bfe_u32 v3, v0, 3, 3
v_lshlrev_b32 v5, 2, v3
v_mul_u32_u24 v3, 1152, v3
v_add_u32 v3, v3, v2
v_cmp_eq_u32 vcc, 0, v2
v_mov_b32 v6, 2146435072
s_nop 0
v_cndmask_b32 v5, v6, v5, vcc
s_mov_b32 s60, 4
v_bfe_u32 v4, v0, 1, 2
v_lshrrev_b32 v6, 3, v0
v_lshl_add_u32 v4, v4, 4, v6
v_and_b32 v6, 1, v0
v_lshl_add_u32 v4, v4, 1, v6
v_lshlrev_b32 v4, 4, v4
buffer_load_dwordx4 v[64:67], v3, s[64:67], s41 offen offset:1536
s_add_u32 s41, s41, 9216
buffer_load_dwordx4 v[68:71], v3, s[64:67], s41 offen offset:1536
s_add_u32 s41, s41, 9216
buffer_load_dwordx4 v[72:75], v3, s[64:67], s41 offen offset:1536
s_add_u32 s41, s41, 9216
buffer_load_dwordx4 v[76:79], v3, s[64:67], s41 offen offset:1536
s_add_u32 s41, s41, 9216
buffer_load_dwordx4 v[80:83], v3, s[64:67], s41 offen offset:1536
s_add_u32 s41, s41, 9216
buffer_load_dwordx4 v[84:87], v3, s[64:67], s41 offen offset:1536
s_add_u32 s41, s41, 9216
buffer_load_dwordx4 v[88:91], v3, s[64:67], s41 offen offset:1536
s_add_u32 s41, s41, 9216
buffer_load_dwordx4 v[92:95], v3, s[64:67], s41 offen offset:1536
s_add_u32 s41, s41, 9216
buffer_load_dwordx4 v[96:99], v3, s[64:67], s41 offen offset:1536
s_add_u32 s41, s41, 9216
buffer_load_dwordx4 v[100:103], v3, s[64:67], s41 offen offset:1536
s_add_u32 s41, s41, 9216
buffer_load_dwordx4 v[104:107], v3, s[64:67], s41 offen offset:1536
s_add_u32 s41, s41, 9216
buffer_load_dwordx4 v[108:111], v3, s[64:67], s41 offen offset:1536
s_add_u32 s41, s41, 9216
buffer_load_dwordx4 v[112:115], v3, s[64:67], s41 offen offset:1536
s_add_u32 s41, s41, 9216
buffer_load_dwordx4 v[116:119], v3, s[64:67], s41 offen offset:1536
s_add_u32 s41, s41, 9216
buffer_load_dwordx4 v[120:123], v3, s[64:67], s41 offen offset:1536
s_add_u32 s41, s41, 9216
buffer_load_dwordx4 v[124:127], v3, s[64:67], s41 offen offset:1536
s_add_u32 s41, s41, 9216
buffer_load_dwordx4 v[128:131], v3, s[64:67], s41 offen offset:1536
s_add_u32 s41, s41, 9216
buffer_load_dwordx4 v[132:135], v3, s[64:67], s41 offen offset:1536
s_add_u32 s41, s41, 9216
buffer_load_dwordx4 v[136:139], v3, s[64:67], s41 offen offset:1536
s_add_u32 s41, s41, 9216
buffer_load_dwordx4 v[140:143], v3, s[64:67], s41 offen offset:1536
s_add_u32 s41, s41, 9216
buffer_load_dwordx4 v[144:147], v3, s[64:67], s41 offen offset:1536
s_add_u32 s41, s41, 9216
buffer_load_dwordx4 v[148:151], v3, s[64:67], s41 offen offset:1536
s_add_u32 s41, s41, 9216
buffer_load_dwordx4 v[152:155], v3, s[64:67], s41 offen offset:1536
s_add_u32 s41, s41, 9216
buffer_load_dwordx4 v[156:159], v3, s[64:67], s41 offen offset:1536
s_add_u32 s41, s41, 9216
buffer_load_dwordx4 v[160:163], v3, s[64:67], s41 offen offset:1536
s_add_u32 s41, s41, 9216
buffer_load_dwordx4 v[164:167], v3, s[64:67], s41 offen offset:1536
s_add_u32 s41, s41, 9216
buffer_load_dwordx4 v[168:171], v3, s[64:67], s41 offen offset:1536
s_add_u32 s41, s41, 9216
buffer_load_dwordx4 v[172:175], v3, s[64:67], s41 offen offset:1536
s_add_u32 s41, s41, 9216
buffer_load_dwordx4 v[176:179], v3, s[64:67], s41 offen offset:1536
s_add_u32 s41, s41, 9216
buffer_load_dwordx4 v[180:183], v3, s[64:67], s41 offen offset:1536
s_add_u32 s41, s41, 9216
buffer_load_dwordx4 v[184:187], v3, s[64:67], s41 offen offset:1536
s_add_u32 s41, s41, 9216
buffer_load_dwordx4 v[188:191], v3, s[64:67], s41 offen offset:1536
s_add_u32 s41, s41, 9216
buffer_load_dwordx4 v[192:195], v3, s[64:67], s41 offen offset:1536
s_add_u32 s41, s41, 9216
buffer_load_dwordx4 v[196:199], v3, s[64:67], s41 offen offset:1536
s_add_u32 s41, s41, 9216
buffer_load_dwordx4 v[200:203], v3, s[64:67], s41 offen offset:1536
s_add_u32 s41, s41, 9216
buffer_load_dwordx4 v[204:207], v3, s[64:67], s41 offen offset:1536
s_add_u32 s41, s41, 9216
s_waitcnt vmcnt(35)
buffer_store_dwordx4 v[64:67], v4, s[12:15], s42 offen offset:0 sc1
s_waitcnt vmcnt(35)
buffer_store_dwordx4 v[68:71], v4, s[12:15], s42 offen offset:256 sc1
s_add_u32 s42, s42, 18432
s_waitcnt vmcnt(35)
buffer_store_dwordx4 v[72:75], v4, s[12:15], s42 offen offset:0 sc1
s_waitcnt vmcnt(35)
buffer_store_dwordx4 v[76:79], v4, s[12:15], s42 offen offset:256 sc1
s_add_u32 s42, s42, 18432
s_waitcnt vmcnt(35)
buffer_store_dwordx4 v[80:83], v4, s[12:15], s42 offen offset:0 sc1
s_waitcnt vmcnt(35)
buffer_store_dwordx4 v[84:87], v4, s[12:15], s42 offen offset:256 sc1
s_add_u32 s42, s42, 18432
s_waitcnt vmcnt(35)
buffer_store_dwordx4 v[88:91], v4, s[12:15], s42 offen offset:0 sc1
s_waitcnt vmcnt(35)
buffer_store_dwordx4 v[92:95], v4, s[12:15], s42 offen offset:256 sc1
s_add_u32 s42, s42, 18432
s_waitcnt vmcnt(35)
buffer_store_dwordx4 v[96:99], v4, s[12:15], s42 offen offset:0 sc1
s_waitcnt vmcnt(35)
buffer_store_dwordx4 v[100:103], v4, s[12:15], s42 offen offset:256 sc1
s_add_u32 s42, s42, 18432
s_waitcnt vmcnt(35)
buffer_store_dwordx4 v[104:107], v4, s[12:15], s42 offen offset:0 sc1
s_waitcnt vmcnt(35)
buffer_store_dwordx4 v[108:111], v4, s[12:15], s42 offen offset:256 sc1
s_add_u32 s42, s42, 18432
s_waitcnt vmcnt(35)
buffer_store_dwordx4 v[112:115], v4, s[12:15], s42 offen offset:0 sc1
s_waitcnt vmcnt(35)
buffer_store_dwordx4 v[116:119], v4, s[12:15], s42 offen offset:256 sc1
s_add_u32 s42, s42, 18432
s_waitcnt vmcnt(35)
buffer_store_dwordx4 v[120:123], v4, s[12:15], s42 offen offset:0 sc1
s_waitcnt vmcnt(35)
buffer_store_dwordx4 v[124:127], v4, s[12:15], s42 offen offset:256 sc1
s_add_u32 s42, s42, 18432
s_waitcnt vmcnt(35)
buffer_store_dwordx4 v[128:131], v4, s[12:15], s42 offen offset:0 sc1
s_waitcnt vmcnt(35)
buffer_store_dwordx4 v[132:135], v4, s[12:15], s42 offen offset:256 sc1
s_add_u32 s42, s42, 18432
s_waitcnt vmcnt(35)
buffer_store_dwordx4 v[136:139], v4, s[12:15], s42 offen offset:0 sc1
s_waitcnt vmcnt(35)
buffer_store_dwordx4 v[140:143], v4, s[12:15], s42 offen offset:256 sc1
s_add_u32 s42, s42, 18432
s_waitcnt vmcnt(35)
buffer_store_dwordx4 v[144:147], v4, s[12:15], s42 offen offset:0 sc1
s_waitcnt vmcnt(35)
buffer_store_dwordx4 v[148:151], v4, s[12:15], s42 offen offset:256 sc1
s_add_u32 s42, s42, 18432
s_waitcnt vmcnt(35)
buffer_store_dwordx4 v[152:155], v4, s[12:15], s42 offen offset:0 sc1
s_waitcnt vmcnt(35)
buffer_store_dwordx4 v[156:159], v4, s[12:15], s42 offen offset:256 sc1
s_add_u32 s42, s42, 18432
s_waitcnt vmcnt(35)
buffer_store_dwordx4 v[160:163], v4, s[12:15], s42 offen offset:0 sc1
s_waitcnt vmcnt(35)
buffer_store_dwordx4 v[164:167], v4, s[12:15], s42 offen offset:256 sc1
s_add_u32 s42, s42, 18432
s_waitcnt vmcnt(35)
buffer_store_dwordx4 v[168:171], v4, s[12:15], s42 offen offset:0 sc1
s_waitcnt vmcnt(35)
buffer_store_dwordx4 v[172:175], v4, s[12:15], s42 offen offset:256 sc1
s_add_u32 s42, s42, 18432
s_waitcnt vmcnt(35)
buffer_store_dwordx4 v[176:179], v4, s[12:15], s42 offen offset:0 sc1
s_waitcnt vmcnt(35)
buffer_store_dwordx4 v[180:183], v4, s[12:15], s42 offen offset:256 sc1
s_add_u32 s42, s42, 18432
s_waitcnt vmcnt(35)
buffer_store_dwordx4 v[184:187], v4, s[12:15], s42 offen offset:0 sc1
s_waitcnt vmcnt(35)
buffer_store_dwordx4 v[188:191], v4, s[12:15], s42 offen offset:256 sc1
s_add_u32 s42, s42, 18432
s_waitcnt vmcnt(35)
buffer_store_dwordx4 v[192:195], v4, s[12:15], s42 offen offset:0 sc1
s_waitcnt vmcnt(35)
buffer_store_dwordx4 v[196:199], v4, s[12:15], s42 offen offset:256 sc1
s_add_u32 s42, s42, 18432
s_waitcnt vmcnt(35)
buffer_store_dwordx4 v[200:203], v4, s[12:15], s42 offen offset:0 sc1
s_waitcnt vmcnt(35)
buffer_store_dwordx4 v[204:207], v4, s[12:15], s42 offen offset:256 sc1
s_add_u32 s42, s42, 18432
v_mov_b32 v50, 0
v_cmp_eq_u32 vcc, 0, v50
s_and_b64 vcc, vcc, 1
s_cbranch_vccz A_n1_x
s_mov_b32 s62, 0
A_n1_p:
buffer_load_dword v50, v27, s[88:91], 0 offen sc1
s_add_u32 s62, s62, 1
s_cmp_gt_u32 s62, 200000
s_cbranch_scc1 A_n1_x
s_waitcnt vmcnt(0)
v_cmp_eq_u32 vcc, 0, v50
s_and_b64 vcc, vcc, 1
s_cbranch_vccnz A_n1_p
A_n1_x:
v_readfirstlane_b32 s92, v50
s_and_b32 s92, s92, -16
s_nop 0
v_mov_b32 v48, s92
s_waitcnt vmcnt(0)
v_add_u32 v49, 8, v48
buffer_store_dword v49, v27, s[12:15], s43 offen sc1
buffer_load_dwordx4 v[28:31], v2, s[84:87], 0 offen offset:0
buffer_load_dwordx4 v[32:35], v2, s[84:87], 0 offen offset:128
buffer_load_dwordx4 v[36:39], v2, s[84:87], 0 offen offset:256
buffer_load_dwordx4 v[40:43], v2, s[84:87], 0 offen offset:384
buffer_load_dwordx4 v[44:47], v2, s[84:87], 0 offen offset:512
buffer_load_dwordx4 v[48:51], v2, s[84:87], 0 offen offset:640
buffer_load_dwordx4 v[52:55], v2, s[84:87], 0 offen offset:768
buffer_load_dwordx4 v[56:59], v2, s[84:87], 0 offen offset:896
buffer_load_dwordx4 v[60:63], v2, s[84:87], 0 offen offset:1024
A_gloop:
buffer_load_dwordx4 v[64:67], v3, s[4:7], s38 offen offset:0
buffer_load_dwordx4 v[68:71], v3, s[4:7], s38 offen offset:128
buffer_load_dwordx4 v[72:75], v3, s[4:7], s38 offen offset:256
buffer_load_dwordx4 v[76:79], v3, s[4:7], s38 offen offset:384
buffer_load_dwordx4 v[80:83], v3, s[4:7], s38 offen offset:512
buffer_load_dwordx4 v[84:87], v3, s[4:7], s38 offen offset:640
buffer_load_dwordx4 v[88:91], v3, s[4:7], s38 offen offset:768
buffer_load_dwordx4 v[92:95], v3, s[4:7], s38 offen offset:896
buffer_load_dwordx4 v[96:99], v3, s[4:7], s38 offen offset:1024
s_add_u32 s38, s38, 9216
buffer_load_dwordx4 v[100:103], v3, s[4:7], s38 offen offset:0
buffer_load_dwordx4 v[104:107], v3, s[4:7], s38 offen offset:128
buffer_load_dwordx4 v[108:111], v3, s[4:7], s38 offen offset:256
buffer_load_dwordx4 v[112:115], v3, s[4:7], s38 offen offset:384
buffer_load_dwordx4 v[116:119], v3, s[4:7], s38 offen offset:512
buffer_load_dwordx4 v[120:123], v3, s[4:7], s38 offen offset:640
buffer_load_dwordx4 v[124:127], v3, s[4:7], s38 offen offset:768
buffer_load_dwordx4 v[128:131], v3, s[4:7], s38 offen offset:896
buffer_load_dwordx4 v[132:135], v3, s[4:7], s38 offen offset:1024
s_add_u32 s38, s38, 9216
buffer_load_dwordx4 v[136:139], v3, s[4:7], s38 offen offset:0
buffer_load_dwordx4 v[140:143], v3, s[4:7], s38 offen offset:128
buffer_load_dwordx4 v[144:147], v3, s[4:7], s38 offen offset:256
buffer_load_dwordx4 v[148:151], v3, s[4:7], s38 offen offset:384
buffer_load_dwordx4 v[152:155], v3, s[4:7], s38 offen offset:512
buffer_load_dwordx4 v[156:159], v3, s[4:7], s38 offen offset:640
buffer_load_dwordx4 v[160:163], v3, s[4:7], s38 offen offset:768
buffer_load_dwordx4 v[164:167], v3, s[4:7], s38 offen offset:896
buffer_load_dwordx4 v[168:171], v3, s[4:7], s38 offen offset:1024
s_add_u32 s38, s38, 9216
buffer_load_dwordx4 v[172:175], v3, s[4:7], s38 offen offset:0
buffer_load_dwordx4 v[176:179], v3, s[4:7], s38 offen offset:128
buffer_load_dwordx4 v[180:183], v3, s[4:7], s38 offen offset:256
buffer_load_dwordx4 v[184:187], v3, s[4:7], s38 offen offset:384
buffer_load_dwordx4 v[188:191], v3, s[4:7], s38 offen offset:512
buffer_load_dwordx4 v[192:195], v3, s[4:7], s38 offen offset:640
buffer_load_dwordx4 v[196:199], v3, s[4:7], s38 offen offset:768
buffer_load_dwordx4 v[200:203], v3, s[4:7], s38 offen offset:896
buffer_load_dwordx4 v[204:207], v3, s[4:7], s38 offen offset:1024
s_add_u32 s38, s38, 9216
s_waitcnt vmcnt(27)
v_dot2_f32_bf16 v210, v64, v28, 0
v_dot2_f32_bf16 v211, v65, v29, 0
v_dot2_f32_bf16 v212, v66, v30, 0
v_dot2_f32_bf16 v213, v67, v31, 0
v_dot2_f32_bf16 v210, v68, v32, v210
v_dot2_f32_bf16 v211, v69, v33, v211
v_dot2_f32_bf16 v212, v70, v34, v212
v_dot2_f32_bf16 v213, v71, v35, v213
v_dot2_f32_bf16 v210, v72, v36, v210
v_dot2_f32_bf16 v211, v73, v37, v211
v_dot2_f32_bf16 v212, v74, v38, v212
v_dot2_f32_bf16 v213, v75, v39, v213
v_dot2_f32_bf16 v210, v76, v40, v210
v_dot2_f32_bf16 v211, v77, v41, v211
v_dot2_f32_bf16 v212, v78, v42, v212
v_dot2_f32_bf16 v213, v79, v43, v213
v_dot2_f32_bf16 v210, v80, v44, v210
v_dot2_f32_bf16 v211, v81, v45, v211
v_dot2_f32_bf16 v212, v82, v46, v212
v_dot2_f32_bf16 v213, v83, v47, v213
v_dot2_f32_bf16 v210, v84, v48, v210
v_dot2_f32_bf16 v211, v85, v49, v211
v_dot2_f32_bf16 v212, v86, v50, v212
v_dot2_f32_bf16 v213, v87, v51, v213
v_dot2_f32_bf16 v210, v88, v52, v210
v_dot2_f32_bf16 v211, v89, v53, v211
v_dot2_f32_bf16 v212, v90, v54, v212
v_dot2_f32_bf16 v213, v91, v55, v213
v_dot2_f32_bf16 v210, v92, v56, v210
v_dot2_f32_bf16 v211, v93, v57, v211
v_dot2_f32_bf16 v212, v94, v58, v212
v_dot2_f32_bf16 v213, v95, v59, v213
v_dot2_f32_bf16 v210, v96, v60, v210
v_dot2_f32_bf16 v211, v97, v61, v211
v_dot2_f32_bf16 v212, v98, v62, v212
v_dot2_f32_bf16 v213, v99, v63, v213
s_nop 2
v_add_f32 v210, v210, v211
v_add_f32 v212, v212, v213
v_add_f32 v210, v210, v212
s_nop 1
v_add_f32_dpp v210, v210, v210 quad_perm:[1,0,3,2] row_mask:0xf bank_mask:0xf
s_nop 1
v_add_f32_dpp v210, v210, v210 quad_perm:[2,3,0,1] row_mask:0xf bank_mask:0xf
s_nop 1
v_add_f32_dpp v210, v210, v210 row_half_mirror row_mask:0xf bank_mask:0xf
v_mul_f32 v210, 3216550459, v210
v_exp_f32 v210, v210
s_nop 0
v_add_f32 v210, 1.0, v210
v_rcp_f32 v214, v210
s_nop 0
buffer_store_dword v214, v5, s[12:15], s39 offen offset:0 sc1
s_waitcnt vmcnt(19)
v_dot2_f32_bf16 v210, v100, v28, 0
v_dot2_f32_bf16 v211, v101, v29, 0
v_dot2_f32_bf16 v212, v102, v30, 0
v_dot2_f32_bf16 v213, v103, v31, 0
v_dot2_f32_bf16 v210, v104, v32, v210
v_dot2_f32_bf16 v211, v105, v33, v211
v_dot2_f32_bf16 v212, v106, v34, v212
v_dot2_f32_bf16 v213, v107, v35, v213
v_dot2_f32_bf16 v210, v108, v36, v210
v_dot2_f32_bf16 v211, v109, v37, v211
v_dot2_f32_bf16 v212, v110, v38, v212
v_dot2_f32_bf16 v213, v111, v39, v213
v_dot2_f32_bf16 v210, v112, v40, v210
v_dot2_f32_bf16 v211, v113, v41, v211
v_dot2_f32_bf16 v212, v114, v42, v212
v_dot2_f32_bf16 v213, v115, v43, v213
v_dot2_f32_bf16 v210, v116, v44, v210
v_dot2_f32_bf16 v211, v117, v45, v211
v_dot2_f32_bf16 v212, v118, v46, v212
v_dot2_f32_bf16 v213, v119, v47, v213
v_dot2_f32_bf16 v210, v120, v48, v210
v_dot2_f32_bf16 v211, v121, v49, v211
v_dot2_f32_bf16 v212, v122, v50, v212
v_dot2_f32_bf16 v213, v123, v51, v213
v_dot2_f32_bf16 v210, v124, v52, v210
v_dot2_f32_bf16 v211, v125, v53, v211
v_dot2_f32_bf16 v212, v126, v54, v212
v_dot2_f32_bf16 v213, v127, v55, v213
v_dot2_f32_bf16 v210, v128, v56, v210
v_dot2_f32_bf16 v211, v129, v57, v211
v_dot2_f32_bf16 v212, v130, v58, v212
v_dot2_f32_bf16 v213, v131, v59, v213
v_dot2_f32_bf16 v210, v132, v60, v210
v_dot2_f32_bf16 v211, v133, v61, v211
v_dot2_f32_bf16 v212, v134, v62, v212
v_dot2_f32_bf16 v213, v135, v63, v213
s_nop 2
v_add_f32 v210, v210, v211
v_add_f32 v212, v212, v213
v_add_f32 v210, v210, v212
s_nop 1
v_add_f32_dpp v210, v210, v210 quad_perm:[1,0,3,2] row_mask:0xf bank_mask:0xf
s_nop 1
v_add_f32_dpp v210, v210, v210 quad_perm:[2,3,0,1] row_mask:0xf bank_mask:0xf
s_nop 1
v_add_f32_dpp v210, v210, v210 row_half_mirror row_mask:0xf bank_mask:0xf
v_mul_f32 v210, 3216550459, v210
v_exp_f32 v210, v210
s_nop 0
v_add_f32 v210, 1.0, v210
v_rcp_f32 v215, v210
s_nop 0
buffer_store_dword v215, v5, s[12:15], s39 offen offset:32 sc1
s_waitcnt vmcnt(11)
v_dot2_f32_bf16 v210, v136, v28, 0
v_dot2_f32_bf16 v211, v137, v29, 0
v_dot2_f32_bf16 v212, v138, v30, 0
v_dot2_f32_bf16 v213, v139, v31, 0
v_dot2_f32_bf16 v210, v140, v32, v210
v_dot2_f32_bf16 v211, v141, v33, v211
v_dot2_f32_bf16 v212, v142, v34, v212
v_dot2_f32_bf16 v213, v143, v35, v213
v_dot2_f32_bf16 v210, v144, v36, v210
v_dot2_f32_bf16 v211, v145, v37, v211
v_dot2_f32_bf16 v212, v146, v38, v212
v_dot2_f32_bf16 v213, v147, v39, v213
v_dot2_f32_bf16 v210, v148, v40, v210
v_dot2_f32_bf16 v211, v149, v41, v211
v_dot2_f32_bf16 v212, v150, v42, v212
v_dot2_f32_bf16 v213, v151, v43, v213
v_dot2_f32_bf16 v210, v152, v44, v210
v_dot2_f32_bf16 v211, v153, v45, v211
v_dot2_f32_bf16 v212, v154, v46, v212
v_dot2_f32_bf16 v213, v155, v47, v213
v_dot2_f32_bf16 v210, v156, v48, v210
v_dot2_f32_bf16 v211, v157, v49, v211
v_dot2_f32_bf16 v212, v158, v50, v212
v_dot2_f32_bf16 v213, v159, v51, v213
v_dot2_f32_bf16 v210, v160, v52, v210
v_dot2_f32_bf16 v211, v161, v53, v211
v_dot2_f32_bf16 v212, v162, v54, v212
v_dot2_f32_bf16 v213, v163, v55, v213
v_dot2_f32_bf16 v210, v164, v56, v210
v_dot2_f32_bf16 v211, v165, v57, v211
v_dot2_f32_bf16 v212, v166, v58, v212
v_dot2_f32_bf16 v213, v167, v59, v213
v_dot2_f32_bf16 v210, v168, v60, v210
v_dot2_f32_bf16 v211, v169, v61, v211
v_dot2_f32_bf16 v212, v170, v62, v212
v_dot2_f32_bf16 v213, v171, v63, v213
s_nop 2
v_add_f32 v210, v210, v211
v_add_f32 v212, v212, v213
v_add_f32 v210, v210, v212
s_nop 1
v_add_f32_dpp v210, v210, v210 quad_perm:[1,0,3,2] row_mask:0xf bank_mask:0xf
s_nop 1
v_add_f32_dpp v210, v210, v210 quad_perm:[2,3,0,1] row_mask:0xf bank_mask:0xf
s_nop 1
v_add_f32_dpp v210, v210, v210 row_half_mirror row_mask:0xf bank_mask:0xf
v_mul_f32 v210, 3216550459, v210
v_exp_f32 v210, v210
s_nop 0
v_add_f32 v210, 1.0, v210
v_rcp_f32 v216, v210
s_nop 0
buffer_store_dword v216, v5, s[12:15], s39 offen offset:64 sc1
s_waitcnt vmcnt(3)
v_dot2_f32_bf16 v210, v172, v28, 0
v_dot2_f32_bf16 v211, v173, v29, 0
v_dot2_f32_bf16 v212, v174, v30, 0
v_dot2_f32_bf16 v213, v175, v31, 0
v_dot2_f32_bf16 v210, v176, v32, v210
v_dot2_f32_bf16 v211, v177, v33, v211
v_dot2_f32_bf16 v212, v178, v34, v212
v_dot2_f32_bf16 v213, v179, v35, v213
v_dot2_f32_bf16 v210, v180, v36, v210
v_dot2_f32_bf16 v211, v181, v37, v211
v_dot2_f32_bf16 v212, v182, v38, v212
v_dot2_f32_bf16 v213, v183, v39, v213
v_dot2_f32_bf16 v210, v184, v40, v210
v_dot2_f32_bf16 v211, v185, v41, v211
v_dot2_f32_bf16 v212, v186, v42, v212
v_dot2_f32_bf16 v213, v187, v43, v213
v_dot2_f32_bf16 v210, v188, v44, v210
v_dot2_f32_bf16 v211, v189, v45, v211
v_dot2_f32_bf16 v212, v190, v46, v212
v_dot2_f32_bf16 v213, v191, v47, v213
v_dot2_f32_bf16 v210, v192, v48, v210
v_dot2_f32_bf16 v211, v193, v49, v211
v_dot2_f32_bf16 v212, v194, v50, v212
v_dot2_f32_bf16 v213, v195, v51, v213
v_dot2_f32_bf16 v210, v196, v52, v210
v_dot2_f32_bf16 v211, v197, v53, v211
v_dot2_f32_bf16 v212, v198, v54, v212
v_dot2_f32_bf16 v213, v199, v55, v213
v_dot2_f32_bf16 v210, v200, v56, v210
v_dot2_f32_bf16 v211, v201, v57, v211
v_dot2_f32_bf16 v212, v202, v58, v212
v_dot2_f32_bf16 v213, v203, v59, v213
v_dot2_f32_bf16 v210, v204, v60, v210
v_dot2_f32_bf16 v211, v205, v61, v211
v_dot2_f32_bf16 v212, v206, v62, v212
v_dot2_f32_bf16 v213, v207, v63, v213
s_nop 2
v_add_f32 v210, v210, v211
v_add_f32 v212, v212, v213
v_add_f32 v210, v210, v212
s_nop 1
v_add_f32_dpp v210, v210, v210 quad_perm:[1,0,3,2] row_mask:0xf bank_mask:0xf
s_nop 1
v_add_f32_dpp v210, v210, v210 quad_perm:[2,3,0,1] row_mask:0xf bank_mask:0xf
s_nop 1
v_add_f32_dpp v210, v210, v210 row_half_mirror row_mask:0xf bank_mask:0xf
v_mul_f32 v210, 3216550459, v210
v_exp_f32 v210, v210
s_nop 0
v_add_f32 v210, 1.0, v210
v_rcp_f32 v217, v210
s_nop 0
buffer_store_dword v217, v5, s[12:15], s39 offen offset:96 sc1
s_add_u32 s39, s39, 128
s_sub_u32 s60, s60, 1
s_cmp_lg_u32 s60, 0
s_cbranch_scc1 A_gloop
v_mov_b32 v25, -1
s_mov_b32 s32, 0
s_mul_i32 s40, s56, 36
s_mul_i32 s41, s24, 9
s_add_u32 s40, s40, s41
s_mul_i32 s96, s40, 36864
v_lshrrev_b32 v28, 4, v0
v_mul_u32_u24 v28, 4608, v28
v_lshrrev_b32 v29, 1, v0
v_and_b32 v30, 8, v29
s_lshl_b32 s41, s24, 2
v_xor_b32 v30, s41, v30
v_xor_b32 v30, v30, v0
v_and_b32 v30, 15, v30
v_lshl_add_u32 v28, v30, 4, v28
s_lshl_b32 s41, s58, 8
v_add_u32 v3, s41, v28
v_add_u32 v4, 96, v3
v_add_u32 v5, 96, v4
v_add_u32 v6, 96, v5
v_mul_u32_u24 v29, 1152, v29
v_and_b32 v30, 1, v0
v_lshl_add_u32 v29, v30, 4, v29
s_lshl_b32 s41, s58, 5
s_add_u32 s41, s41, 1536
v_cmp_gt_u32 vcc, 32, v0
v_add_u32 v29, s41, v29
v_mov_b32 v30, 2146435072
v_cndmask_b32 v216, v30, v29, vcc
s_lshl_b32 s41, s58, 9
s_add_u32 s41, s41, 43139072
v_lshl_add_u32 v29, v0, 4, s41
v_cndmask_b32 v2, v30, v29, vcc
s_lshl_b32 s43, s57, 2
s_mov_b32 s44, 841027584
s_mov_b32 s45, 1716868163
s_lshr_b64 s[44:45], s[44:45], s43
s_and_b32 s44, s44, 7
s_mul_i32 s44, s44, 144
s_add_u32 s44, s44, s40
s_mov_b32 s46, 857870592
s_mov_b32 s47, 1717916740
s_lshr_b64 s[46:47], s[46:47], s43
s_and_b32 s46, s46, 7
s_mul_i32 s46, s46, 144
s_add_u32 s46, s46, s40
s_sub_u32 s46, s46, 9
s_lshr_b32 s47, s57, 2
s_mul_i32 s47, s47, 144
s_lshl_b32 s45, s58, 2
s_add_u32 s42, s47, s45
s_add_u32 s42, s42, 1086
s_lshl_b32 s45, s58, 5
s_add_u32 s47, s47, s45
s_add_u32 s47, s47, 990
s_add_u32 s45, s57, 1584
v_add_u32 v28, s44, v0
v_add_u32 v29, s46, v0
v_cmp_gt_u32 vcc, 9, v0
v_add_u32 v30, s47, v0
v_mov_b32 v31, s45
v_cndmask_b32 v28, v29, v28, vcc
v_cmp_gt_u32 vcc, 50, v0
v_add_u32 v29, s42, v0
s_nop 0
v_cndmask_b32 v30, v29, v30, vcc
v_cmp_gt_u32 vcc, 54, v0
v_mov_b32 v29, 23675008
s_nop 0
v_cndmask_b32 v30, v31, v30, vcc
v_cmp_gt_u32 vcc, 18, v0
s_nop 1
v_cndmask_b32 v28, v30, v28, vcc
v_lshl_add_u32 v7, v28, 5, v29
v_bfe_u32 v28, v0, 2, 2
v_mul_u32_u24 v28, 1056, v28
v_and_b32 v29, 3, v0
v_lshl_add_u32 v28, v29, 3, v28
v_and_b32 v29, 48, v0
v_lshl_add_u32 v28, v29, 4, v28
v_add_u32 v28, 512, v28
v_lshlrev_b32 v29, 3, v0
v_and_b32 v32, 128, v29
v_add_u32 v30, v28, v32
v_sub_u32 v31, v28, v32
v_add_u32 v14, s95, v30
v_add_u32 v15, s95, v31
v_add_u32 v16, s95, v29
v_add_u32 v17, s54, v30
v_add_u32 v18, s54, v31
v_add_u32 v19, s54, v29
s_add_u32 m0, s95, 0
s_add_u32 s97, s96, 0
buffer_load_dwordx4 v2, s[12:15], s97 offen sc1 lds
buffer_load_dwordx4 v3, s[64:67], s97 offen offset:512 lds
buffer_load_dwordx4 v4, s[64:67], s97 offen offset:1568 lds
buffer_load_dwordx4 v5, s[64:67], s97 offen offset:2624 lds
buffer_load_dwordx4 v6, s[64:67], s97 offen offset:3680 lds
s_add_u32 m0, s95, 5120
s_add_u32 s97, s96, 18432
buffer_load_dwordx4 v2, s[12:15], s97 offen sc1 lds
buffer_load_dwordx4 v3, s[64:67], s97 offen offset:512 lds
buffer_load_dwordx4 v4, s[64:67], s97 offen offset:1568 lds
buffer_load_dwordx4 v5, s[64:67], s97 offen offset:2624 lds
buffer_load_dwordx4 v6, s[64:67], s97 offen offset:3680 lds
s_add_u32 m0, s95, 10240
s_add_u32 s97, s96, 36864
buffer_load_dwordx4 v2, s[12:15], s97 offen sc1 lds
buffer_load_dwordx4 v3, s[64:67], s97 offen offset:512 lds
buffer_load_dwordx4 v4, s[64:67], s97 offen offset:1568 lds
buffer_load_dwordx4 v5, s[64:67], s97 offen offset:2624 lds
buffer_load_dwordx4 v6, s[64:67], s97 offen offset:3680 lds
s_add_u32 m0, s95, 15360
s_add_u32 s97, s96, 55296
buffer_load_dwordx4 v2, s[12:15], s97 offen sc1 lds
buffer_load_dwordx4 v3, s[64:67], s97 offen offset:512 lds
buffer_load_dwordx4 v4, s[64:67], s97 offen offset:1568 lds
buffer_load_dwordx4 v5, s[64:67], s97 offen offset:2624 lds
buffer_load_dwordx4 v6, s[64:67], s97 offen offset:3680 lds
s_waitcnt vmcnt(15)
ds_read_b64_tr_b16 v[100:101], v14 offset:0
ds_read_b64_tr_b16 v[104:105], v14 offset:32
ds_read_b64_tr_b16 v[108:109], v14 offset:64
ds_read_b64_tr_b16 v[112:113], v14 offset:96
ds_read_b64_tr_b16 v[116:117], v15 offset:128
ds_read_b64_tr_b16 v[120:121], v15 offset:160
ds_read_b64_tr_b16 v[124:125], v15 offset:192
ds_read_b64_tr_b16 v[128:129], v15 offset:224
ds_read_b64_tr_b16 v[168:169], v16 offset:0
s_waitcnt vmcnt(10)
ds_read_b64_tr_b16 v[102:103], v14 offset:5120
ds_read_b64_tr_b16 v[106:107], v14 offset:5152
ds_read_b64_tr_b16 v[110:111], v14 offset:5184
ds_read_b64_tr_b16 v[114:115], v14 offset:5216
ds_read_b64_tr_b16 v[118:119], v15 offset:5248
ds_read_b64_tr_b16 v[122:123], v15 offset:5280
ds_read_b64_tr_b16 v[126:127], v15 offset:5312
ds_read_b64_tr_b16 v[130:131], v15 offset:5344
ds_read_b64_tr_b16 v[170:171], v16 offset:5120
s_waitcnt vmcnt(5)
ds_read_b64_tr_b16 v[172:173], v14 offset:10240
ds_read_b64_tr_b16 v[176:177], v14 offset:10272
ds_read_b64_tr_b16 v[180:181], v14 offset:10304
ds_read_b64_tr_b16 v[184:185], v14 offset:10336
ds_read_b64_tr_b16 v[188:189], v15 offset:10368
ds_read_b64_tr_b16 v[192:193], v15 offset:10400
ds_read_b64_tr_b16 v[196:197], v15 offset:10432
ds_read_b64_tr_b16 v[200:201], v15 offset:10464
ds_read_b64_tr_b16 v[204:205], v16 offset:10240
s_waitcnt vmcnt(0)
ds_read_b64_tr_b16 v[174:175], v14 offset:15360
ds_read_b64_tr_b16 v[178:179], v14 offset:15392
ds_read_b64_tr_b16 v[182:183], v14 offset:15424
ds_read_b64_tr_b16 v[186:187], v14 offset:15456
ds_read_b64_tr_b16 v[190:191], v15 offset:15488
ds_read_b64_tr_b16 v[194:195], v15 offset:15520
ds_read_b64_tr_b16 v[198:199], v15 offset:15552
ds_read_b64_tr_b16 v[202:203], v15 offset:15584
ds_read_b64_tr_b16 v[206:207], v16 offset:15360
s_waitcnt lgkmcnt(0)
s_add_u32 m0, s95, 0
s_add_u32 s97, s96, 73728
buffer_load_dwordx4 v2, s[12:15], s97 offen sc1 lds
buffer_load_dwordx4 v3, s[64:67], s97 offen offset:512 lds
buffer_load_dwordx4 v4, s[64:67], s97 offen offset:1568 lds
buffer_load_dwordx4 v5, s[64:67], s97 offen offset:2624 lds
buffer_load_dwordx4 v6, s[64:67], s97 offen offset:3680 lds
s_add_u32 m0, s95, 5120
s_add_u32 s97, s96, 92160
buffer_load_dwordx4 v2, s[12:15], s97 offen sc1 lds
buffer_load_dwordx4 v3, s[64:67], s97 offen offset:512 lds
buffer_load_dwordx4 v4, s[64:67], s97 offen offset:1568 lds
buffer_load_dwordx4 v5, s[64:67], s97 offen offset:2624 lds
buffer_load_dwordx4 v6, s[64:67], s97 offen offset:3680 lds
s_add_u32 m0, s95, 10240
s_add_u32 s97, s96, 110592
buffer_load_dwordx4 v2, s[12:15], s97 offen sc1 lds
buffer_load_dwordx4 v3, s[64:67], s97 offen offset:512 lds
buffer_load_dwordx4 v4, s[64:67], s97 offen offset:1568 lds
buffer_load_dwordx4 v5, s[64:67], s97 offen offset:2624 lds
buffer_load_dwordx4 v6, s[64:67], s97 offen offset:3680 lds
s_add_u32 m0, s95, 15360
s_add_u32 s97, s96, 129024
buffer_load_dwordx4 v2, s[12:15], s97 offen sc1 lds
buffer_load_dwordx4 v3, s[64:67], s97 offen offset:512 lds
buffer_load_dwordx4 v4, s[64:67], s97 offen offset:1568 lds
buffer_load_dwordx4 v5, s[64:67], s97 offen offset:2624 lds
buffer_load_dwordx4 v6, s[64:67], s97 offen offset:3680 lds
s_add_u32 m0, s95, 20480
s_add_u32 s97, s96, 147456
buffer_load_dwordx4 v2, s[12:15], s97 offen sc1 lds
buffer_load_dwordx4 v3, s[64:67], s97 offen offset:512 lds
buffer_load_dwordx4 v4, s[64:67], s97 offen offset:1568 lds
buffer_load_dwordx4 v5, s[64:67], s97 offen offset:2624 lds
buffer_load_dwordx4 v6, s[64:67], s97 offen offset:3680 lds
s_add_u32 m0, s54, 0
s_add_u32 s97, s96, 165888
buffer_load_dwordx4 v2, s[12:15], s97 offen sc1 lds
buffer_load_dwordx4 v3, s[64:67], s97 offen offset:512 lds
buffer_load_dwordx4 v4, s[64:67], s97 offen offset:1568 lds
buffer_load_dwordx4 v5, s[64:67], s97 offen offset:2624 lds
buffer_load_dwordx4 v6, s[64:67], s97 offen offset:3680 lds
s_add_u32 m0, s54, 20480
s_add_u32 s97, s96, 184320
buffer_load_dwordx4 v2, s[12:15], s97 offen sc1 lds
buffer_load_dwordx4 v3, s[64:67], s97 offen offset:512 lds
buffer_load_dwordx4 v4, s[64:67], s97 offen offset:1568 lds
buffer_load_dwordx4 v5, s[64:67], s97 offen offset:2624 lds
buffer_load_dwordx4 v6, s[64:67], s97 offen offset:3680 lds
s_add_u32 m0, s54, 40960
s_add_u32 s97, s96, 202752
buffer_load_dwordx4 v2, s[12:15], s97 offen sc1 lds
buffer_load_dwordx4 v3, s[64:67], s97 offen offset:512 lds
buffer_load_dwordx4 v4, s[64:67], s97 offen offset:1568 lds
buffer_load_dwordx4 v5, s[64:67], s97 offen offset:2624 lds
buffer_load_dwordx4 v6, s[64:67], s97 offen offset:3680 lds
buffer_load_dword v8, v7, s[12:15], 0 offen sc1
s_waitcnt vmcnt(0)
s_branch A_nc
.section .rodata,"a"
.p2align 6
.amdhsa_kernel gated_mix__ssm_conv_h3__geglu_ffn__prompt_kernel
  .amdhsa_next_free_vgpr 512
  .amdhsa_next_free_sgpr 102
  .amdhsa_accum_offset 256
  .amdhsa_group_segment_fixed_size 0
  .amdhsa_kernarg_size 112
  .amdhsa_user_sgpr_count 2
  .amdhsa_user_sgpr_kernarg_segment_ptr 1
  .amdhsa_system_sgpr_workgroup_id_x 1
.end_amdhsa_kernel
.text
```
